```python
import torch

def _softmax(x, axis=-1):
    return torch.softmax(x, dim=axis)

def _gelu(x):
    return torch.nn.functional.gelu(x, approximate='tanh')

def _silu(x):
    return torch.nn.functional.silu(x)

def _sigmoid(x):
    return torch.sigmoid(x)

def _layernorm(x, axis=-1, eps=1e-05):
    m = x.mean(dim=axis, keepdim=True)
    v = x.var(dim=axis, keepdim=True, unbiased=False)
    return (x - m) / torch.sqrt(v + eps)

def _scatter_add(tgt, idx, src, axis=0):
    return tgt.clone().index_add_(axis, idx, src)

def _segment_sum(src, seg, n):
    out = torch.zeros((n,) + src.shape[1:], dtype=src.dtype)
    return out.index_add_(0, seg, src)

def _pad(x, pw):
    flat = tuple((v for pair in reversed(pw) for v in pair))
    return torch.nn.functional.pad(x, flat)
kernel_name = 'adaLN_cond__sliding_block__glu_gated_reglu__prompt'

def setup_inputs():

    _w = lambda a: (lambda t: t.to(torch.bfloat16) if t.is_floating_point() else t)(torch.as_tensor(a))

    def _A_setup():
        B, S, D = (1, 2048, 448)
        return {'x': _w((lambda *s: torch.randn(*s, dtype=torch.bfloat16) * 0.05)(B, S, D)), 'wqkv': _w((lambda *s: torch.randn(*s, dtype=torch.bfloat16) * 0.05)(D, 3 * D)), 'wo': _w((lambda *s: torch.randn(*s, dtype=torch.bfloat16) * 0.05)(D, D))}
    _A_in = _A_setup()

    def _B_setup():
        B, S, D, F = (1, 2048, 448, 1792)
        return {'x': _w((lambda *s: torch.randn(*s, dtype=torch.bfloat16) * 0.05)(B, S, D)), 'W_gate': _w((lambda *s: torch.randn(*s, dtype=torch.bfloat16) * 0.8)(D, F) * (2.0 / D) ** 0.5), 'W_up': _w((lambda *s: torch.randn(*s, dtype=torch.bfloat16) * 0.8)(D, F) * (2.0 / D) ** 0.5), 'W_down': _w((lambda *s: torch.randn(*s, dtype=torch.bfloat16) * 0.8)(F, D) * (1.0 / F) ** 0.5)}
    _B_in = _B_setup()
    return {'A_x': _A_in['x'], 'A_wqkv': _A_in['wqkv'], 'A_wo': _A_in['wo'], 'B_x': _B_in['x'], 'B_W_gate': _B_in['W_gate'], 'B_W_up': _B_in['W_up'], 'B_W_down': _B_in['W_down'], 'c': _w((lambda *s: torch.randn(*s, dtype=torch.bfloat16) * 0.1)(1, 448) * 8.0), 'w_mod': _w((lambda *s: torch.randn(*s, dtype=torch.bfloat16) * 0.1)(448, 6 * 448) * 448 ** (-0.5) * 8.0)}

def reference(A_x, A_wqkv, A_wo, B_x, B_W_gate, B_W_up, B_W_down, c, w_mod):

    def _A_ref(x, wqkv, wo):
        B, S, D = x.shape
        H = 16
        Dh = D // H
        W = 256
        qkv = (lambda x, *d: x.permute(*d))((x @ wqkv).reshape(B, S, 3, H, Dh), 2, 0, 3, 1, 4)
        q, k, v = (qkv[0], qkv[1], qkv[2])
        scores = torch.einsum('bhqd,bhkd->bhqk', q, k) * Dh ** (-0.5)
        idx = torch.arange(S)
        mask = (idx[:, None] - idx[None, :] >= 0) & (idx[:, None] - idx[None, :] < W)
        scores = torch.where(mask[None, None], scores, -1000000000.0)
        p = _softmax(scores, axis=-1)
        o = torch.einsum('bhqk,bhkd->bhqd', p, v)
        return (lambda x, *d: x.permute(*d))(o, 0, 2, 1, 3).reshape(B, S, D) @ wo

    def _B_ref(x, W_gate, W_up, W_down):
        gate = torch.einsum('bsd,df->bsf', x, W_gate)
        up = torch.einsum('bsd,df->bsf', x, W_up)
        gate = gate * (lambda x, dt: x.to(dt))(gate > 0, gate.dtype)
        h = gate * up
        return torch.einsum('bsf,fd->bsd', h, W_down)
    x = A_x
    mod = (_silu(c) @ w_mod).reshape(c.shape[0], 6, 1, -1)
    sa, ca, ga, sb, cb, gb = (mod[:, 0].clone(), mod[:, 1].clone(), mod[:, 2].clone(), mod[:, 3].clone(), mod[:, 4].clone(), mod[:, 5].clone())
    h = _layernorm(x, axis=-1) * (1 + ca) + sa
    x = x + ga * _A_ref(h, A_wqkv, A_wo)
    h = _layernorm(x, axis=-1) * (1 + cb) + sb
    x = x + gb * _B_ref(h, B_W_gate, B_W_up, B_W_down)
    return x
```

```asm
; @launch grid=(256,1,1) block=(256,1,1) lds=163840
.amdgcn_target "amdgcn-amd-amdhsa--gfx950"
.text
.globl adaLN_cond__sliding_block__glu_gated_reglu__prompt_kernel
.p2align 8
.type adaLN_cond__sliding_block__glu_gated_reglu__prompt_kernel,@function
adaLN_cond__sliding_block__glu_gated_reglu__prompt_kernel:
    s_load_dwordx16 s[64:79], s[0:1], 0
    s_load_dwordx8 s[80:87], s[0:1], 64
    s_lshr_b32 s3, s2, 8
    s_cbranch_scc1 L_exit
    v_lshrrev_b32 v2, 6, v0
    v_and_b32 v3, 63, v0
    v_readfirstlane_b32 s46, v2
    s_getpc_b64 s[98:99]
L_pc:
    s_lshr_b32 s45, s2, 3
    s_lshl2_add_u32 s53, s45, s46
    s_lshl_b32 s53, s53, 9
    v_lshl_add_u32 v4, v3, 7, s53
    v_min_u32 v4, L_fast_end-L_pc-4, v4
    s_mov_b64 exec, 15
    global_load_dword a255, v4, s[98:99]
    s_mov_b64 exec, -1
    v_lshlrev_b32 v1, 4, v3
    s_and_b32 s44, s2, 7
    s_mul_i32 s49, s45, 37
    s_lshr_b32 s49, s49, 8
    s_cmp_ge_u32 s45, 28
    s_cbranch_scc1 L_helper0
    v_mov_b32 v5, 2130706432
    v_cmp_gt_u32 vcc, 56, v3
    s_lshl2_add_u32 s55, s44, s49
    s_lshl2_add_u32 s55, s55, s46
    s_mul_i32 s55, s55, 14336
    v_cndmask_b32 v5, v5, v1, vcc
    s_mul_i32 s53, s49, 7
    s_sub_u32 s50, s45, s53
    s_lshl_b32 s53, s50, 7
    v_mul_u32_u24 v4, 896, v3
    s_add_u32 s53, s53, s55
    s_waitcnt lgkmcnt(0)
    s_mov_b64 s[4:5], s[64:65]
    s_mov_b32 s6, 0x1c0000
    s_mov_b32 s7, 0x20000
    s_mov_b64 exec, 0xffff
    buffer_load_dword a255, v4, s[4:7], s53 offen
    s_mov_b64 exec, -1
    buffer_load_dwordx4 v[160:163], v5, s[4:7], s55 offen offset:0
    buffer_load_dwordx4 v[164:167], v5, s[4:7], s55 offen offset:896
    buffer_load_dwordx4 v[168:171], v5, s[4:7], s55 offen offset:1792
    buffer_load_dwordx4 v[172:175], v5, s[4:7], s55 offen offset:2688
    s_mov_b64 s[36:37], s[80:81]
    s_mov_b32 s38, 0x24c000
    s_mov_b32 s39, 0x20000
    s_mov_b64 s[8:9], s[66:67]
    s_mov_b32 s10, 0x126000
    s_mov_b32 s11, 0x20000
    s_mov_b64 s[32:33], s[86:87]
    s_mov_b32 s34, 0x1200000
    s_mov_b32 s35, 0x20000
    s_lshl2_add_u32 s3, s2, s46
    v_lshlrev_b32 v4, 7, v3
    s_lshr_b32 s56, s3, 1
    s_and_b32 s54, s3, 1
    s_mul_i32 s54, s54, 896
    s_mul_i32 s53, s56, 5376
    s_add_u32 s53, s53, s54
    s_mul_i32 s56, s56, 2688
    s_add_u32 s54, s54, s56
    s_and_b32 s56, s3, 511
    s_lshl_b32 s56, s56, 7
    s_mov_b64 exec, 0x7f
    buffer_load_dword a255, v4, s[36:39], s53 offen
    buffer_load_dword a255, v4, s[8:11], s54 offen offset:896
    s_mov_b64 exec, 1
    buffer_load_dword a255, v4, s[32:35], s56 offen
    s_mov_b64 exec, -1
    s_add_u32 s55, s55, 3584
    buffer_load_dwordx4 v[176:179], v5, s[4:7], s55 offen offset:0
    buffer_load_dwordx4 v[180:183], v5, s[4:7], s55 offen offset:896
    buffer_load_dwordx4 v[184:187], v5, s[4:7], s55 offen offset:1792
    buffer_load_dwordx4 v[188:191], v5, s[4:7], s55 offen offset:2688
    s_branch L_front
L_helper0:
    v_min_u32 v8, 223, v0
    v_lshlrev_b32 v8, 2, v8
    s_lshl_b32 s57, s44, 2
    s_add_u32 s57, s57, s45
    s_sub_u32 s57, s57, 28
    v_lshrrev_b32 v10, 2, v3
    v_mul_u32_u24 v10, 5376, v10
    v_and_b32 v11, 48, v1
    v_add_u32 v5, v10, v11
    s_mul_i32 s53, s46, 86016
    s_lshl_b32 s54, s57, 6
    s_add_u32 s53, s53, s54
    s_cmp_lt_u32 s57, 28
    s_cselect_b32 s53, s53, 2130706432
    s_lshl_b32 s58, s46, 10
    s_mov_b32 s55, s58
    s_add_u32 s56, s55, 28672
    s_waitcnt lgkmcnt(0)
    s_mov_b64 s[40:41], s[78:79]
    s_mov_b32 s42, 0x380
    s_mov_b32 s43, 0x20000
    s_mov_b64 s[36:37], s[80:81]
    s_mov_b32 s38, 0x24c000
    s_mov_b32 s39, 0x20000
    buffer_load_dword v9, v8, s[40:43], 0 offen
L_mdma:
    s_mov_b32 m0, s55
    s_add_u32 s55, s55, 4096
    buffer_load_dwordx4 v5, s[36:39], s53 offen lds
    s_add_u32 s53, s53, 344064
    s_cmp_lg_u32 s55, s56
    s_cbranch_scc1 L_mdma
    s_branch L_helper
L_front:
    s_mov_b64 s[12:13], s[68:69]
    s_mov_b32 s14, 0x62000
    s_mov_b32 s15, 0x20000
    s_mov_b64 s[16:17], s[72:73]
    s_mov_b32 s18, 0x188000
    s_mov_b32 s19, 0x20000
    s_mov_b64 s[20:21], s[74:75]
    s_mov_b32 s22, 0x188000
    s_mov_b32 s23, 0x20000
    s_mov_b64 s[24:25], s[76:77]
    s_mov_b32 s26, 0x188000
    s_mov_b32 s27, 0x20000
    s_mov_b64 s[28:29], s[82:83]
    s_mov_b32 s30, 0x1c0000
    s_mov_b32 s31, 0x20000
    s_load_dword s47, s[32:33], 0
    s_getreg_b32 s51, hwreg(HW_REG_XCC_ID, 0, 4)
    s_add_u32 s48, s44, 1
    s_lshl_b32 s48, s48, 21
    s_mul_i32 s53, s49, 7
    s_sub_u32 s50, s45, s53
    s_lshr_b32 s61, s46, 1
    s_and_b32 s62, s46, 1
    s_lshl1_add_u32 s63, s49, s61
    v_lshrrev_b32 v8, 7, v1
    v_mul_u32_u24 v6, 2688, v8
    v_and_b32 v8, 2, v8
    v_lshlrev_b32 v8, 5, v8
    v_and_b32 v9, 0x70, v1
    v_xor_b32 v8, v8, v9
    v_add_u32 v6, v6, v8
    s_mul_i32 s53, s46, 21504
    s_lshl_b32 s54, s50, 7
    s_add_u32 s57, s53, s54
    s_lshl_b32 s58, s46, 10
    v_lshrrev_b32 v8, 4, v1
    v_bfe_u32 v9, v8, 2, 2
    v_lshrrev_b32 v10, 5, v8
    v_lshl_add_u32 v10, v10, 3, v9
    v_lshlrev_b32 v2, 7, v10
    v_lshrrev_b32 v9, 1, v9
    v_lshlrev_b32 v9, 6, v9
    v_and_b32 v10, 1, v8
    v_lshlrev_b32 v10, 4, v10
    v_xor_b32 v9, v9, v10
    v_and_b32 v10, 2, v8
    v_lshlrev_b32 v10, 2, v10
    v_xor_b32 v9, v9, v10
    v_and_b32 v10, 16, v8
    v_lshlrev_b32 v10, 1, v10
    v_xor_b32 v9, v9, v10
    s_lshl_b32 s53, s62, 6
    v_xor_b32 v9, s53, v9
    v_add_u32 v2, v2, v9
    v_lshrrev_b32 v8, 4, v1
    v_bfe_u32 v9, v8, 2, 2
    v_lshrrev_b32 v10, 5, v8
    v_lshl_add_u32 v10, v10, 3, v9
    v_lshlrev_b32 v4, 7, v10
    v_lshrrev_b32 v9, 1, v9
    v_lshlrev_b32 v9, 6, v9
    v_and_b32 v10, 3, v8
    v_lshlrev_b32 v10, 3, v10
    v_xor_b32 v9, v9, v10
    v_and_b32 v10, 16, v8
    v_lshlrev_b32 v10, 1, v10
    v_xor_b32 v9, v9, v10
    s_lshl_b32 s53, s62, 6
    v_xor_b32 v9, s53, v9
    v_add_u32 v4, v4, v9
    v_add_u32 v3, 114688, v4
    v_add_u32 v2, 57344, v2
    v_lshrrev_b32 v24, 4, v1
    s_lshl_b32 s53, s49, 2
    s_add_u32 s53, s53, s46
    s_mul_i32 s53, s53, 28
    v_add_u32 v25, s53, v24
    v_mul_u32_u24 v26, 2688, v25
    v_mul_u32_u24 v25, 896, v25
    s_lshl_b32 s3, s50, 7
    s_mul_i32 s53, s63, 28672
    s_add_u32 s53, s53, s48
    s_lshl_b32 s54, s50, 1
    s_add_u32 s54, s54, s62
    s_lshl_b32 s54, s54, 11
    s_add_u32 s53, s53, s54
    v_lshl_add_u32 v27, v24, 7, s53
    s_lshl2_add_u32 s54, s2, s46
    s_lshr_b32 s53, s54, 1
    s_and_b32 s54, s54, 1
    s_mul_i32 s54, s54, 384
    v_lshl_add_u32 v28, v24, 7, s54
    s_mul_i32 s54, s53, 2688
    v_add_u32 v29, s54, v28
    s_mul_i32 s54, s53, 896
    v_add_u32 v28, s54, v28
    s_mul_i32 s53, s61, 28672
    s_lshl_b32 s54, s62, 8
    s_add_u32 s54, s54, s53
    v_lshlrev_b32 v16, 5, v1
    v_and_b32 v12, 0x70, v1
    v_add3_u32 v16, v16, v12, s54
    v_cmp_gt_u32 vcc, 896, v1
    v_mov_b32 v12, 0x100000
    s_nop 0
    v_cndmask_b32 v16, v12, v16, vcc
    v_xor_b32 v17, 16, v16
    v_xor_b32 v18, 32, v16
    v_xor_b32 v19, 48, v16
    v_xor_b32 v20, 64, v16
    v_xor_b32 v21, 80, v16
    v_xor_b32 v22, 96, v16
    v_xor_b32 v23, 112, v16
    v_lshrrev_b32 v12, 9, v1
    v_lshlrev_b32 v12, 4, v12
    v_xor_b32 v12, v12, v1
    v_add_u32 v8, s53, v12
    v_xor_b32 v9, 32, v8
    v_xor_b32 v10, 64, v8
    v_xor_b32 v11, 96, v8
    v_min_u32 v30, 880, v1
    v_lshlrev_b32 v30, 1, v30
    v_and_b32 v31, 0x1f0, v1
    v_lshrrev_b32 v31, 1, v31
    s_lshl_b32 s59, s44, 8
    s_mov_b32 s36, 0xffff0000
    s_mov_b32 s37, 0x3f803f80
    s_waitcnt vmcnt(10)
    v_dot2_f32_bf16 v224, v160, s37, 0
    v_dot2_f32_bf16 v240, v160, v160, 0
    v_lshlrev_b32 v32, 16, v160
    v_and_b32 v33, s36, v160
    s_add_u32 s55, s55, 3584
    buffer_load_dwordx4 v[192:195], v5, s[4:7], s55 offen offset:0
    v_dot2_f32_bf16 v224, v161, s37, v224
    v_dot2_f32_bf16 v240, v161, v161, v240
    v_lshlrev_b32 v34, 16, v161
    v_and_b32 v35, s36, v161
    v_dot2_f32_bf16 v224, v162, s37, v224
    v_dot2_f32_bf16 v240, v162, v162, v240
    v_lshlrev_b32 v36, 16, v162
    v_and_b32 v37, s36, v162
    buffer_load_dwordx4 v[196:199], v5, s[4:7], s55 offen offset:896
    v_dot2_f32_bf16 v224, v163, s37, v224
    v_dot2_f32_bf16 v240, v163, v163, v240
    v_lshlrev_b32 v38, 16, v163
    v_and_b32 v39, s36, v163
    s_waitcnt vmcnt(11)
    v_dot2_f32_bf16 v225, v164, s37, 0
    v_dot2_f32_bf16 v241, v164, v164, 0
    v_lshlrev_b32 v40, 16, v164
    v_and_b32 v41, s36, v164
    buffer_load_dwordx4 v[200:203], v5, s[4:7], s55 offen offset:1792
    v_dot2_f32_bf16 v225, v165, s37, v225
    v_dot2_f32_bf16 v241, v165, v165, v241
    v_lshlrev_b32 v42, 16, v165
    v_and_b32 v43, s36, v165
    v_dot2_f32_bf16 v225, v166, s37, v225
    v_dot2_f32_bf16 v241, v166, v166, v241
    v_lshlrev_b32 v44, 16, v166
    v_and_b32 v45, s36, v166
    buffer_load_dwordx4 v[204:207], v5, s[4:7], s55 offen offset:2688
    v_dot2_f32_bf16 v225, v167, s37, v225
    v_dot2_f32_bf16 v241, v167, v167, v241
    v_lshlrev_b32 v46, 16, v167
    v_and_b32 v47, s36, v167
    s_waitcnt vmcnt(12)
    v_dot2_f32_bf16 v226, v168, s37, 0
    v_dot2_f32_bf16 v242, v168, v168, 0
    v_lshlrev_b32 v48, 16, v168
    v_and_b32 v49, s36, v168
    s_add_u32 s55, s55, 3584
    buffer_load_dwordx4 v[208:211], v5, s[4:7], s55 offen offset:0
    v_dot2_f32_bf16 v226, v169, s37, v226
    v_dot2_f32_bf16 v242, v169, v169, v242
    v_lshlrev_b32 v50, 16, v169
    v_and_b32 v51, s36, v169
    v_dot2_f32_bf16 v226, v170, s37, v226
    v_dot2_f32_bf16 v242, v170, v170, v242
    v_lshlrev_b32 v52, 16, v170
    v_and_b32 v53, s36, v170
    buffer_load_dwordx4 v[212:215], v5, s[4:7], s55 offen offset:896
    v_dot2_f32_bf16 v226, v171, s37, v226
    v_dot2_f32_bf16 v242, v171, v171, v242
    v_lshlrev_b32 v54, 16, v171
    v_and_b32 v55, s36, v171
    s_waitcnt vmcnt(13)
    v_dot2_f32_bf16 v227, v172, s37, 0
    v_dot2_f32_bf16 v243, v172, v172, 0
    v_lshlrev_b32 v56, 16, v172
    v_and_b32 v57, s36, v172
    buffer_load_dwordx4 v[216:219], v5, s[4:7], s55 offen offset:1792
    v_dot2_f32_bf16 v227, v173, s37, v227
    v_dot2_f32_bf16 v243, v173, v173, v243
    v_lshlrev_b32 v58, 16, v173
    v_and_b32 v59, s36, v173
    v_dot2_f32_bf16 v227, v174, s37, v227
    v_dot2_f32_bf16 v243, v174, v174, v243
    v_lshlrev_b32 v60, 16, v174
    v_and_b32 v61, s36, v174
    buffer_load_dwordx4 v[220:223], v5, s[4:7], s55 offen offset:2688
    v_dot2_f32_bf16 v227, v175, s37, v227
    v_dot2_f32_bf16 v243, v175, v175, v243
    v_lshlrev_b32 v62, 16, v175
    v_and_b32 v63, s36, v175
    s_waitcnt vmcnt(11)
    v_dot2_f32_bf16 v228, v176, s37, 0
    v_dot2_f32_bf16 v244, v176, v176, 0
    v_lshlrev_b32 v64, 16, v176
    v_and_b32 v65, s36, v176
    s_add_u32 m0, s58, 0
    s_add_u32 s60, s57, 1033984
    buffer_load_dwordx4 v6, s[8:11], s60 offen lds
    v_dot2_f32_bf16 v228, v177, s37, v228
    v_dot2_f32_bf16 v244, v177, v177, v244
    v_lshlrev_b32 v66, 16, v177
    v_and_b32 v67, s36, v177
    v_dot2_f32_bf16 v228, v178, s37, v228
    v_dot2_f32_bf16 v244, v178, v178, v244
    v_lshlrev_b32 v68, 16, v178
    v_and_b32 v69, s36, v178
    s_add_u32 m0, s58, 4096
    s_add_u32 s60, s57, 1120000
    buffer_load_dwordx4 v6, s[8:11], s60 offen lds
    v_dot2_f32_bf16 v228, v179, s37, v228
    v_dot2_f32_bf16 v244, v179, v179, v244
    v_lshlrev_b32 v70, 16, v179
    v_and_b32 v71, s36, v179
    s_waitcnt vmcnt(12)
    v_dot2_f32_bf16 v229, v180, s37, 0
    v_dot2_f32_bf16 v245, v180, v180, 0
    v_lshlrev_b32 v72, 16, v180
    v_and_b32 v73, s36, v180
    s_add_u32 m0, s58, 57344
    s_add_u32 s60, s57, 896
    buffer_load_dwordx4 v6, s[8:11], s60 offen lds
    v_dot2_f32_bf16 v229, v181, s37, v229
    v_dot2_f32_bf16 v245, v181, v181, v245
    v_lshlrev_b32 v74, 16, v181
    v_and_b32 v75, s36, v181
    v_dot2_f32_bf16 v229, v182, s37, v229
    v_dot2_f32_bf16 v245, v182, v182, v245
    v_lshlrev_b32 v76, 16, v182
    v_and_b32 v77, s36, v182
    s_add_u32 m0, s58, 114688
    s_add_u32 s60, s57, 1792
    buffer_load_dwordx4 v6, s[8:11], s60 offen lds
    v_dot2_f32_bf16 v229, v183, s37, v229
    v_dot2_f32_bf16 v245, v183, v183, v245
    v_lshlrev_b32 v78, 16, v183
    v_and_b32 v79, s36, v183
    s_waitcnt vmcnt(13)
    s_waitcnt lgkmcnt(0)
    s_mul_i32 s47, s47, 1664525
    s_add_u32 s47, s47, 1013904223
    s_lshl_b32 s53, s44, 8
    s_lshl_b32 s54, s45, 3
    s_add_u32 s53, s53, s54
    v_mov_b32 v12, s51
    v_mov_b32 v13, s47
    v_mov_b32 v14, 1024
    s_cmp_eq_u32 s46, 0
    s_cselect_b64 exec, 1, 0
    buffer_store_dwordx2 v[12:13], v14, s[32:35], s53 offen sc1
    s_mov_b64 exec, -1
    v_dot2_f32_bf16 v230, v184, s37, 0
    v_dot2_f32_bf16 v246, v184, v184, 0
    v_lshlrev_b32 v80, 16, v184
    v_and_b32 v81, s36, v184
    s_add_u32 m0, s58, 61440
    s_add_u32 s60, s57, 86912
    buffer_load_dwordx4 v6, s[8:11], s60 offen lds
    v_dot2_f32_bf16 v230, v185, s37, v230
    v_dot2_f32_bf16 v246, v185, v185, v246
    v_lshlrev_b32 v82, 16, v185
    v_and_b32 v83, s36, v185
    v_dot2_f32_bf16 v230, v186, s37, v230
    v_dot2_f32_bf16 v246, v186, v186, v246
    v_lshlrev_b32 v84, 16, v186
    v_and_b32 v85, s36, v186
    v_dot2_f32_bf16 v230, v187, s37, v230
    v_dot2_f32_bf16 v246, v187, v187, v246
    v_lshlrev_b32 v86, 16, v187
    v_and_b32 v87, s36, v187
    s_waitcnt vmcnt(14)
    v_dot2_f32_bf16 v231, v188, s37, 0
    v_dot2_f32_bf16 v247, v188, v188, 0
    v_lshlrev_b32 v88, 16, v188
    v_and_b32 v89, s36, v188
    s_add_u32 m0, s58, 118784
    s_add_u32 s60, s57, 87808
    buffer_load_dwordx4 v6, s[8:11], s60 offen lds
    v_dot2_f32_bf16 v231, v189, s37, v231
    v_dot2_f32_bf16 v247, v189, v189, v247
    v_lshlrev_b32 v90, 16, v189
    v_and_b32 v91, s36, v189
    v_dot2_f32_bf16 v231, v190, s37, v231
    v_dot2_f32_bf16 v247, v190, v190, v247
    v_lshlrev_b32 v92, 16, v190
    v_and_b32 v93, s36, v190
    v_dot2_f32_bf16 v231, v191, s37, v231
    v_dot2_f32_bf16 v247, v191, v191, v247
    v_lshlrev_b32 v94, 16, v191
    v_and_b32 v95, s36, v191
    s_waitcnt vmcnt(14)
    v_dot2_f32_bf16 v232, v192, s37, 0
    v_dot2_f32_bf16 v248, v192, v192, 0
    v_lshlrev_b32 v96, 16, v192
    v_and_b32 v97, s36, v192
    s_add_u32 m0, s58, 65536
    s_add_u32 s60, s57, 172928
    buffer_load_dwordx4 v6, s[8:11], s60 offen lds
    v_dot2_f32_bf16 v232, v193, s37, v232
    v_dot2_f32_bf16 v248, v193, v193, v248
    v_lshlrev_b32 v98, 16, v193
    v_and_b32 v99, s36, v193
    v_dot2_f32_bf16 v232, v194, s37, v232
    v_dot2_f32_bf16 v248, v194, v194, v248
    v_lshlrev_b32 v100, 16, v194
    v_and_b32 v101, s36, v194
    v_dot2_f32_bf16 v232, v195, s37, v232
    v_dot2_f32_bf16 v248, v195, v195, v248
    v_lshlrev_b32 v102, 16, v195
    v_and_b32 v103, s36, v195
    s_waitcnt vmcnt(14)
    s_mov_b64 exec, 15
    buffer_load_dword a255, v29, s[8:11], 0 offen
    buffer_load_dword a255, v28, s[12:15], 0 offen
    s_mov_b64 exec, -1
    v_dot2_f32_bf16 v233, v196, s37, 0
    v_dot2_f32_bf16 v249, v196, v196, 0
    v_lshlrev_b32 v104, 16, v196
    v_and_b32 v105, s36, v196
    s_add_u32 m0, s58, 122880
    s_add_u32 s60, s57, 173824
    buffer_load_dwordx4 v6, s[8:11], s60 offen lds
    v_dot2_f32_bf16 v233, v197, s37, v233
    v_dot2_f32_bf16 v249, v197, v197, v249
    v_lshlrev_b32 v106, 16, v197
    v_and_b32 v107, s36, v197
    v_dot2_f32_bf16 v233, v198, s37, v233
    v_dot2_f32_bf16 v249, v198, v198, v249
    v_lshlrev_b32 v108, 16, v198
    v_and_b32 v109, s36, v198
    v_dot2_f32_bf16 v233, v199, s37, v233
    v_dot2_f32_bf16 v249, v199, v199, v249
    v_lshlrev_b32 v110, 16, v199
    v_and_b32 v111, s36, v199
    s_waitcnt vmcnt(16)
    v_dot2_f32_bf16 v234, v200, s37, 0
    v_dot2_f32_bf16 v250, v200, v200, 0
    v_lshlrev_b32 v112, 16, v200
    v_and_b32 v113, s36, v200
    s_add_u32 m0, s58, 69632
    s_add_u32 s60, s57, 258944
    buffer_load_dwordx4 v6, s[8:11], s60 offen lds
    v_dot2_f32_bf16 v234, v201, s37, v234
    v_dot2_f32_bf16 v250, v201, v201, v250
    v_lshlrev_b32 v114, 16, v201
    v_and_b32 v115, s36, v201
    v_dot2_f32_bf16 v234, v202, s37, v234
    v_dot2_f32_bf16 v250, v202, v202, v250
    v_lshlrev_b32 v116, 16, v202
    v_and_b32 v117, s36, v202
    v_dot2_f32_bf16 v234, v203, s37, v234
    v_dot2_f32_bf16 v250, v203, v203, v250
    v_lshlrev_b32 v118, 16, v203
    v_and_b32 v119, s36, v203
    s_waitcnt vmcnt(16)
    v_dot2_f32_bf16 v235, v204, s37, 0
    v_dot2_f32_bf16 v251, v204, v204, 0
    v_lshlrev_b32 v120, 16, v204
    v_and_b32 v121, s36, v204
    s_add_u32 m0, s58, 126976
    s_add_u32 s60, s57, 259840
    buffer_load_dwordx4 v6, s[8:11], s60 offen lds
    v_dot2_f32_bf16 v235, v205, s37, v235
    v_dot2_f32_bf16 v251, v205, v205, v251
    v_lshlrev_b32 v122, 16, v205
    v_and_b32 v123, s36, v205
    v_dot2_f32_bf16 v235, v206, s37, v235
    v_dot2_f32_bf16 v251, v206, v206, v251
    v_lshlrev_b32 v124, 16, v206
    v_and_b32 v125, s36, v206
    v_dot2_f32_bf16 v235, v207, s37, v235
    v_dot2_f32_bf16 v251, v207, v207, v251
    v_lshlrev_b32 v126, 16, v207
    v_and_b32 v127, s36, v207
    s_waitcnt vmcnt(16)
    v_dot2_f32_bf16 v236, v208, s37, 0
    v_dot2_f32_bf16 v252, v208, v208, 0
    v_lshlrev_b32 v128, 16, v208
    v_and_b32 v129, s36, v208
    s_add_u32 m0, s58, 73728
    s_add_u32 s60, s57, 344960
    buffer_load_dwordx4 v6, s[8:11], s60 offen lds
    v_dot2_f32_bf16 v236, v209, s37, v236
    v_dot2_f32_bf16 v252, v209, v209, v252
    v_lshlrev_b32 v130, 16, v209
    v_and_b32 v131, s36, v209
    v_dot2_f32_bf16 v236, v210, s37, v236
    v_dot2_f32_bf16 v252, v210, v210, v252
    v_lshlrev_b32 v132, 16, v210
    v_and_b32 v133, s36, v210
    v_dot2_f32_bf16 v236, v211, s37, v236
    v_dot2_f32_bf16 v252, v211, v211, v252
    v_lshlrev_b32 v134, 16, v211
    v_and_b32 v135, s36, v211
    s_waitcnt vmcnt(16)
    v_dot2_f32_bf16 v237, v212, s37, 0
    v_dot2_f32_bf16 v253, v212, v212, 0
    v_lshlrev_b32 v136, 16, v212
    v_and_b32 v137, s36, v212
    s_add_u32 m0, s58, 131072
    s_add_u32 s60, s57, 345856
    buffer_load_dwordx4 v6, s[8:11], s60 offen lds
    v_dot2_f32_bf16 v237, v213, s37, v237
    v_dot2_f32_bf16 v253, v213, v213, v253
    v_lshlrev_b32 v138, 16, v213
    v_and_b32 v139, s36, v213
    v_dot2_f32_bf16 v237, v214, s37, v237
    v_dot2_f32_bf16 v253, v214, v214, v253
    v_lshlrev_b32 v140, 16, v214
    v_and_b32 v141, s36, v214
    v_dot2_f32_bf16 v237, v215, s37, v237
    v_dot2_f32_bf16 v253, v215, v215, v253
    v_lshlrev_b32 v142, 16, v215
    v_and_b32 v143, s36, v215
    s_waitcnt vmcnt(16)
    v_dot2_f32_bf16 v238, v216, s37, 0
    v_dot2_f32_bf16 v254, v216, v216, 0
    v_lshlrev_b32 v144, 16, v216
    v_and_b32 v145, s36, v216
    s_add_u32 m0, s58, 77824
    s_add_u32 s60, s57, 430976
    buffer_load_dwordx4 v6, s[8:11], s60 offen lds
    v_dot2_f32_bf16 v238, v217, s37, v238
    v_dot2_f32_bf16 v254, v217, v217, v254
    v_lshlrev_b32 v146, 16, v217
    v_and_b32 v147, s36, v217
    v_dot2_f32_bf16 v238, v218, s37, v238
    v_dot2_f32_bf16 v254, v218, v218, v254
    v_lshlrev_b32 v148, 16, v218
    v_and_b32 v149, s36, v218
    v_dot2_f32_bf16 v238, v219, s37, v238
    v_dot2_f32_bf16 v254, v219, v219, v254
    v_lshlrev_b32 v150, 16, v219
    v_and_b32 v151, s36, v219
    s_waitcnt vmcnt(16)
    v_dot2_f32_bf16 v239, v220, s37, 0
    v_dot2_f32_bf16 v255, v220, v220, 0
    v_lshlrev_b32 v152, 16, v220
    v_and_b32 v153, s36, v220
    s_add_u32 m0, s58, 135168
    s_add_u32 s60, s57, 431872
    buffer_load_dwordx4 v6, s[8:11], s60 offen lds
    v_dot2_f32_bf16 v239, v221, s37, v239
    v_dot2_f32_bf16 v255, v221, v221, v255
    v_lshlrev_b32 v154, 16, v221
    v_and_b32 v155, s36, v221
    v_dot2_f32_bf16 v239, v222, s37, v239
    v_dot2_f32_bf16 v255, v222, v222, v255
    v_lshlrev_b32 v156, 16, v222
    v_and_b32 v157, s36, v222
    v_dot2_f32_bf16 v239, v223, s37, v239
    v_dot2_f32_bf16 v255, v223, v223, v255
    v_lshlrev_b32 v158, 16, v223
    v_and_b32 v159, s36, v223
    v_permlane32_swap_b32 v224, v240
    v_permlane32_swap_b32 v225, v241
    v_permlane32_swap_b32 v226, v242
    v_permlane32_swap_b32 v227, v243
    v_permlane32_swap_b32 v228, v244
    v_permlane32_swap_b32 v229, v245
    v_permlane32_swap_b32 v230, v246
    v_permlane32_swap_b32 v231, v247
    v_permlane32_swap_b32 v232, v248
    v_permlane32_swap_b32 v233, v249
    v_permlane32_swap_b32 v234, v250
    v_permlane32_swap_b32 v235, v251
    v_permlane32_swap_b32 v236, v252
    v_permlane32_swap_b32 v237, v253
    v_permlane32_swap_b32 v238, v254
    v_permlane32_swap_b32 v239, v255
    s_add_u32 m0, s58, 81920
    s_add_u32 s60, s57, 516992
    buffer_load_dwordx4 v6, s[8:11], s60 offen lds
    v_add_f32 v224, v224, v240
    v_add_f32 v225, v225, v241
    v_add_f32 v226, v226, v242
    v_add_f32 v227, v227, v243
    v_add_f32 v228, v228, v244
    v_add_f32 v229, v229, v245
    v_add_f32 v230, v230, v246
    v_add_f32 v231, v231, v247
    v_add_f32 v232, v232, v248
    v_add_f32 v233, v233, v249
    v_add_f32 v234, v234, v250
    v_add_f32 v235, v235, v251
    v_add_f32 v236, v236, v252
    v_add_f32 v237, v237, v253
    v_add_f32 v238, v238, v254
    v_add_f32 v239, v239, v255
    s_add_u32 m0, s58, 139264
    s_add_u32 s60, s57, 517888
    buffer_load_dwordx4 v6, s[8:11], s60 offen lds
    v_permlane16_swap_b32 v224, v232
    v_permlane16_swap_b32 v225, v233
    v_permlane16_swap_b32 v226, v234
    v_permlane16_swap_b32 v227, v235
    v_permlane16_swap_b32 v228, v236
    v_permlane16_swap_b32 v229, v237
    v_permlane16_swap_b32 v230, v238
    v_permlane16_swap_b32 v231, v239
    v_add_f32 v224, v224, v232
    v_add_f32 v225, v225, v233
    v_add_f32 v226, v226, v234
    v_add_f32 v227, v227, v235
    v_add_f32 v228, v228, v236
    v_add_f32 v229, v229, v237
    v_add_f32 v230, v230, v238
    v_add_f32 v231, v231, v239
    s_add_u32 m0, s58, 86016
    s_add_u32 s60, s57, 603008
    buffer_load_dwordx4 v6, s[8:11], s60 offen lds
    v_add_f32_dpp v224, v224, v224 row_ror:8 row_mask:0xf bank_mask:0xf
    v_add_f32_dpp v225, v225, v225 row_ror:8 row_mask:0xf bank_mask:0xf
    v_add_f32_dpp v226, v226, v226 row_ror:8 row_mask:0xf bank_mask:0xf
    v_add_f32_dpp v227, v227, v227 row_ror:8 row_mask:0xf bank_mask:0xf
    v_add_f32_dpp v228, v228, v228 row_ror:8 row_mask:0xf bank_mask:0xf
    v_add_f32_dpp v229, v229, v229 row_ror:8 row_mask:0xf bank_mask:0xf
    v_add_f32_dpp v230, v230, v230 row_ror:8 row_mask:0xf bank_mask:0xf
    v_add_f32_dpp v231, v231, v231 row_ror:8 row_mask:0xf bank_mask:0xf
    v_add_f32_dpp v224, v224, v224 row_ror:4 row_mask:0xf bank_mask:0xf
    v_add_f32_dpp v225, v225, v225 row_ror:4 row_mask:0xf bank_mask:0xf
    v_add_f32_dpp v226, v226, v226 row_ror:4 row_mask:0xf bank_mask:0xf
    v_add_f32_dpp v227, v227, v227 row_ror:4 row_mask:0xf bank_mask:0xf
    v_add_f32_dpp v228, v228, v228 row_ror:4 row_mask:0xf bank_mask:0xf
    v_add_f32_dpp v229, v229, v229 row_ror:4 row_mask:0xf bank_mask:0xf
    v_add_f32_dpp v230, v230, v230 row_ror:4 row_mask:0xf bank_mask:0xf
    v_add_f32_dpp v231, v231, v231 row_ror:4 row_mask:0xf bank_mask:0xf
    s_add_u32 m0, s58, 143360
    s_add_u32 s60, s57, 603904
    buffer_load_dwordx4 v6, s[8:11], s60 offen lds
    v_add_f32_dpp v224, v224, v224 row_ror:2 row_mask:0xf bank_mask:0xf
    v_add_f32_dpp v225, v225, v225 row_ror:2 row_mask:0xf bank_mask:0xf
    v_add_f32_dpp v226, v226, v226 row_ror:2 row_mask:0xf bank_mask:0xf
    v_add_f32_dpp v227, v227, v227 row_ror:2 row_mask:0xf bank_mask:0xf
    v_add_f32_dpp v228, v228, v228 row_ror:2 row_mask:0xf bank_mask:0xf
    v_add_f32_dpp v229, v229, v229 row_ror:2 row_mask:0xf bank_mask:0xf
    v_add_f32_dpp v230, v230, v230 row_ror:2 row_mask:0xf bank_mask:0xf
    v_add_f32_dpp v231, v231, v231 row_ror:2 row_mask:0xf bank_mask:0xf
    v_add_f32_dpp v224, v224, v224 row_ror:1 row_mask:0xf bank_mask:0xf
    v_add_f32_dpp v225, v225, v225 row_ror:1 row_mask:0xf bank_mask:0xf
    v_add_f32_dpp v226, v226, v226 row_ror:1 row_mask:0xf bank_mask:0xf
    v_add_f32_dpp v227, v227, v227 row_ror:1 row_mask:0xf bank_mask:0xf
    v_add_f32_dpp v228, v228, v228 row_ror:1 row_mask:0xf bank_mask:0xf
    v_add_f32_dpp v229, v229, v229 row_ror:1 row_mask:0xf bank_mask:0xf
    v_add_f32_dpp v230, v230, v230 row_ror:1 row_mask:0xf bank_mask:0xf
    v_add_f32_dpp v231, v231, v231 row_ror:1 row_mask:0xf bank_mask:0xf
    s_add_u32 m0, s58, 90112
    s_add_u32 s60, s57, 689024
    buffer_load_dwordx4 v6, s[8:11], s60 offen lds
    s_mov_b32 s98, 0x02020202
    s_mov_b32 s99, s98
    v_cndmask_b32 v224, v224, v225, s[98:99]
    s_lshl_b64 s[98:99], s[98:99], 1
    v_cndmask_b32 v224, v224, v226, s[98:99]
    s_lshl_b64 s[98:99], s[98:99], 1
    v_cndmask_b32 v224, v224, v227, s[98:99]
    s_lshl_b64 s[98:99], s[98:99], 1
    v_cndmask_b32 v224, v224, v228, s[98:99]
    s_lshl_b64 s[98:99], s[98:99], 1
    v_cndmask_b32 v224, v224, v229, s[98:99]
    s_lshl_b64 s[98:99], s[98:99], 1
    v_cndmask_b32 v224, v224, v230, s[98:99]
    s_lshl_b64 s[98:99], s[98:99], 1
    v_cndmask_b32 v224, v224, v231, s[98:99]
    s_lshl_b64 s[98:99], s[98:99], 1
    s_add_u32 m0, s58, 147456
    s_add_u32 s60, s57, 689920
    buffer_load_dwordx4 v6, s[8:11], s60 offen lds
    v_mov_b32 v12, v224
    s_nop 1
    v_permlane32_swap_b32 v12, v224
    v_mul_f32 v12, 0x3b124925, v12
    v_mul_f32 v13, 0x3b124925, v224
    v_fma_f32 v13, -v12, v12, v13
    v_max_f32 v13, 0, v13
    v_add_f32 v13, 0x3727c5ac, v13
    v_rsq_f32 v13, v13
    s_nop 0
    v_mul_f32 v12, v12, v13
    v_sub_f32 v12, 0, v12
    s_add_u32 m0, s58, 94208
    s_add_u32 s60, s57, 775040
    buffer_load_dwordx4 v6, s[8:11], s60 offen lds
    v_readlane_b32 s64, v13, 0
    v_readlane_b32 s65, v12, 0
    v_readlane_b32 s66, v13, 1
    v_readlane_b32 s67, v12, 1
    v_readlane_b32 s68, v13, 2
    v_readlane_b32 s69, v12, 2
    v_readlane_b32 s70, v13, 3
    v_readlane_b32 s71, v12, 3
    v_readlane_b32 s72, v13, 4
    v_readlane_b32 s73, v12, 4
    v_readlane_b32 s74, v13, 5
    v_readlane_b32 s75, v12, 5
    v_readlane_b32 s76, v13, 6
    v_readlane_b32 s77, v12, 6
    v_readlane_b32 s78, v13, 7
    v_readlane_b32 s79, v12, 7
    s_add_u32 m0, s58, 151552
    s_add_u32 s60, s57, 775936
    buffer_load_dwordx4 v6, s[8:11], s60 offen lds
    v_readlane_b32 s80, v13, 16
    v_readlane_b32 s81, v12, 16
    v_readlane_b32 s82, v13, 17
    v_readlane_b32 s83, v12, 17
    v_readlane_b32 s84, v13, 18
    v_readlane_b32 s85, v12, 18
    v_readlane_b32 s86, v13, 19
    v_readlane_b32 s87, v12, 19
    v_readlane_b32 s88, v13, 20
    v_readlane_b32 s89, v12, 20
    v_readlane_b32 s90, v13, 21
    v_readlane_b32 s91, v12, 21
    v_readlane_b32 s92, v13, 22
    v_readlane_b32 s93, v12, 22
    v_readlane_b32 s94, v13, 23
    v_readlane_b32 s95, v12, 23
    s_add_u32 m0, s58, 98304
    s_add_u32 s60, s57, 861056
    buffer_load_dwordx4 v6, s[8:11], s60 offen lds
    s_mov_b32 s53, 4096
    s_add_u32 m0, s58, 155648
    s_add_u32 s60, s57, 861952
    buffer_load_dwordx4 v6, s[8:11], s60 offen lds
    s_add_u32 m0, s58, 102400
    s_add_u32 s60, s57, 947072
    buffer_load_dwordx4 v6, s[8:11], s60 offen lds
    s_add_u32 m0, s58, 159744
    s_add_u32 s60, s57, 947968
    buffer_load_dwordx4 v6, s[8:11], s60 offen lds
    s_add_u32 m0, s58, 106496
    s_add_u32 s60, s57, 1033088
    buffer_load_dwordx4 v6, s[8:11], s60 offen lds
    s_add_u32 m0, s58, 110592
    s_add_u32 s60, s57, 1119104
    buffer_load_dwordx4 v6, s[8:11], s60 offen lds
    s_waitcnt vmcnt(29)
    s_barrier
    ds_read_b64_tr_b16 a[0:1], v4 offset:0
    ds_read_b64_tr_b16 a[2:3], v4 offset:512
    ds_read_b64_tr_b16 a[4:5], v4 offset:2048
    ds_read_b64_tr_b16 a[6:7], v4 offset:2560
    ds_read_b64_tr_b16 a[8:9], v4 offset:4096
    ds_read_b64_tr_b16 a[10:11], v4 offset:4608
    ds_read_b64_tr_b16 a[12:13], v4 offset:6144
    ds_read_b64_tr_b16 a[14:15], v4 offset:6656
    buffer_load_dwordx4 v[160:163], v30, s[32:35], s53 offen offset:0 sc1
    buffer_load_dwordx4 v[164:167], v30, s[32:35], s53 offen offset:16 sc1
    buffer_load_dwordx4 v[168:171], v30, s[32:35], s53 offen offset:1792 sc1
    buffer_load_dwordx4 v[172:175], v30, s[32:35], s53 offen offset:1808 sc1
    buffer_load_dwordx2 v[14:15], v31, s[32:35], s59 offen offset:1024 sc1
    v_pk_fma_f32 v[32:33], v[32:33], s[64:65], s[64:65] op_sel:[0,0,1] op_sel_hi:[1,0,1]
    v_pk_fma_f32 v[34:35], v[34:35], s[64:65], s[64:65] op_sel:[0,0,1] op_sel_hi:[1,0,1]
    v_pk_fma_f32 v[36:37], v[36:37], s[64:65], s[64:65] op_sel:[0,0,1] op_sel_hi:[1,0,1]
    v_pk_fma_f32 v[38:39], v[38:39], s[64:65], s[64:65] op_sel:[0,0,1] op_sel_hi:[1,0,1]
    v_pk_fma_f32 v[40:41], v[40:41], s[66:67], s[66:67] op_sel:[0,0,1] op_sel_hi:[1,0,1]
    v_pk_fma_f32 v[42:43], v[42:43], s[66:67], s[66:67] op_sel:[0,0,1] op_sel_hi:[1,0,1]
    v_pk_fma_f32 v[44:45], v[44:45], s[66:67], s[66:67] op_sel:[0,0,1] op_sel_hi:[1,0,1]
    v_pk_fma_f32 v[46:47], v[46:47], s[66:67], s[66:67] op_sel:[0,0,1] op_sel_hi:[1,0,1]
    v_pk_fma_f32 v[48:49], v[48:49], s[68:69], s[68:69] op_sel:[0,0,1] op_sel_hi:[1,0,1]
    v_pk_fma_f32 v[50:51], v[50:51], s[68:69], s[68:69] op_sel:[0,0,1] op_sel_hi:[1,0,1]
    v_pk_fma_f32 v[52:53], v[52:53], s[68:69], s[68:69] op_sel:[0,0,1] op_sel_hi:[1,0,1]
    v_pk_fma_f32 v[54:55], v[54:55], s[68:69], s[68:69] op_sel:[0,0,1] op_sel_hi:[1,0,1]
    v_pk_fma_f32 v[56:57], v[56:57], s[70:71], s[70:71] op_sel:[0,0,1] op_sel_hi:[1,0,1]
    v_pk_fma_f32 v[58:59], v[58:59], s[70:71], s[70:71] op_sel:[0,0,1] op_sel_hi:[1,0,1]
    v_pk_fma_f32 v[60:61], v[60:61], s[70:71], s[70:71] op_sel:[0,0,1] op_sel_hi:[1,0,1]
    v_pk_fma_f32 v[62:63], v[62:63], s[70:71], s[70:71] op_sel:[0,0,1] op_sel_hi:[1,0,1]
    v_pk_fma_f32 v[64:65], v[64:65], s[72:73], s[72:73] op_sel:[0,0,1] op_sel_hi:[1,0,1]
    v_pk_fma_f32 v[66:67], v[66:67], s[72:73], s[72:73] op_sel:[0,0,1] op_sel_hi:[1,0,1]
    v_pk_fma_f32 v[68:69], v[68:69], s[72:73], s[72:73] op_sel:[0,0,1] op_sel_hi:[1,0,1]
    v_pk_fma_f32 v[70:71], v[70:71], s[72:73], s[72:73] op_sel:[0,0,1] op_sel_hi:[1,0,1]
    v_pk_fma_f32 v[72:73], v[72:73], s[74:75], s[74:75] op_sel:[0,0,1] op_sel_hi:[1,0,1]
    v_pk_fma_f32 v[74:75], v[74:75], s[74:75], s[74:75] op_sel:[0,0,1] op_sel_hi:[1,0,1]
    v_pk_fma_f32 v[76:77], v[76:77], s[74:75], s[74:75] op_sel:[0,0,1] op_sel_hi:[1,0,1]
    v_pk_fma_f32 v[78:79], v[78:79], s[74:75], s[74:75] op_sel:[0,0,1] op_sel_hi:[1,0,1]
    v_pk_fma_f32 v[80:81], v[80:81], s[76:77], s[76:77] op_sel:[0,0,1] op_sel_hi:[1,0,1]
    v_pk_fma_f32 v[82:83], v[82:83], s[76:77], s[76:77] op_sel:[0,0,1] op_sel_hi:[1,0,1]
    v_pk_fma_f32 v[84:85], v[84:85], s[76:77], s[76:77] op_sel:[0,0,1] op_sel_hi:[1,0,1]
    v_pk_fma_f32 v[86:87], v[86:87], s[76:77], s[76:77] op_sel:[0,0,1] op_sel_hi:[1,0,1]
    v_pk_fma_f32 v[88:89], v[88:89], s[78:79], s[78:79] op_sel:[0,0,1] op_sel_hi:[1,0,1]
    v_pk_fma_f32 v[90:91], v[90:91], s[78:79], s[78:79] op_sel:[0,0,1] op_sel_hi:[1,0,1]
    v_pk_fma_f32 v[92:93], v[92:93], s[78:79], s[78:79] op_sel:[0,0,1] op_sel_hi:[1,0,1]
    v_pk_fma_f32 v[94:95], v[94:95], s[78:79], s[78:79] op_sel:[0,0,1] op_sel_hi:[1,0,1]
    v_pk_fma_f32 v[96:97], v[96:97], s[80:81], s[80:81] op_sel:[0,0,1] op_sel_hi:[1,0,1]
    v_pk_fma_f32 v[98:99], v[98:99], s[80:81], s[80:81] op_sel:[0,0,1] op_sel_hi:[1,0,1]
    v_pk_fma_f32 v[100:101], v[100:101], s[80:81], s[80:81] op_sel:[0,0,1] op_sel_hi:[1,0,1]
    v_pk_fma_f32 v[102:103], v[102:103], s[80:81], s[80:81] op_sel:[0,0,1] op_sel_hi:[1,0,1]
    v_pk_fma_f32 v[104:105], v[104:105], s[82:83], s[82:83] op_sel:[0,0,1] op_sel_hi:[1,0,1]
    v_pk_fma_f32 v[106:107], v[106:107], s[82:83], s[82:83] op_sel:[0,0,1] op_sel_hi:[1,0,1]
    v_pk_fma_f32 v[108:109], v[108:109], s[82:83], s[82:83] op_sel:[0,0,1] op_sel_hi:[1,0,1]
    v_pk_fma_f32 v[110:111], v[110:111], s[82:83], s[82:83] op_sel:[0,0,1] op_sel_hi:[1,0,1]
    v_pk_fma_f32 v[112:113], v[112:113], s[84:85], s[84:85] op_sel:[0,0,1] op_sel_hi:[1,0,1]
    v_pk_fma_f32 v[114:115], v[114:115], s[84:85], s[84:85] op_sel:[0,0,1] op_sel_hi:[1,0,1]
    v_pk_fma_f32 v[116:117], v[116:117], s[84:85], s[84:85] op_sel:[0,0,1] op_sel_hi:[1,0,1]
    v_pk_fma_f32 v[118:119], v[118:119], s[84:85], s[84:85] op_sel:[0,0,1] op_sel_hi:[1,0,1]
    v_pk_fma_f32 v[120:121], v[120:121], s[86:87], s[86:87] op_sel:[0,0,1] op_sel_hi:[1,0,1]
    v_pk_fma_f32 v[122:123], v[122:123], s[86:87], s[86:87] op_sel:[0,0,1] op_sel_hi:[1,0,1]
    v_pk_fma_f32 v[124:125], v[124:125], s[86:87], s[86:87] op_sel:[0,0,1] op_sel_hi:[1,0,1]
    v_pk_fma_f32 v[126:127], v[126:127], s[86:87], s[86:87] op_sel:[0,0,1] op_sel_hi:[1,0,1]
    v_pk_fma_f32 v[128:129], v[128:129], s[88:89], s[88:89] op_sel:[0,0,1] op_sel_hi:[1,0,1]
    v_pk_fma_f32 v[130:131], v[130:131], s[88:89], s[88:89] op_sel:[0,0,1] op_sel_hi:[1,0,1]
    v_pk_fma_f32 v[132:133], v[132:133], s[88:89], s[88:89] op_sel:[0,0,1] op_sel_hi:[1,0,1]
    v_pk_fma_f32 v[134:135], v[134:135], s[88:89], s[88:89] op_sel:[0,0,1] op_sel_hi:[1,0,1]
    v_pk_fma_f32 v[136:137], v[136:137], s[90:91], s[90:91] op_sel:[0,0,1] op_sel_hi:[1,0,1]
    v_pk_fma_f32 v[138:139], v[138:139], s[90:91], s[90:91] op_sel:[0,0,1] op_sel_hi:[1,0,1]
    v_pk_fma_f32 v[140:141], v[140:141], s[90:91], s[90:91] op_sel:[0,0,1] op_sel_hi:[1,0,1]
    v_pk_fma_f32 v[142:143], v[142:143], s[90:91], s[90:91] op_sel:[0,0,1] op_sel_hi:[1,0,1]
    v_pk_fma_f32 v[144:145], v[144:145], s[92:93], s[92:93] op_sel:[0,0,1] op_sel_hi:[1,0,1]
    v_pk_fma_f32 v[146:147], v[146:147], s[92:93], s[92:93] op_sel:[0,0,1] op_sel_hi:[1,0,1]
    v_pk_fma_f32 v[148:149], v[148:149], s[92:93], s[92:93] op_sel:[0,0,1] op_sel_hi:[1,0,1]
    v_pk_fma_f32 v[150:151], v[150:151], s[92:93], s[92:93] op_sel:[0,0,1] op_sel_hi:[1,0,1]
    v_pk_fma_f32 v[152:153], v[152:153], s[94:95], s[94:95] op_sel:[0,0,1] op_sel_hi:[1,0,1]
    v_pk_fma_f32 v[154:155], v[154:155], s[94:95], s[94:95] op_sel:[0,0,1] op_sel_hi:[1,0,1]
    v_pk_fma_f32 v[156:157], v[156:157], s[94:95], s[94:95] op_sel:[0,0,1] op_sel_hi:[1,0,1]
    v_pk_fma_f32 v[158:159], v[158:159], s[94:95], s[94:95] op_sel:[0,0,1] op_sel_hi:[1,0,1]
    s_waitcnt lgkmcnt(0)
    s_barrier
    s_waitcnt vmcnt(0)
    v_xor_b32 v255, s47, v161
    v_bitop3_b32 v255, v255, v163, s47 bitop3:0xf6
    v_bitop3_b32 v255, v255, v165, s47 bitop3:0xf6
    v_bitop3_b32 v255, v255, v167, s47 bitop3:0xf6
    v_bitop3_b32 v255, v255, v169, s47 bitop3:0xf6
    v_bitop3_b32 v255, v255, v171, s47 bitop3:0xf6
    v_bitop3_b32 v255, v255, v173, s47 bitop3:0xf6
    v_bitop3_b32 v255, v255, v175, s47 bitop3:0xf6
    v_bitop3_b32 v255, v255, v15, s47 bitop3:0xf6
    v_cmp_ne_u32 vcc, 0, v255
    s_cbranch_vccnz L_chk_1
L_chk_1_back:
    s_mov_b64 exec, 0x0fffffff
    buffer_load_dword a255, v26, s[8:11], s3 offen
    buffer_load_dword a255, v25, s[12:15], s3 offen
    s_mov_b64 exec, -1
    s_mov_b64 exec, 0xffff
    buffer_load_dword a255, v27, s[32:35], 0 offen
    s_mov_b64 exec, -1
    v_lshlrev_b32 v176, 16, v168
    v_and_b32 v177, 0xffff0000, v168
    v_lshlrev_b32 v184, 16, v160
    v_and_b32 v185, 0xffff0000, v160
    v_lshlrev_b32 v178, 16, v170
    v_and_b32 v179, 0xffff0000, v170
    v_lshlrev_b32 v186, 16, v162
    v_and_b32 v187, 0xffff0000, v162
    v_lshlrev_b32 v180, 16, v172
    v_and_b32 v181, 0xffff0000, v172
    v_lshlrev_b32 v188, 16, v164
    v_and_b32 v189, 0xffff0000, v164
    v_lshlrev_b32 v182, 16, v174
    v_and_b32 v183, 0xffff0000, v174
    v_lshlrev_b32 v190, 16, v166
    v_and_b32 v191, 0xffff0000, v166
    v_add_f32 v176, 1.0, v176
    v_add_f32 v177, 1.0, v177
    v_add_f32 v178, 1.0, v178
    v_add_f32 v179, 1.0, v179
    v_add_f32 v180, 1.0, v180
    v_add_f32 v181, 1.0, v181
    v_add_f32 v182, 1.0, v182
    v_add_f32 v183, 1.0, v183
    v_cvt_pk_bf16_f32 v160, v176, v177
    v_cvt_pk_bf16_f32 v161, v178, v179
    v_cvt_pk_bf16_f32 v162, v180, v181
    v_cvt_pk_bf16_f32 v163, v182, v183
    v_lshlrev_b32 v176, 16, v160
    v_and_b32 v177, 0xffff0000, v160
    v_lshlrev_b32 v178, 16, v161
    v_and_b32 v179, 0xffff0000, v161
    v_lshlrev_b32 v180, 16, v162
    v_and_b32 v181, 0xffff0000, v162
    v_lshlrev_b32 v182, 16, v163
    v_and_b32 v183, 0xffff0000, v163
    v_pk_fma_f32 v[32:33], v[32:33], v[176:177], v[184:185]
    v_pk_fma_f32 v[34:35], v[34:35], v[178:179], v[186:187]
    v_pk_fma_f32 v[36:37], v[36:37], v[180:181], v[188:189]
    v_pk_fma_f32 v[38:39], v[38:39], v[182:183], v[190:191]
    v_cvt_pk_bf16_f32 v32, v32, v33
    v_cvt_pk_bf16_f32 v33, v34, v35
    v_cvt_pk_bf16_f32 v34, v36, v37
    v_cvt_pk_bf16_f32 v35, v38, v39
    ds_write_b128 v16, v[32:35] offset:0
    v_pk_fma_f32 v[40:41], v[40:41], v[176:177], v[184:185]
    v_pk_fma_f32 v[42:43], v[42:43], v[178:179], v[186:187]
    v_pk_fma_f32 v[44:45], v[44:45], v[180:181], v[188:189]
    v_pk_fma_f32 v[46:47], v[46:47], v[182:183], v[190:191]
    v_cvt_pk_bf16_f32 v40, v40, v41
    v_cvt_pk_bf16_f32 v41, v42, v43
    v_cvt_pk_bf16_f32 v42, v44, v45
    v_cvt_pk_bf16_f32 v43, v46, v47
    ds_write_b128 v17, v[40:43] offset:0
    v_pk_fma_f32 v[48:49], v[48:49], v[176:177], v[184:185]
    v_pk_fma_f32 v[50:51], v[50:51], v[178:179], v[186:187]
    v_pk_fma_f32 v[52:53], v[52:53], v[180:181], v[188:189]
    v_pk_fma_f32 v[54:55], v[54:55], v[182:183], v[190:191]
    v_cvt_pk_bf16_f32 v48, v48, v49
    v_cvt_pk_bf16_f32 v49, v50, v51
    v_cvt_pk_bf16_f32 v50, v52, v53
    v_cvt_pk_bf16_f32 v51, v54, v55
    ds_write_b128 v18, v[48:51] offset:0
    v_pk_fma_f32 v[56:57], v[56:57], v[176:177], v[184:185]
    v_pk_fma_f32 v[58:59], v[58:59], v[178:179], v[186:187]
    v_pk_fma_f32 v[60:61], v[60:61], v[180:181], v[188:189]
    v_pk_fma_f32 v[62:63], v[62:63], v[182:183], v[190:191]
    v_cvt_pk_bf16_f32 v56, v56, v57
    v_cvt_pk_bf16_f32 v57, v58, v59
    v_cvt_pk_bf16_f32 v58, v60, v61
    v_cvt_pk_bf16_f32 v59, v62, v63
    ds_write_b128 v19, v[56:59] offset:0
    v_pk_fma_f32 v[64:65], v[64:65], v[176:177], v[184:185]
    v_pk_fma_f32 v[66:67], v[66:67], v[178:179], v[186:187]
    v_pk_fma_f32 v[68:69], v[68:69], v[180:181], v[188:189]
    v_pk_fma_f32 v[70:71], v[70:71], v[182:183], v[190:191]
    v_cvt_pk_bf16_f32 v64, v64, v65
    v_cvt_pk_bf16_f32 v65, v66, v67
    v_cvt_pk_bf16_f32 v66, v68, v69
    v_cvt_pk_bf16_f32 v67, v70, v71
    ds_write_b128 v20, v[64:67] offset:0
    v_pk_fma_f32 v[72:73], v[72:73], v[176:177], v[184:185]
    v_pk_fma_f32 v[74:75], v[74:75], v[178:179], v[186:187]
    v_pk_fma_f32 v[76:77], v[76:77], v[180:181], v[188:189]
    v_pk_fma_f32 v[78:79], v[78:79], v[182:183], v[190:191]
    v_cvt_pk_bf16_f32 v72, v72, v73
    v_cvt_pk_bf16_f32 v73, v74, v75
    v_cvt_pk_bf16_f32 v74, v76, v77
    v_cvt_pk_bf16_f32 v75, v78, v79
    ds_write_b128 v21, v[72:75] offset:0
    v_pk_fma_f32 v[80:81], v[80:81], v[176:177], v[184:185]
    v_pk_fma_f32 v[82:83], v[82:83], v[178:179], v[186:187]
    v_pk_fma_f32 v[84:85], v[84:85], v[180:181], v[188:189]
    v_pk_fma_f32 v[86:87], v[86:87], v[182:183], v[190:191]
    v_cvt_pk_bf16_f32 v80, v80, v81
    v_cvt_pk_bf16_f32 v81, v82, v83
    v_cvt_pk_bf16_f32 v82, v84, v85
    v_cvt_pk_bf16_f32 v83, v86, v87
    ds_write_b128 v22, v[80:83] offset:0
    v_pk_fma_f32 v[88:89], v[88:89], v[176:177], v[184:185]
    v_pk_fma_f32 v[90:91], v[90:91], v[178:179], v[186:187]
    v_pk_fma_f32 v[92:93], v[92:93], v[180:181], v[188:189]
    v_pk_fma_f32 v[94:95], v[94:95], v[182:183], v[190:191]
    v_cvt_pk_bf16_f32 v88, v88, v89
    v_cvt_pk_bf16_f32 v89, v90, v91
    v_cvt_pk_bf16_f32 v90, v92, v93
    v_cvt_pk_bf16_f32 v91, v94, v95
    ds_write_b128 v23, v[88:91] offset:0
    v_pk_fma_f32 v[96:97], v[96:97], v[176:177], v[184:185]
    v_pk_fma_f32 v[98:99], v[98:99], v[178:179], v[186:187]
    v_pk_fma_f32 v[100:101], v[100:101], v[180:181], v[188:189]
    v_pk_fma_f32 v[102:103], v[102:103], v[182:183], v[190:191]
    v_cvt_pk_bf16_f32 v96, v96, v97
    v_cvt_pk_bf16_f32 v97, v98, v99
    v_cvt_pk_bf16_f32 v98, v100, v101
    v_cvt_pk_bf16_f32 v99, v102, v103
    ds_write_b128 v16, v[96:99] offset:128
    v_pk_fma_f32 v[104:105], v[104:105], v[176:177], v[184:185]
    v_pk_fma_f32 v[106:107], v[106:107], v[178:179], v[186:187]
    v_pk_fma_f32 v[108:109], v[108:109], v[180:181], v[188:189]
    v_pk_fma_f32 v[110:111], v[110:111], v[182:183], v[190:191]
    v_cvt_pk_bf16_f32 v104, v104, v105
    v_cvt_pk_bf16_f32 v105, v106, v107
    v_cvt_pk_bf16_f32 v106, v108, v109
    v_cvt_pk_bf16_f32 v107, v110, v111
    ds_write_b128 v17, v[104:107] offset:128
    v_pk_fma_f32 v[112:113], v[112:113], v[176:177], v[184:185]
    v_pk_fma_f32 v[114:115], v[114:115], v[178:179], v[186:187]
    v_pk_fma_f32 v[116:117], v[116:117], v[180:181], v[188:189]
    v_pk_fma_f32 v[118:119], v[118:119], v[182:183], v[190:191]
    v_cvt_pk_bf16_f32 v112, v112, v113
    v_cvt_pk_bf16_f32 v113, v114, v115
    v_cvt_pk_bf16_f32 v114, v116, v117
    v_cvt_pk_bf16_f32 v115, v118, v119
    ds_write_b128 v18, v[112:115] offset:128
    v_pk_fma_f32 v[120:121], v[120:121], v[176:177], v[184:185]
    v_pk_fma_f32 v[122:123], v[122:123], v[178:179], v[186:187]
    v_pk_fma_f32 v[124:125], v[124:125], v[180:181], v[188:189]
    v_pk_fma_f32 v[126:127], v[126:127], v[182:183], v[190:191]
    v_cvt_pk_bf16_f32 v120, v120, v121
    v_cvt_pk_bf16_f32 v121, v122, v123
    v_cvt_pk_bf16_f32 v122, v124, v125
    v_cvt_pk_bf16_f32 v123, v126, v127
    ds_write_b128 v19, v[120:123] offset:128
    v_pk_fma_f32 v[128:129], v[128:129], v[176:177], v[184:185]
    v_pk_fma_f32 v[130:131], v[130:131], v[178:179], v[186:187]
    v_pk_fma_f32 v[132:133], v[132:133], v[180:181], v[188:189]
    v_pk_fma_f32 v[134:135], v[134:135], v[182:183], v[190:191]
    v_cvt_pk_bf16_f32 v128, v128, v129
    v_cvt_pk_bf16_f32 v129, v130, v131
    v_cvt_pk_bf16_f32 v130, v132, v133
    v_cvt_pk_bf16_f32 v131, v134, v135
    ds_write_b128 v20, v[128:131] offset:128
    v_pk_fma_f32 v[136:137], v[136:137], v[176:177], v[184:185]
    v_pk_fma_f32 v[138:139], v[138:139], v[178:179], v[186:187]
    v_pk_fma_f32 v[140:141], v[140:141], v[180:181], v[188:189]
    v_pk_fma_f32 v[142:143], v[142:143], v[182:183], v[190:191]
    v_cvt_pk_bf16_f32 v136, v136, v137
    v_cvt_pk_bf16_f32 v137, v138, v139
    v_cvt_pk_bf16_f32 v138, v140, v141
    v_cvt_pk_bf16_f32 v139, v142, v143
    ds_write_b128 v21, v[136:139] offset:128
    v_pk_fma_f32 v[144:145], v[144:145], v[176:177], v[184:185]
    v_pk_fma_f32 v[146:147], v[146:147], v[178:179], v[186:187]
    v_pk_fma_f32 v[148:149], v[148:149], v[180:181], v[188:189]
    v_pk_fma_f32 v[150:151], v[150:151], v[182:183], v[190:191]
    v_cvt_pk_bf16_f32 v144, v144, v145
    v_cvt_pk_bf16_f32 v145, v146, v147
    v_cvt_pk_bf16_f32 v146, v148, v149
    v_cvt_pk_bf16_f32 v147, v150, v151
    ds_write_b128 v22, v[144:147] offset:128
    v_pk_fma_f32 v[152:153], v[152:153], v[176:177], v[184:185]
    v_pk_fma_f32 v[154:155], v[154:155], v[178:179], v[186:187]
    v_pk_fma_f32 v[156:157], v[156:157], v[180:181], v[188:189]
    v_pk_fma_f32 v[158:159], v[158:159], v[182:183], v[190:191]
    v_cvt_pk_bf16_f32 v152, v152, v153
    v_cvt_pk_bf16_f32 v153, v154, v155
    v_cvt_pk_bf16_f32 v154, v156, v157
    v_cvt_pk_bf16_f32 v155, v158, v159
    ds_write_b128 v23, v[152:155] offset:128
    s_waitcnt lgkmcnt(0)
    s_barrier
    v_cmp_ne_u32 vcc, s51, v14
    s_cbranch_vccnz L_p1_slow
    ds_read_b128 v[32:35], v8 offset:0
    ds_read_b64_tr_b16 v[192:193], v2 offset:0
    ds_read_b64_tr_b16 v[194:195], v2 offset:512
    ds_read_b64_tr_b16 v[196:197], v3 offset:0
    ds_read_b64_tr_b16 v[198:199], v3 offset:512
    ds_read_b128 v[36:39], v9 offset:1024
    ds_read_b64_tr_b16 v[200:201], v2 offset:2048
    ds_read_b64_tr_b16 v[202:203], v2 offset:2560
    ds_read_b64_tr_b16 v[204:205], v3 offset:2048
    ds_read_b64_tr_b16 v[206:207], v3 offset:2560
    ds_read_b128 v[40:43], v10 offset:2048
    s_waitcnt lgkmcnt(6)
    v_mfma_f32_32x32x16_bf16 v[144:159], v[192:195], v[32:35], 0
    ds_read_b128 v[44:47], v11 offset:3072
    ds_read_b64_tr_b16 v[208:209], v2 offset:4096
    ds_read_b64_tr_b16 v[210:211], v2 offset:4608
    s_mul_i32 s53, s63, 28672
    s_lshl_b32 s54, s50, 1
    v_mfma_f32_32x32x16_bf16 v[160:175], v[32:35], v[196:199], 0
    ds_read_b64_tr_b16 v[212:213], v3 offset:4096
    ds_read_b64_tr_b16 v[214:215], v3 offset:4608
    s_add_u32 s54, s54, s62
    s_lshl_b32 s55, s54, 11
    s_waitcnt lgkmcnt(6)
    v_mfma_f32_32x32x16_bf16 v[144:159], v[200:203], v[36:39], v[144:159]
    ds_read_b128 v[48:51], v8 offset:4096
    ds_read_b128 v[52:55], v9 offset:5120
    ds_read_b64_tr_b16 v[216:217], v2 offset:6144
    s_add_u32 s55, s55, s53
    s_lshl_b32 s54, s54, 9
    v_mfma_f32_32x32x16_bf16 v[160:175], v[36:39], v[204:207], v[160:175]
    ds_read_b64_tr_b16 v[218:219], v2 offset:6656
    ds_read_b64_tr_b16 v[220:221], v3 offset:6144
    ds_read_b64_tr_b16 v[222:223], v3 offset:6656
    s_add_u32 s54, s54, s53
    s_waitcnt lgkmcnt(6)
    v_mfma_f32_32x32x16_bf16 v[144:159], v[208:211], v[40:43], v[144:159]
    ds_read_b128 v[56:59], v10 offset:6144
    ds_read_b128 v[60:63], v11 offset:7168
    ds_read_b64_tr_b16 v[224:225], v2 offset:8192
    s_add_u32 s55, s55, s48
    s_add_u32 s56, s55, 229376
    v_mfma_f32_32x32x16_bf16 v[160:175], v[40:43], v[212:215], v[160:175]
    ds_read_b64_tr_b16 v[226:227], v2 offset:8704
    ds_read_b64_tr_b16 v[228:229], v3 offset:8192
    ds_read_b64_tr_b16 v[230:231], v3 offset:8704
    s_add_u32 s54, s54, s48
    s_waitcnt lgkmcnt(6)
    v_mfma_f32_32x32x16_bf16 v[144:159], v[216:219], v[44:47], v[144:159]
    ds_read_b128 v[64:67], v8 offset:8192
    ds_read_b128 v[68:71], v9 offset:9216
    ds_read_b64_tr_b16 v[232:233], v2 offset:10240
    s_add_u32 s53, s54, 458752
    v_lshrrev_b32 v4, 9, v1
    v_mfma_f32_32x32x16_bf16 v[160:175], v[44:47], v[220:223], v[160:175]
    ds_read_b64_tr_b16 v[234:235], v2 offset:10752
    ds_read_b64_tr_b16 v[236:237], v3 offset:10240
    ds_read_b64_tr_b16 v[238:239], v3 offset:10752
    v_mul_u32_u24 v4, 7168, v4
    s_waitcnt lgkmcnt(6)
    v_mfma_f32_32x32x16_bf16 v[144:159], v[224:227], v[48:51], v[144:159]
    ds_read_b128 v[72:75], v10 offset:10240
    ds_read_b128 v[76:79], v11 offset:11264
    ds_read_b64_tr_b16 v[240:241], v2 offset:12288
    v_and_b32 v5, 0x1f0, v1
    v_add_u32 v4, v4, v5
    v_mfma_f32_32x32x16_bf16 v[160:175], v[48:51], v[228:231], v[160:175]
    ds_read_b64_tr_b16 v[242:243], v2 offset:12800
    ds_read_b64_tr_b16 v[244:245], v3 offset:12288
    ds_read_b64_tr_b16 v[246:247], v3 offset:12800
    v_add_u32 v5, 14336, v4
    s_waitcnt lgkmcnt(6)
    v_mfma_f32_32x32x16_bf16 v[144:159], v[232:235], v[52:55], v[144:159]
    ds_read_b128 v[80:83], v8 offset:12288
    ds_read_b128 v[84:87], v9 offset:13312
    ds_read_b64_tr_b16 v[248:249], v2 offset:14336
    v_subrev_u32 v31, 57344, v2
    v_lshrrev_b32 v24, 7, v1
    v_mfma_f32_32x32x16_bf16 v[160:175], v[52:55], v[236:239], v[160:175]
    ds_read_b64_tr_b16 v[250:251], v2 offset:14848
    ds_read_b64_tr_b16 v[252:253], v3 offset:14336
    ds_read_b64_tr_b16 v[254:255], v3 offset:14848
    v_mul_u32_u24 v30, 896, v24
    s_waitcnt lgkmcnt(6)
    v_mfma_f32_32x32x16_bf16 v[144:159], v[240:243], v[56:59], v[144:159]
    ds_read_b128 v[88:91], v10 offset:14336
    ds_read_b128 v[92:95], v11 offset:15360
    ds_read_b64_tr_b16 v[192:193], v2 offset:16384
    v_and_b32 v24, 2, v24
    v_lshlrev_b32 v24, 5, v24
    v_mfma_f32_32x32x16_bf16 v[160:175], v[56:59], v[244:247], v[160:175]
    ds_read_b64_tr_b16 v[194:195], v2 offset:16896
    ds_read_b64_tr_b16 v[196:197], v3 offset:16384
    ds_read_b64_tr_b16 v[198:199], v3 offset:16896
    v_and_b32 v25, 0x70, v1
    s_waitcnt lgkmcnt(6)
    v_mfma_f32_32x32x16_bf16 v[144:159], v[248:251], v[60:63], v[144:159]
    ds_read_b128 v[96:99], v8 offset:16384
    ds_read_b128 v[100:103], v9 offset:17408
    ds_read_b64_tr_b16 v[200:201], v2 offset:18432
    v_xor_b32 v24, v24, v25
    v_add_u32 v30, v30, v24
    v_mfma_f32_32x32x16_bf16 v[160:175], v[60:63], v[252:255], v[160:175]
    ds_read_b64_tr_b16 v[202:203], v2 offset:18944
    ds_read_b64_tr_b16 v[204:205], v3 offset:18432
    ds_read_b64_tr_b16 v[206:207], v3 offset:18944
    s_mul_i32 s43, s46, 7168
    s_waitcnt lgkmcnt(6)
    v_mfma_f32_32x32x16_bf16 v[144:159], v[192:195], v[64:67], v[144:159]
    ds_read_b128 v[104:107], v10 offset:18432
    ds_read_b128 v[108:111], v11 offset:19456
    ds_read_b64_tr_b16 v[208:209], v2 offset:20480
    s_lshl_b32 s59, s50, 7
    s_add_u32 s43, s43, s59
    v_mfma_f32_32x32x16_bf16 v[160:175], v[64:67], v[196:199], v[160:175]
    ds_read_b64_tr_b16 v[210:211], v2 offset:20992
    ds_read_b64_tr_b16 v[212:213], v3 offset:20480
    ds_read_b64_tr_b16 v[214:215], v3 offset:20992
    s_waitcnt lgkmcnt(6)
    v_mfma_f32_32x32x16_bf16 v[144:159], v[200:203], v[68:71], v[144:159]
    ds_read_b128 v[112:115], v8 offset:20480
    ds_read_b128 v[116:119], v9 offset:21504
    ds_read_b64_tr_b16 v[216:217], v2 offset:22528
    v_mfma_f32_32x32x16_bf16 v[160:175], v[68:71], v[204:207], v[160:175]
    ds_read_b64_tr_b16 v[218:219], v2 offset:23040
    ds_read_b64_tr_b16 v[220:221], v3 offset:22528
    ds_read_b64_tr_b16 v[222:223], v3 offset:23040
    s_waitcnt lgkmcnt(6)
    v_mfma_f32_32x32x16_bf16 v[144:159], v[208:211], v[72:75], v[144:159]
    ds_read_b128 v[120:123], v10 offset:22528
    ds_read_b128 v[124:127], v11 offset:23552
    ds_read_b64_tr_b16 v[224:225], v2 offset:24576
    v_mfma_f32_32x32x16_bf16 v[160:175], v[72:75], v[212:215], v[160:175]
    ds_read_b64_tr_b16 v[226:227], v2 offset:25088
    ds_read_b64_tr_b16 v[228:229], v3 offset:24576
    ds_read_b64_tr_b16 v[230:231], v3 offset:25088
    s_waitcnt lgkmcnt(6)
    v_mfma_f32_32x32x16_bf16 v[144:159], v[216:219], v[76:79], v[144:159]
    ds_read_b128 v[128:131], v8 offset:24576
    ds_read_b128 v[132:135], v9 offset:25600
    ds_read_b64_tr_b16 v[232:233], v2 offset:26624
    v_mfma_f32_32x32x16_bf16 v[160:175], v[76:79], v[220:223], v[160:175]
    ds_read_b64_tr_b16 v[234:235], v2 offset:27136
    ds_read_b64_tr_b16 v[236:237], v3 offset:26624
    ds_read_b64_tr_b16 v[238:239], v3 offset:27136
    s_waitcnt lgkmcnt(6)
    v_mfma_f32_32x32x16_bf16 v[144:159], v[224:227], v[80:83], v[144:159]
    ds_read_b128 v[136:139], v10 offset:26624
    ds_read_b128 v[140:143], v11 offset:27648
    ds_read_b64_tr_b16 v[240:241], v2 offset:28672
    v_mfma_f32_32x32x16_bf16 v[160:175], v[80:83], v[228:231], v[160:175]
    ds_read_b64_tr_b16 v[242:243], v2 offset:29184
    ds_read_b64_tr_b16 v[244:245], v3 offset:28672
    ds_read_b64_tr_b16 v[246:247], v3 offset:29184
    s_waitcnt lgkmcnt(6)
    v_mfma_f32_32x32x16_bf16 v[144:159], v[232:235], v[84:87], v[144:159]
    ds_read_b64_tr_b16 v[248:249], v2 offset:30720
    ds_read_b64_tr_b16 v[250:251], v2 offset:31232
    ds_read_b64_tr_b16 v[252:253], v3 offset:30720
    v_mfma_f32_32x32x16_bf16 v[160:175], v[84:87], v[236:239], v[160:175]
    ds_read_b64_tr_b16 v[254:255], v3 offset:31232
    s_waitcnt lgkmcnt(4)
    v_mfma_f32_32x32x16_bf16 v[144:159], v[240:243], v[88:91], v[144:159]
    v_mfma_f32_32x32x16_bf16 v[160:175], v[88:91], v[244:247], v[160:175]
    s_barrier
    s_waitcnt lgkmcnt(0)
    v_mfma_f32_32x32x16_bf16 v[144:159], v[248:251], v[92:95], v[144:159]
    ds_read_b64_tr_b16 v[192:193], v2 offset:32768
    ds_read_b64_tr_b16 v[194:195], v2 offset:33280
    ds_read_b64_tr_b16 v[196:197], v3 offset:32768
    s_add_u32 m0, s58, 0
    s_add_u32 s60, s57, 0
    v_mfma_f32_32x32x16_bf16 v[160:175], v[92:95], v[252:255], v[160:175]
    ds_read_b64_tr_b16 v[198:199], v3 offset:33280
    ds_read_b64_tr_b16 v[200:201], v2 offset:34816
    ds_read_b64_tr_b16 v[202:203], v2 offset:35328
    buffer_load_dwordx4 v6, s[8:11], s60 offen lds
    s_waitcnt lgkmcnt(2)
    v_mfma_f32_32x32x16_bf16 v[144:159], v[192:195], v[96:99], v[144:159]
    ds_read_b64_tr_b16 v[204:205], v3 offset:34816
    ds_read_b64_tr_b16 v[206:207], v3 offset:35328
    ds_read_b64_tr_b16 v[208:209], v2 offset:36864
    s_add_u32 m0, s58, 4096
    s_add_u32 s60, s57, 86016
    v_mfma_f32_32x32x16_bf16 v[160:175], v[96:99], v[196:199], v[160:175]
    ds_read_b64_tr_b16 v[210:211], v2 offset:37376
    ds_read_b64_tr_b16 v[212:213], v3 offset:36864
    ds_read_b64_tr_b16 v[214:215], v3 offset:37376
    buffer_load_dwordx4 v6, s[8:11], s60 offen lds
    s_waitcnt lgkmcnt(4)
    v_mfma_f32_32x32x16_bf16 v[144:159], v[200:203], v[100:103], v[144:159]
    ds_read_b64_tr_b16 v[216:217], v2 offset:38912
    ds_read_b64_tr_b16 v[218:219], v2 offset:39424
    ds_read_b64_tr_b16 v[220:221], v3 offset:38912
    s_add_u32 m0, s58, 8192
    s_add_u32 s60, s57, 172032
    v_mfma_f32_32x32x16_bf16 v[160:175], v[100:103], v[204:207], v[160:175]
    ds_read_b64_tr_b16 v[222:223], v3 offset:39424
    ds_read_b64_tr_b16 v[224:225], v2 offset:40960
    ds_read_b64_tr_b16 v[226:227], v2 offset:41472
    buffer_load_dwordx4 v6, s[8:11], s60 offen lds
    s_waitcnt lgkmcnt(6)
    v_mfma_f32_32x32x16_bf16 v[144:159], v[208:211], v[104:107], v[144:159]
    ds_read_b64_tr_b16 v[228:229], v3 offset:40960
    ds_read_b64_tr_b16 v[230:231], v3 offset:41472
    ds_read_b64_tr_b16 v[232:233], v2 offset:43008
    s_add_u32 m0, s58, 12288
    s_add_u32 s60, s57, 258048
    v_mfma_f32_32x32x16_bf16 v[160:175], v[104:107], v[212:215], v[160:175]
    ds_read_b64_tr_b16 v[234:235], v2 offset:43520
    ds_read_b64_tr_b16 v[236:237], v3 offset:43008
    ds_read_b64_tr_b16 v[238:239], v3 offset:43520
    buffer_load_dwordx4 v6, s[8:11], s60 offen lds
    s_waitcnt lgkmcnt(8)
    v_mfma_f32_32x32x16_bf16 v[144:159], v[216:219], v[108:111], v[144:159]
    ds_read_b64_tr_b16 v[240:241], v2 offset:45056
    ds_read_b64_tr_b16 v[242:243], v2 offset:45568
    s_add_u32 m0, s58, 16384
    s_add_u32 s60, s57, 344064
    buffer_load_dwordx4 v6, s[8:11], s60 offen lds
    v_mfma_f32_32x32x16_bf16 v[160:175], v[108:111], v[220:223], v[160:175]
    ds_read_b64_tr_b16 v[244:245], v3 offset:45056
    ds_read_b64_tr_b16 v[246:247], v3 offset:45568
    s_add_u32 m0, s58, 20480
    s_add_u32 s60, s57, 430080
    s_waitcnt lgkmcnt(8)
    v_mfma_f32_32x32x16_bf16 v[144:159], v[224:227], v[112:115], v[144:159]
    ds_read_b64_tr_b16 v[248:249], v2 offset:47104
    ds_read_b64_tr_b16 v[250:251], v2 offset:47616
    buffer_load_dwordx4 v6, s[8:11], s60 offen lds
    s_add_u32 m0, s58, 24576
    s_add_u32 s60, s57, 516096
    v_mfma_f32_32x32x16_bf16 v[160:175], v[112:115], v[228:231], v[160:175]
    ds_read_b64_tr_b16 v[252:253], v3 offset:47104
    ds_read_b64_tr_b16 v[254:255], v3 offset:47616
    buffer_load_dwordx4 v6, s[8:11], s60 offen lds
    s_add_u32 m0, s58, 28672
    s_waitcnt lgkmcnt(8)
    v_mfma_f32_32x32x16_bf16 v[144:159], v[232:235], v[116:119], v[144:159]
    ds_read_b64_tr_b16 v[192:193], v2 offset:49152
    ds_read_b64_tr_b16 v[194:195], v2 offset:49664
    s_add_u32 s60, s57, 602112
    buffer_load_dwordx4 v6, s[8:11], s60 offen lds
    s_add_u32 m0, s58, 32768
    v_mfma_f32_32x32x16_bf16 v[160:175], v[116:119], v[236:239], v[160:175]
    s_add_u32 s60, s57, 688128
    buffer_load_dwordx4 v6, s[8:11], s60 offen lds
    s_add_u32 m0, s58, 36864
    s_add_u32 s60, s57, 774144
    s_waitcnt lgkmcnt(6)
    v_mfma_f32_32x32x16_bf16 v[144:159], v[240:243], v[120:123], v[144:159]
    ds_read_b64_tr_b16 v[200:201], v2 offset:51200
    ds_read_b64_tr_b16 v[202:203], v2 offset:51712
    buffer_load_dwordx4 v6, s[8:11], s60 offen lds
    s_add_u32 m0, s58, 40960
    s_add_u32 s60, s57, 860160
    v_mfma_f32_32x32x16_bf16 v[160:175], v[120:123], v[244:247], v[160:175]
    buffer_load_dwordx4 v6, s[8:11], s60 offen lds
    s_add_u32 m0, s58, 45056
    s_add_u32 s60, s57, 946176
    buffer_load_dwordx4 v6, s[8:11], s60 offen lds
    s_waitcnt lgkmcnt(4)
    v_mfma_f32_32x32x16_bf16 v[144:159], v[248:251], v[124:127], v[144:159]
    ds_read_b64_tr_b16 v[208:209], v2 offset:53248
    ds_read_b64_tr_b16 v[210:211], v2 offset:53760
    s_add_u32 m0, s58, 49152
    s_add_u32 s60, s57, 1032192
    buffer_load_dwordx4 v6, s[8:11], s60 offen lds
    v_mfma_f32_32x32x16_bf16 v[160:175], v[124:127], v[252:255], v[160:175]
    s_add_u32 m0, s58, 53248
    s_add_u32 s60, s57, 1118208
    buffer_load_dwordx4 v6, s[8:11], s60 offen lds
    s_waitcnt lgkmcnt(4)
    v_mfma_f32_32x32x16_bf16 v[144:159], v[192:195], v[128:131], v[144:159]
    ds_read_b64_tr_b16 v[216:217], v2 offset:55296
    ds_read_b64_tr_b16 v[218:219], v2 offset:55808
    v_mfma_f32_32x32x16_bf16 v[160:175], v[128:131], a[0:3], v[160:175]
    s_waitcnt lgkmcnt(4)
    v_mfma_f32_32x32x16_bf16 v[144:159], v[200:203], v[132:135], v[144:159]
    v_mfma_f32_32x32x16_bf16 v[160:175], v[132:135], a[4:7], v[160:175]
    s_waitcnt lgkmcnt(2)
    v_mfma_f32_32x32x16_bf16 v[144:159], v[208:211], v[136:139], v[144:159]
    v_mfma_f32_32x32x16_bf16 v[160:175], v[136:139], a[8:11], v[160:175]
    s_waitcnt lgkmcnt(0)
    v_mfma_f32_32x32x16_bf16 v[144:159], v[216:219], v[140:143], v[144:159]
    v_mfma_f32_32x32x16_bf16 v[160:175], v[140:143], a[12:15], v[160:175]
    s_nop 10
    v_cvt_pk_bf16_f32 v144, v144, v145
    v_cvt_pk_bf16_f32 v145, v146, v147
    v_cvt_pk_bf16_f32 v146, v148, v149
    v_cvt_pk_bf16_f32 v147, v150, v151
    buffer_store_dwordx4 v[144:147], v1, s[32:35], s56 offen offset:0 sc1
    v_cvt_pk_bf16_f32 v152, v152, v153
    v_cvt_pk_bf16_f32 v153, v154, v155
    v_cvt_pk_bf16_f32 v154, v156, v157
    v_cvt_pk_bf16_f32 v155, v158, v159
    buffer_store_dwordx4 v[152:155], v1, s[32:35], s56 offen offset:1024 sc1
    v_cvt_pk_bf16_f32 v160, v160, v161
    v_cvt_pk_bf16_f32 v161, v162, v163
    v_cvt_pk_bf16_f32 v162, v164, v165
    v_cvt_pk_bf16_f32 v163, v166, v167
    buffer_store_dwordx4 v[160:163], v4, s[32:35], s53 offen sc1
    v_cvt_pk_bf16_f32 v168, v168, v169
    v_cvt_pk_bf16_f32 v169, v170, v171
    v_cvt_pk_bf16_f32 v170, v172, v173
    v_cvt_pk_bf16_f32 v171, v174, v175
    buffer_store_dwordx4 v[168:171], v5, s[32:35], s53 offen sc1
    s_waitcnt vmcnt(4)
    s_barrier
    ds_read_b64_tr_b16 v[192:193], v31 offset:0
    ds_read_b64_tr_b16 v[194:195], v31 offset:512
    ds_read_b64_tr_b16 v[196:197], v31 offset:2048
    ds_read_b64_tr_b16 v[198:199], v31 offset:2560
    ds_read_b64_tr_b16 v[200:201], v31 offset:4096
    ds_read_b64_tr_b16 v[202:203], v31 offset:4608
    ds_read_b64_tr_b16 v[204:205], v31 offset:6144
    ds_read_b64_tr_b16 v[206:207], v31 offset:6656
    v_mov_b32 v6, v30
    ds_read_b64_tr_b16 v[208:209], v31 offset:8192
    ds_read_b64_tr_b16 v[210:211], v31 offset:8704
    s_waitcnt lgkmcnt(6)
    v_mfma_f32_32x32x16_bf16 v[176:191], v[192:195], v[32:35], 0
    s_lshl_b32 s3, s44, 5
    s_add_u32 s3, s3, s45
    s_lshl_b32 s3, s3, 7
    v_mov_b32 v10, 32768
    ds_read_b64_tr_b16 v[212:213], v31 offset:10240
    ds_read_b64_tr_b16 v[214:215], v31 offset:10752
    v_mfma_f32_32x32x16_bf16 v[176:191], v[196:199], v[36:39], v[176:191]
    s_add_u32 m0, s58, 57344
    s_nop 0
    buffer_load_dwordx4 v6, s[12:15], s43 offen lds
    ds_read_b64_tr_b16 v[216:217], v31 offset:12288
    ds_read_b64_tr_b16 v[218:219], v31 offset:12800
    s_waitcnt lgkmcnt(6)
    v_mfma_f32_32x32x16_bf16 v[176:191], v[200:203], v[40:43], v[176:191]
    v_mov_b32 v11, s47
    s_and_b32 s36, s45, 15
    s_lshr_b32 s37, s45, 4
    s_mul_i32 s38, s36, 7
    ds_read_b64_tr_b16 v[220:221], v31 offset:14336
    ds_read_b64_tr_b16 v[222:223], v31 offset:14848
    v_mfma_f32_32x32x16_bf16 v[176:191], v[204:207], v[44:47], v[176:191]
    s_lshr_b32 s38, s38, 1
    s_bitcmp1_b32 s36, 0
    s_cselect_b32 s100, 15, 0xf0000000
    s_mov_b32 s101, s100
    s_lshl_b32 s41, s46, 12
    ds_read_b64_tr_b16 v[192:193], v31 offset:16384
    ds_read_b64_tr_b16 v[194:195], v31 offset:16896
    s_waitcnt lgkmcnt(6)
    v_mfma_f32_32x32x16_bf16 v[176:191], v[208:211], v[48:51], v[176:191]
    s_add_u32 s41, s41, 114688
    v_add_u32 v12, s41, v1
    v_bfe_u32 v24, v1, 4, 5
    v_lshrrev_b32 v25, 9, v1
    ds_read_b64_tr_b16 v[196:197], v31 offset:18432
    ds_read_b64_tr_b16 v[198:199], v31 offset:18944
    v_mfma_f32_32x32x16_bf16 v[176:191], v[212:215], v[52:55], v[176:191]
    s_add_u32 m0, s58, 61440
    s_add_u32 s60, s43, 28672
    buffer_load_dwordx4 v6, s[12:15], s60 offen lds
    ds_read_b64_tr_b16 v[200:201], v31 offset:20480
    ds_read_b64_tr_b16 v[202:203], v31 offset:20992
    s_waitcnt lgkmcnt(6)
    v_mfma_f32_32x32x16_bf16 v[176:191], v[216:219], v[56:59], v[176:191]
    v_lshlrev_b32 v26, 2, v25
    v_sub_u32 v26, v24, v26
    v_cmp_le_i32 s[64:65], 0, v26
    v_cmp_le_i32 s[66:67], 1, v26
    ds_read_b64_tr_b16 v[204:205], v31 offset:22528
    ds_read_b64_tr_b16 v[206:207], v31 offset:23040
    v_mfma_f32_32x32x16_bf16 v[176:191], v[220:223], v[60:63], v[176:191]
    v_cmp_le_i32 s[68:69], 2, v26
    v_cmp_le_i32 s[70:71], 3, v26
    v_cmp_le_i32 s[72:73], 8, v26
    v_cmp_le_i32 s[74:75], 9, v26
    ds_read_b64_tr_b16 v[208:209], v31 offset:24576
    ds_read_b64_tr_b16 v[210:211], v31 offset:25088
    s_waitcnt lgkmcnt(6)
    v_mfma_f32_32x32x16_bf16 v[176:191], v[192:195], v[64:67], v[176:191]
    v_cmp_le_i32 s[76:77], 10, v26
    v_cmp_le_i32 s[78:79], 11, v26
    v_cmp_le_i32 s[80:81], 16, v26
    v_cmp_le_i32 s[82:83], 17, v26
    ds_read_b64_tr_b16 v[212:213], v31 offset:26624
    ds_read_b64_tr_b16 v[214:215], v31 offset:27136
    v_mfma_f32_32x32x16_bf16 v[176:191], v[196:199], v[68:71], v[176:191]
    s_add_u32 m0, s58, 65536
    s_add_u32 s60, s43, 57344
    buffer_load_dwordx4 v6, s[12:15], s60 offen lds
    ds_read_b64_tr_b16 v[216:217], v31 offset:28672
    ds_read_b64_tr_b16 v[218:219], v31 offset:29184
    s_waitcnt lgkmcnt(6)
    v_mfma_f32_32x32x16_bf16 v[176:191], v[200:203], v[72:75], v[176:191]
    v_cmp_le_i32 s[84:85], 18, v26
    v_cmp_le_i32 s[86:87], 19, v26
    v_cmp_le_i32 s[88:89], 24, v26
    v_cmp_le_i32 s[90:91], 25, v26
    ds_read_b64_tr_b16 v[220:221], v31 offset:30720
    ds_read_b64_tr_b16 v[222:223], v31 offset:31232
    v_mfma_f32_32x32x16_bf16 v[176:191], v[204:207], v[76:79], v[176:191]
    v_cmp_le_i32 s[92:93], 26, v26
    v_cmp_le_i32 s[94:95], 27, v26
    v_mov_b32 v27, 0
    v_mov_b32 v28, 0xffff
    ds_read_b64_tr_b16 v[192:193], v31 offset:32768
    ds_read_b64_tr_b16 v[194:195], v31 offset:33280
    s_waitcnt lgkmcnt(6)
    v_mfma_f32_32x32x16_bf16 v[176:191], v[208:211], v[80:83], v[176:191]
    v_mov_b32 v29, 0xffff0000
    v_cndmask_b32 v16, v27, v28, s[64:65]
    v_cndmask_b32 v30, v27, v29, s[66:67]
    v_or_b32 v16, v16, v30
    ds_read_b64_tr_b16 v[196:197], v31 offset:34816
    ds_read_b64_tr_b16 v[198:199], v31 offset:35328
    v_mfma_f32_32x32x16_bf16 v[176:191], v[212:215], v[84:87], v[176:191]
    s_add_u32 m0, s58, 69632
    s_add_u32 s60, s43, 86016
    buffer_load_dwordx4 v6, s[12:15], s60 offen lds
    ds_read_b64_tr_b16 v[200:201], v31 offset:36864
    ds_read_b64_tr_b16 v[202:203], v31 offset:37376
    s_waitcnt lgkmcnt(6)
    v_mfma_f32_32x32x16_bf16 v[176:191], v[216:219], v[88:91], v[176:191]
    v_cndmask_b32 v17, v27, v28, s[68:69]
    v_cndmask_b32 v30, v27, v29, s[70:71]
    v_or_b32 v17, v17, v30
    v_cndmask_b32 v18, v27, v28, s[72:73]
    ds_read_b64_tr_b16 v[204:205], v31 offset:38912
    ds_read_b64_tr_b16 v[206:207], v31 offset:39424
    v_mfma_f32_32x32x16_bf16 v[176:191], v[220:223], v[92:95], v[176:191]
    v_cndmask_b32 v30, v27, v29, s[74:75]
    v_or_b32 v18, v18, v30
    v_cndmask_b32 v19, v27, v28, s[76:77]
    v_cndmask_b32 v30, v27, v29, s[78:79]
    ds_read_b64_tr_b16 v[208:209], v31 offset:40960
    ds_read_b64_tr_b16 v[210:211], v31 offset:41472
    s_waitcnt lgkmcnt(6)
    v_mfma_f32_32x32x16_bf16 v[176:191], v[192:195], v[96:99], v[176:191]
    v_or_b32 v19, v19, v30
    v_cndmask_b32 v20, v27, v28, s[80:81]
    v_cndmask_b32 v30, v27, v29, s[82:83]
    v_or_b32 v20, v20, v30
    ds_read_b64_tr_b16 v[212:213], v31 offset:43008
    ds_read_b64_tr_b16 v[214:215], v31 offset:43520
    v_mfma_f32_32x32x16_bf16 v[176:191], v[196:199], v[100:103], v[176:191]
    s_add_u32 m0, s58, 73728
    s_add_u32 s60, s43, 114688
    buffer_load_dwordx4 v6, s[12:15], s60 offen lds
    ds_read_b64_tr_b16 v[216:217], v31 offset:45056
    ds_read_b64_tr_b16 v[218:219], v31 offset:45568
    s_waitcnt lgkmcnt(6)
    v_mfma_f32_32x32x16_bf16 v[176:191], v[200:203], v[104:107], v[176:191]
    v_cndmask_b32 v21, v27, v28, s[84:85]
    v_cndmask_b32 v30, v27, v29, s[86:87]
    v_or_b32 v21, v21, v30
    v_cndmask_b32 v22, v27, v28, s[88:89]
    ds_read_b64_tr_b16 v[220:221], v31 offset:47104
    ds_read_b64_tr_b16 v[222:223], v31 offset:47616
    v_mfma_f32_32x32x16_bf16 v[176:191], v[204:207], v[108:111], v[176:191]
    v_cndmask_b32 v30, v27, v29, s[90:91]
    v_or_b32 v22, v22, v30
    v_cndmask_b32 v23, v27, v28, s[92:93]
    v_cndmask_b32 v30, v27, v29, s[94:95]
    ds_read_b64_tr_b16 v[192:193], v31 offset:49152
    ds_read_b64_tr_b16 v[194:195], v31 offset:49664
    s_waitcnt lgkmcnt(6)
    v_mfma_f32_32x32x16_bf16 v[176:191], v[208:211], v[112:115], v[176:191]
    v_or_b32 v23, v23, v30
    v_and_b32 v26, 0x13, v24
    v_and_b32 v27, 4, v24
    v_lshl_or_b32 v26, v27, 1, v26
    ds_read_b64_tr_b16 v[196:197], v31 offset:51200
    ds_read_b64_tr_b16 v[198:199], v31 offset:51712
    v_mfma_f32_32x32x16_bf16 v[176:191], v[212:215], v[116:119], v[176:191]
    v_and_b32 v27, 8, v24
    v_lshrrev_b32 v27, 1, v27
    v_or_b32 v26, v26, v27
    v_lshlrev_b32 v26, 4, v26
    ds_read_b64_tr_b16 v[200:201], v31 offset:53248
    ds_read_b64_tr_b16 v[202:203], v31 offset:53760
    s_waitcnt lgkmcnt(6)
    v_mfma_f32_32x32x16_bf16 v[176:191], v[216:219], v[120:123], v[176:191]
    v_mul_u32_u24 v13, 7168, v25
    v_add_u32 v13, v13, v26
    s_lshl_b32 s53, s37, 2
    s_add_u32 s53, s53, s46
    ds_read_b64_tr_b16 v[204:205], v31 offset:55296
    ds_read_b64_tr_b16 v[206:207], v31 offset:55808
    v_mfma_f32_32x32x16_bf16 v[176:191], v[220:223], v[124:127], v[176:191]
    s_sub_u32 s39, 8, s53
    s_cmp_eq_u32 s44, 0
    s_cselect_b32 s39, s39, 0
    s_mul_i32 s40, s53, 28672
    s_add_u32 s40, s40, s48
    s_waitcnt vmcnt(5)
    s_barrier
    s_cmp_eq_u32 s46, 0
    s_cselect_b64 exec, 1, 0
    buffer_store_dword v11, v10, s[32:35], s3 offen sc1
    s_mov_b64 exec, -1
    s_waitcnt lgkmcnt(4)
    v_mfma_f32_32x32x16_bf16 v[176:191], v[192:195], v[128:131], v[176:191]
    s_lshr_b32 s53, s38, 3
    s_add_u32 s54, s38, 3
    s_lshr_b32 s54, s54, 3
    s_sub_u32 s54, s54, s53
    v_mfma_f32_32x32x16_bf16 v[176:191], v[196:199], v[132:135], v[176:191]
    s_add_u32 m0, s58, 77824
    s_add_u32 s60, s43, 143360
    buffer_load_dwordx4 v6, s[12:15], s60 offen lds
    s_waitcnt lgkmcnt(0)
    v_mfma_f32_32x32x16_bf16 v[176:191], v[200:203], v[136:139], v[176:191]
    s_add_u32 m0, s58, 81920
    s_add_u32 s60, s43, 172032
    buffer_load_dwordx4 v6, s[12:15], s60 offen lds
    v_mfma_f32_32x32x16_bf16 v[176:191], v[204:207], v[140:143], v[176:191]
    s_add_u32 m0, s58, 86016
    s_add_u32 s60, s43, 200704
    buffer_load_dwordx4 v6, s[12:15], s60 offen lds
    s_mov_b32 s56, 0x3e8b97f6
    v_bfe_u32 v25, v24, 3, 1
    v_mul_u32_u24 v25, s54, v25
    v_add_u32 v25, s53, v25
    v_and_b32 v26, 7, v24
    v_min_u32 v26, 5, v26
    s_lshl3_add_u32 s53, s44, 0
    s_lshr_b32 s53, s53, 1
    s_lshl1_add_u32 s53, s37, s53
    v_mul_f32 v176, s56, v176
    v_mul_f32 v177, s56, v177
    v_mul_f32 v178, s56, v178
    v_mul_f32 v179, s56, v179
    v_mul_f32 v180, s56, v180
    v_mul_f32 v181, s56, v181
    v_mul_f32 v182, s56, v182
    v_mul_f32 v183, s56, v183
    v_mul_f32 v184, s56, v184
    v_mul_f32 v185, s56, v185
    v_mul_f32 v186, s56, v186
    v_mul_f32 v187, s56, v187
    v_mul_f32 v188, s56, v188
    v_mul_f32 v189, s56, v189
    v_mul_f32 v190, s56, v190
    v_mul_f32 v191, s56, v191
    v_cvt_pk_bf16_f32 v176, v176, v177
    v_cvt_pk_bf16_f32 v177, v178, v179
    v_cvt_pk_bf16_f32 v178, v180, v181
    v_cvt_pk_bf16_f32 v179, v182, v183
    buffer_store_dwordx4 v[176:179], v1, s[32:35], s55 offen offset:0
    v_cvt_pk_bf16_f32 v184, v184, v185
    v_cvt_pk_bf16_f32 v185, v186, v187
    v_cvt_pk_bf16_f32 v186, v188, v189
    v_cvt_pk_bf16_f32 v187, v190, v191
    buffer_store_dwordx4 v[184:187], v1, s[32:35], s55 offen offset:1024
    s_add_u32 m0, s58, 90112
    s_add_u32 s60, s43, 229376
    buffer_load_dwordx4 v6, s[12:15], s60 offen lds
    s_add_u32 m0, s58, 94208
    s_add_u32 s60, s43, 258048
    buffer_load_dwordx4 v6, s[12:15], s60 offen lds
    s_add_u32 m0, s58, 98304
    s_add_u32 s60, s43, 286720
    buffer_load_dwordx4 v6, s[12:15], s60 offen lds
    s_add_u32 m0, s58, 102400
    s_add_u32 s60, s43, 315392
    buffer_load_dwordx4 v6, s[12:15], s60 offen lds
    s_add_u32 m0, s58, 106496
    s_add_u32 s60, s43, 344064
    buffer_load_dwordx4 v6, s[12:15], s60 offen lds
    s_add_u32 m0, s58, 110592
    s_add_u32 s60, s43, 372736
    buffer_load_dwordx4 v6, s[12:15], s60 offen lds
    v_add_u32 v26, s53, v26
    v_subrev_u32 v26, 4, v26
    v_max_i32 v26, 0, v26
    v_lshrrev_b32 v27, 2, v26
    v_and_b32 v26, 3, v26
    v_mul_u32_u24 v26, 7, v26
    v_lshl_add_u32 v26, v27, 5, v26
    v_add_u32 v26, v26, v25
    v_lshlrev_b32 v26, 7, v26
    v_add_u32 v14, 32768, v26
    v_bfe_u32 v26, v24, 1, 1
    s_lshl_b32 s53, s37, 1
    v_add_u32 v26, s53, v26
    v_mul_u32_u24 v26, 7, v26
    v_add_u32 v26, v26, v25
    v_and_b32 v27, 1, v24
    v_lshlrev_b32 v27, 3, v27
    v_lshl_add_u32 v26, v26, 4, v27
    v_add_u32 v243, 946176, v26
    v_lshrrev_b32 v24, 7, v1
    v_mul_u32_u24 v15, 3584, v24
    v_and_b32 v24, 2, v24
    v_lshlrev_b32 v24, 5, v24
    v_and_b32 v25, 0x70, v1
    v_xor_b32 v24, v24, v25
    v_add_u32 v15, v15, v24
    s_sub_u32 s53, s45, 28
    s_lshl3_add_u32 s53, s53, s44
    s_cmp_lt_u32 s45, 28
    s_cselect_b32 s53, s45, s53
    s_min_u32 s53, s53, 27
    s_lshl_b32 s53, s53, 7
    s_mul_i32 s54, s46, 28672
    s_add_u32 s42, s53, s54
    v_bfe_u32 v3, v1, 4, 5
    v_mul_u32_u24 v3, 896, v3
    v_lshrrev_b32 v4, 9, v1
    v_lshl_add_u32 v3, v4, 4, v3
    s_lshl3_add_u32 s59, s44, s63
    s_mul_i32 s59, s59, 28672
    s_lshl1_add_u32 s51, s50, s62
    s_lshl_b32 s51, s51, 6
    s_add_u32 s51, s51, s59
    v_min_u32 v240, 223, v0
    v_lshlrev_b32 v240, 3, v240
    v_add_u32 v241, 7680, v240
    v_add_u32 v242, 11264, v240
    v_mov_b32 v24, 0x3f803f80
    v_mov_b32 v25, 0x3f803f80
    v_mov_b32 v26, 0x3f803f80
    v_mov_b32 v27, 0x3f803f80
    s_mov_b64 exec, s[100:101]
    ds_write_b128 v12, v[24:27] offset:2048
    ds_write_b128 v12, v[24:27] offset:3072
    ds_write_b128 v12, v[24:27] offset:18432
    ds_write_b128 v12, v[24:27] offset:19456
    ds_write_b128 v12, v[24:27] offset:34816
    ds_write_b128 v12, v[24:27] offset:35840
    s_mov_b64 exec, -1
    v_lshrrev_b32 v8, 4, v1
    v_bfe_u32 v9, v8, 2, 2
    v_lshrrev_b32 v10, 5, v8
    v_lshl_add_u32 v10, v10, 3, v9
    v_lshlrev_b32 v2, 7, v10
    v_lshrrev_b32 v9, 1, v9
    v_lshlrev_b32 v9, 6, v9
    v_and_b32 v10, 1, v8
    v_lshlrev_b32 v10, 4, v10
    v_xor_b32 v9, v9, v10
    v_and_b32 v10, 2, v8
    v_lshlrev_b32 v10, 2, v10
    v_xor_b32 v9, v9, v10
    v_and_b32 v10, 16, v8
    v_lshlrev_b32 v10, 1, v10
    v_xor_b32 v9, v9, v10
    s_lshl_b32 s53, s62, 6
    v_xor_b32 v9, s53, v9
    v_add_u32 v2, v2, v9
    s_mul_i32 s53, s62, 28672
    s_add_u32 s53, s53, 57344
    v_add_u32 v2, s53, v2
    v_xor_b32 v6, 32, v15
    s_lshl_b32 s58, s46, 10
    s_lshl_b32 s54, s38, 9
    s_add_u32 s55, s40, s54
    s_mov_b32 s3, s55
    s_lshl_b32 s53, s38, 7
    s_add_u32 s59, s40, s53
    s_add_u32 s59, s59, 458752
    s_add_u32 s55, s55, 229376
    s_cmp_eq_u32 s44, 0
    s_cselect_b32 s60, 2130706432, 0
    s_sub_u32 s60, s60, 1867776
    s_add_u32 s53, s55, s60
    s_sub_u32 s53, s53, 229376
    s_add_u32 s56, s59, s60
    s_sub_u32 s56, s56, 229376
    s_cmp_eq_u32 s37, 0
    s_cselect_b32 s60, s60, 0
    s_add_u32 s54, s55, s60
    s_sub_u32 s54, s54, 114688
    s_add_u32 s57, s59, s60
    s_sub_u32 s57, s57, 114688
    s_lshl2_add_u32 s98, s45, s46
    s_lshl2_add_u32 s98, s98, 946176
    v_mov_b32 v8, s98
    v_mov_b32 v9, s47
    s_waitcnt vmcnt(6)
    s_mov_b64 exec, 1
    buffer_store_dword v9, v8, s[32:35], s48 offen
    s_mov_b64 exec, -1
L_p2_fast:
    s_mov_b32 s52, 0
    buffer_load_dword v8, v14, s[32:35], 0 offen sc1
    buffer_load_dwordx2 v[10:11], v243, s[32:35], s48 offen sc1
L_poll_2:
    s_waitcnt vmcnt(0)
    v_xor_b32 v255, s47, v8
    v_bitop3_b32 v255, v255, v10, s47 bitop3:0xf6
    v_bitop3_b32 v255, v255, v11, s47 bitop3:0xf6
    v_cmp_ne_u32 vcc, 0, v255
    s_cbranch_vccnz L_poll_2_again
    s_add_u32 m0, s41, 0
    s_nop 0
    buffer_load_dwordx4 v1, s[32:35], s53 offen sc1 lds
    s_add_u32 m0, s41, 0
    s_nop 0
    buffer_load_dwordx4 v1, s[32:35], s53 offen offset:1024 sc1 lds
    s_add_u32 m0, s41, 16384
    s_nop 0
    buffer_load_dwordx4 v1, s[32:35], s54 offen sc1 lds
    s_add_u32 m0, s41, 16384
    s_nop 0
    buffer_load_dwordx4 v1, s[32:35], s54 offen offset:1024 sc1 lds
    s_add_u32 m0, s41, 32768
    s_nop 0
    buffer_load_dwordx4 v1, s[32:35], s55 offen sc1 lds
    s_add_u32 m0, s41, 32768
    s_nop 0
    buffer_load_dwordx4 v1, s[32:35], s55 offen offset:1024 sc1 lds
    buffer_load_dwordx4 v[24:27], v1, s[32:35], s3 offen offset:0 sc1
    buffer_load_dwordx4 v[28:31], v1, s[32:35], s3 offen offset:1024 sc1
    s_andn2_b64 exec, -1, s[100:101]
    s_add_u32 m0, s41, 2048
    s_nop 0
    buffer_load_dwordx4 v13, s[32:35], s56 offen sc1 lds
    s_add_u32 m0, s41, 3072
    s_add_u32 s60, s56, 14336
    buffer_load_dwordx4 v13, s[32:35], s60 offen sc1 lds
    s_add_u32 m0, s41, 18432
    s_nop 0
    buffer_load_dwordx4 v13, s[32:35], s57 offen sc1 lds
    s_add_u32 m0, s41, 19456
    s_add_u32 s60, s57, 14336
    buffer_load_dwordx4 v13, s[32:35], s60 offen sc1 lds
    s_add_u32 m0, s41, 34816
    s_nop 0
    buffer_load_dwordx4 v13, s[32:35], s59 offen sc1 lds
    s_add_u32 m0, s41, 35840
    s_add_u32 s60, s59, 14336
    buffer_load_dwordx4 v13, s[32:35], s60 offen sc1 lds
    s_mov_b64 exec, -1
    s_barrier
    v_xor_b32 v5, 64, v2
    ds_read_b64_tr_b16 a[128:129], v2 offset:0
    ds_read_b64_tr_b16 a[130:131], v2 offset:512
    ds_read_b64_tr_b16 a[132:133], v5 offset:0
    ds_read_b64_tr_b16 a[134:135], v5 offset:512
    ds_read_b64_tr_b16 a[136:137], v2 offset:2048
    ds_read_b64_tr_b16 a[138:139], v2 offset:2560
    ds_read_b64_tr_b16 a[140:141], v5 offset:2048
    ds_read_b64_tr_b16 a[142:143], v5 offset:2560
    ds_read_b64_tr_b16 a[144:145], v2 offset:4096
    ds_read_b64_tr_b16 a[146:147], v2 offset:4608
    ds_read_b64_tr_b16 a[148:149], v5 offset:4096
    ds_read_b64_tr_b16 a[150:151], v5 offset:4608
    ds_read_b64_tr_b16 a[152:153], v2 offset:6144
    ds_read_b64_tr_b16 a[154:155], v2 offset:6656
    ds_read_b64_tr_b16 a[156:157], v5 offset:6144
    ds_read_b64_tr_b16 a[158:159], v5 offset:6656
    ds_read_b64_tr_b16 a[160:161], v2 offset:8192
    ds_read_b64_tr_b16 a[162:163], v2 offset:8704
    ds_read_b64_tr_b16 a[164:165], v5 offset:8192
    ds_read_b64_tr_b16 a[166:167], v5 offset:8704
    ds_read_b64_tr_b16 a[168:169], v2 offset:10240
    ds_read_b64_tr_b16 a[170:171], v2 offset:10752
    ds_read_b64_tr_b16 a[172:173], v5 offset:10240
    ds_read_b64_tr_b16 a[174:175], v5 offset:10752
    ds_read_b64_tr_b16 a[176:177], v2 offset:12288
    ds_read_b64_tr_b16 a[178:179], v2 offset:12800
    ds_read_b64_tr_b16 a[180:181], v5 offset:12288
    ds_read_b64_tr_b16 a[182:183], v5 offset:12800
    ds_read_b64_tr_b16 a[184:185], v2 offset:14336
    ds_read_b64_tr_b16 a[186:187], v2 offset:14848
    ds_read_b64_tr_b16 a[188:189], v5 offset:14336
    ds_read_b64_tr_b16 a[190:191], v5 offset:14848
    ds_read_b64_tr_b16 a[192:193], v2 offset:16384
    ds_read_b64_tr_b16 a[194:195], v2 offset:16896
    ds_read_b64_tr_b16 a[196:197], v5 offset:16384
    ds_read_b64_tr_b16 a[198:199], v5 offset:16896
    ds_read_b64_tr_b16 a[200:201], v2 offset:18432
    ds_read_b64_tr_b16 a[202:203], v2 offset:18944
    ds_read_b64_tr_b16 a[204:205], v5 offset:18432
    ds_read_b64_tr_b16 a[206:207], v5 offset:18944
    ds_read_b64_tr_b16 a[208:209], v2 offset:20480
    ds_read_b64_tr_b16 a[210:211], v2 offset:20992
    ds_read_b64_tr_b16 a[212:213], v5 offset:20480
    ds_read_b64_tr_b16 a[214:215], v5 offset:20992
    ds_read_b64_tr_b16 a[216:217], v2 offset:22528
    ds_read_b64_tr_b16 a[218:219], v2 offset:23040
    ds_read_b64_tr_b16 a[220:221], v5 offset:22528
    ds_read_b64_tr_b16 a[222:223], v5 offset:23040
    ds_read_b64_tr_b16 a[224:225], v2 offset:24576
    ds_read_b64_tr_b16 a[226:227], v2 offset:25088
    ds_read_b64_tr_b16 a[228:229], v5 offset:24576
    ds_read_b64_tr_b16 a[230:231], v5 offset:25088
    ds_read_b64_tr_b16 a[232:233], v2 offset:26624
    ds_read_b64_tr_b16 a[234:235], v2 offset:27136
    ds_read_b64_tr_b16 a[236:237], v5 offset:26624
    ds_read_b64_tr_b16 a[238:239], v5 offset:27136
    s_bitcmp1_b32 s36, 0
    s_cselect_b32 s98, -1, 0
    s_mov_b32 s99, 0
    s_waitcnt vmcnt(6)
    s_waitcnt lgkmcnt(0)
    s_barrier
    s_mov_b64 exec, s[98:99]
    v_mov_b32 v24, 0
    v_mov_b32 v25, 0
    s_not_b32 exec_hi, s98
    s_mov_b32 exec_lo, 0
    v_mov_b32 v30, 0
    v_mov_b32 v31, 0
    s_mov_b64 exec, -1
    ds_read_b128 a[0:3], v12 offset:0
    ds_read_b128 a[4:7], v12 offset:1024
    ds_read_b128 a[8:11], v12 offset:32768
    ds_read_b128 a[12:15], v12 offset:33792
    ds_read_b128 a[16:19], v12 offset:4096
    ds_read_b128 a[20:23], v12 offset:5120
    ds_read_b128 a[24:27], v12 offset:8192
    ds_read_b128 a[28:31], v12 offset:9216
    ds_read_b128 a[32:35], v12 offset:12288
    ds_read_b128 a[36:39], v12 offset:13312
    s_waitcnt lgkmcnt(8)
    v_mfma_f32_32x32x16_bf16 v[32:47], a[0:3], v[24:27], 0
    v_mfma_f32_32x32x16_bf16 v[32:47], a[4:7], v[28:31], v[32:47]
    s_add_u32 m0, s58, 0
    s_nop 0
    buffer_load_dwordx4 v15, s[16:19], s42 offen lds
    ds_read_b128 a[40:43], v12 offset:16384
    ds_read_b128 a[44:47], v12 offset:17408
    s_waitcnt lgkmcnt(8)
    v_mfma_f32_32x32x16_bf16 v[160:175], a[8:11], v[24:27], 0
    v_mfma_f32_32x32x16_bf16 v[160:175], a[12:15], v[28:31], v[160:175]
    s_add_u32 m0, s58, 57344
    s_nop 0
    buffer_load_dwordx4 v6, s[20:23], s42 offen lds
    ds_read_b128 a[48:51], v12 offset:20480
    ds_read_b128 a[52:55], v12 offset:21504
    s_waitcnt lgkmcnt(8)
    v_mfma_f32_32x32x16_bf16 v[48:63], a[16:19], v[24:27], 0
    v_mfma_f32_32x32x16_bf16 v[48:63], a[20:23], v[28:31], v[48:63]
    s_cmp_gt_i32 s39, 0
    s_cbranch_scc1 L_miss_3
L_miss_3_back:
    buffer_load_dwordx4 v[224:227], v3, s[4:7], s51 offen offset:0
    ds_read_b128 a[56:59], v12 offset:24576
    ds_read_b128 a[60:63], v12 offset:25600
    s_waitcnt lgkmcnt(8)
    v_mfma_f32_32x32x16_bf16 v[64:79], a[24:27], v[24:27], 0
    v_cndmask_b32 v160, v32, v160, s[64:65]
    v_cndmask_b32 v161, v33, v161, s[66:67]
    v_cndmask_b32 v162, v34, v162, s[68:69]
    v_cndmask_b32 v163, v35, v163, s[70:71]
    v_cndmask_b32 v164, v36, v164, s[72:73]
    v_mfma_f32_32x32x16_bf16 v[64:79], a[28:31], v[28:31], v[64:79]
    v_cndmask_b32 v165, v37, v165, s[74:75]
    v_cndmask_b32 v166, v38, v166, s[76:77]
    v_cndmask_b32 v167, v39, v167, s[78:79]
    v_cndmask_b32 v168, v40, v168, s[80:81]
    v_cndmask_b32 v169, v41, v169, s[82:83]
    s_cmp_gt_i32 s39, 1
    s_cbranch_scc1 L_miss_4
L_miss_4_back:
    s_add_u32 m0, s58, 4096
    s_add_u32 s60, s42, 114688
    buffer_load_dwordx4 v15, s[16:19], s60 offen lds
    ds_read_b128 a[64:67], v12 offset:28672
    ds_read_b128 a[68:71], v12 offset:29696
    s_waitcnt lgkmcnt(8)
    v_mfma_f32_32x32x16_bf16 v[80:95], a[32:35], v[24:27], 0
    v_cndmask_b32 v170, v42, v170, s[84:85]
    v_cndmask_b32 v171, v43, v171, s[86:87]
    v_cndmask_b32 v172, v44, v172, s[88:89]
    v_cndmask_b32 v173, v45, v173, s[90:91]
    v_cndmask_b32 v174, v46, v174, s[92:93]
    v_mfma_f32_32x32x16_bf16 v[80:95], a[36:39], v[28:31], v[80:95]
    v_cndmask_b32 v175, v47, v175, s[94:95]
    v_max3_f32 v8, v160, v161, v162
    v_max3_f32 v9, v163, v164, v165
    v_max3_f32 v8, v8, v166, v167
    v_max3_f32 v9, v9, v168, v169
    s_cmp_gt_i32 s39, 2
    s_cbranch_scc1 L_miss_5
L_miss_5_back:
    s_mul_i32 s53, s63, 28672
    s_add_u32 s53, s53, s48
    s_lshl_b32 s54, s50, 1
    s_add_u32 s54, s54, s62
    s_lshl_b32 s54, s54, 11
    s_add_u32 s53, s53, s54
    s_add_u32 s53, s53, 688128
    v_lshlrev_b32 v5, 3, v1
    s_mov_b64 exec, 0xffff
    buffer_load_dword a255, v5, s[32:35], s53 offen
    s_mov_b64 exec, -1
    s_waitcnt lgkmcnt(6)
    v_mfma_f32_32x32x16_bf16 v[96:111], a[40:43], v[24:27], 0
    v_max3_f32 v8, v8, v170, v171
    v_max3_f32 v9, v9, v172, v173
    v_max3_f32 v8, v8, v174, v175
    v_max3_f32 v8, v8, v48, v49
    v_max3_f32 v9, v9, v50, v51
    v_mfma_f32_32x32x16_bf16 v[96:111], a[44:47], v[28:31], v[96:111]
    v_max3_f32 v8, v8, v52, v53
    v_max3_f32 v9, v9, v54, v55
    v_max3_f32 v8, v8, v56, v57
    v_max3_f32 v9, v9, v58, v59
    v_max3_f32 v8, v8, v60, v61
    s_cmp_gt_i32 s39, 3
    s_cbranch_scc1 L_miss_6
L_miss_6_back:
    buffer_load_dwordx4 v[228:231], v3, s[4:7], s51 offen offset:32
    s_waitcnt lgkmcnt(4)
    v_mfma_f32_32x32x16_bf16 v[112:127], a[48:51], v[24:27], 0
    v_max3_f32 v9, v9, v62, v63
    v_max3_f32 v8, v8, v64, v65
    v_max3_f32 v9, v9, v66, v67
    v_max3_f32 v8, v8, v68, v69
    v_max3_f32 v9, v9, v70, v71
    v_mfma_f32_32x32x16_bf16 v[112:127], a[52:55], v[28:31], v[112:127]
    v_max3_f32 v8, v8, v72, v73
    v_max3_f32 v9, v9, v74, v75
    v_max3_f32 v8, v8, v76, v77
    v_max3_f32 v9, v9, v78, v79
    v_max3_f32 v8, v8, v80, v81
    s_cmp_gt_i32 s39, 4
    s_cbranch_scc1 L_miss_7
L_miss_7_back:
    s_add_u32 m0, s58, 61440
    s_add_u32 s60, s42, 114688
    buffer_load_dwordx4 v6, s[20:23], s60 offen lds
    s_waitcnt lgkmcnt(2)
    v_mfma_f32_32x32x16_bf16 v[128:143], a[56:59], v[24:27], 0
    v_max3_f32 v9, v9, v82, v83
    v_max3_f32 v8, v8, v84, v85
    v_max3_f32 v9, v9, v86, v87
    v_max3_f32 v8, v8, v88, v89
    v_max3_f32 v9, v9, v90, v91
    v_mfma_f32_32x32x16_bf16 v[128:143], a[60:63], v[28:31], v[128:143]
    v_max3_f32 v8, v8, v92, v93
    v_max3_f32 v9, v9, v94, v95
    v_max3_f32 v8, v8, v96, v97
    v_max3_f32 v9, v9, v98, v99
    v_max3_f32 v8, v8, v100, v101
    s_cmp_gt_i32 s39, 5
    s_cbranch_scc1 L_miss_8
L_miss_8_back:
    buffer_load_dwordx2 v[232:233], v241, s[32:35], 0 offen offset:0 sc1
    s_waitcnt lgkmcnt(0)
    v_mfma_f32_32x32x16_bf16 v[144:159], a[64:67], v[24:27], 0
    v_max3_f32 v9, v9, v102, v103
    v_max3_f32 v8, v8, v104, v105
    v_max3_f32 v9, v9, v106, v107
    v_max3_f32 v8, v8, v108, v109
    v_max3_f32 v9, v9, v110, v111
    v_mfma_f32_32x32x16_bf16 v[144:159], a[68:71], v[28:31], v[144:159]
    v_max3_f32 v8, v8, v112, v113
    v_max3_f32 v9, v9, v114, v115
    v_max3_f32 v8, v8, v116, v117
    v_max3_f32 v9, v9, v118, v119
    v_max3_f32 v8, v8, v120, v121
    s_cmp_gt_i32 s39, 6
    s_cbranch_scc1 L_miss_9
L_miss_9_back:
    s_add_u32 m0, s58, 8192
    s_add_u32 s60, s42, 229376
    buffer_load_dwordx4 v15, s[16:19], s60 offen lds
    v_max3_f32 v9, v9, v122, v123
    v_max3_f32 v8, v8, v124, v125
    v_max3_f32 v9, v9, v126, v127
    v_max3_f32 v8, v8, v128, v129
    v_max3_f32 v9, v9, v130, v131
    v_max3_f32 v8, v8, v132, v133
    v_max3_f32 v9, v9, v134, v135
    v_max3_f32 v8, v8, v136, v137
    v_max3_f32 v9, v9, v138, v139
    v_max3_f32 v8, v8, v140, v141
    v_max3_f32 v9, v9, v142, v143
    s_cmp_gt_i32 s39, 7
    s_cbranch_scc1 L_miss_10
L_miss_10_back:
    v_max3_f32 v8, v8, v144, v145
    v_max3_f32 v9, v9, v146, v147
    v_max3_f32 v8, v8, v148, v149
    v_max3_f32 v9, v9, v150, v151
    v_max3_f32 v8, v8, v152, v153
    v_max3_f32 v9, v9, v154, v155
    v_max3_f32 v8, v8, v156, v157
    v_max3_f32 v9, v9, v158, v159
    v_max_f32 v8, v8, v9
    v_mov_b32 v9, v8
    s_nop 1
    v_permlane32_swap_b32 v9, v8
    v_max_f32 v8, v8, v9
    v_sub_f32 v10, 0, v8
    s_waitcnt vmcnt(9)
    s_barrier
    ds_read_b128 a[72:75], v12 offset:6144
    ds_read_b128 a[76:79], v12 offset:7168
    ds_read_b128 a[80:83], v12 offset:10240
    ds_read_b128 a[84:87], v12 offset:11264
    ds_read_b128 a[88:91], v12 offset:14336
    ds_read_b128 a[92:95], v12 offset:15360
    ds_read_b128 a[96:99], v12 offset:18432
    ds_read_b128 a[100:103], v12 offset:19456
    ds_read_b128 a[104:107], v12 offset:22528
    ds_read_b128 a[108:111], v12 offset:23552
    v_pk_add_f32 v[48:49], v[48:49], v[10:11] op_sel_hi:[1,0]
    v_pk_add_f32 v[50:51], v[50:51], v[10:11] op_sel_hi:[1,0]
    v_pk_add_f32 v[52:53], v[52:53], v[10:11] op_sel_hi:[1,0]
    v_pk_add_f32 v[54:55], v[54:55], v[10:11] op_sel_hi:[1,0]
    v_pk_add_f32 v[56:57], v[56:57], v[10:11] op_sel_hi:[1,0]
    v_pk_add_f32 v[58:59], v[58:59], v[10:11] op_sel_hi:[1,0]
    v_pk_add_f32 v[60:61], v[60:61], v[10:11] op_sel_hi:[1,0]
    v_pk_add_f32 v[62:63], v[62:63], v[10:11] op_sel_hi:[1,0]
    v_exp_f32 v48, v48
    v_exp_f32 v49, v49
    v_exp_f32 v50, v50
    v_exp_f32 v51, v51
    v_cvt_pk_bf16_f32 v32, v48, v49
    v_exp_f32 v52, v52
    v_exp_f32 v53, v53
    v_cvt_pk_bf16_f32 v33, v50, v51
    v_exp_f32 v54, v54
    v_exp_f32 v55, v55
    v_cvt_pk_bf16_f32 v34, v52, v53
    buffer_load_dwordx2 v[234:235], v241, s[32:35], 0 offen offset:1792 sc1
    v_cvt_pk_bf16_f32 v35, v54, v55
    v_exp_f32 v56, v56
    v_exp_f32 v57, v57
    v_exp_f32 v58, v58
    v_exp_f32 v59, v59
    v_cvt_pk_bf16_f32 v36, v56, v57
    v_exp_f32 v60, v60
    v_exp_f32 v61, v61
    v_cvt_pk_bf16_f32 v37, v58, v59
    v_exp_f32 v62, v62
    v_exp_f32 v63, v63
    v_cvt_pk_bf16_f32 v38, v60, v61
    s_add_u32 m0, s58, 65536
    s_add_u32 s60, s42, 229376
    buffer_load_dwordx4 v6, s[20:23], s60 offen lds
    v_cvt_pk_bf16_f32 v39, v62, v63
    ds_read_b128 a[112:115], v12 offset:26624
    ds_read_b128 a[116:119], v12 offset:27648
    v_pk_add_f32 v[64:65], v[64:65], v[10:11] op_sel_hi:[1,0]
    v_pk_add_f32 v[66:67], v[66:67], v[10:11] op_sel_hi:[1,0]
    v_pk_add_f32 v[68:69], v[68:69], v[10:11] op_sel_hi:[1,0]
    v_pk_add_f32 v[70:71], v[70:71], v[10:11] op_sel_hi:[1,0]
    v_pk_add_f32 v[72:73], v[72:73], v[10:11] op_sel_hi:[1,0]
    v_pk_add_f32 v[74:75], v[74:75], v[10:11] op_sel_hi:[1,0]
    v_pk_add_f32 v[76:77], v[76:77], v[10:11] op_sel_hi:[1,0]
    v_pk_add_f32 v[78:79], v[78:79], v[10:11] op_sel_hi:[1,0]
    s_waitcnt lgkmcnt(10)
    v_mfma_f32_32x32x16_bf16 v[192:207], a[72:75], v[32:35], 0
    v_exp_f32 v64, v64
    v_exp_f32 v65, v65
    v_exp_f32 v66, v66
    v_exp_f32 v67, v67
    v_cvt_pk_bf16_f32 v40, v64, v65
    v_exp_f32 v68, v68
    v_exp_f32 v69, v69
    v_cvt_pk_bf16_f32 v41, v66, v67
    v_exp_f32 v70, v70
    v_exp_f32 v71, v71
    v_cvt_pk_bf16_f32 v42, v68, v69
    buffer_load_dwordx2 v[236:237], v242, s[32:35], 0 offen offset:0 sc1
    v_cvt_pk_bf16_f32 v43, v70, v71
    v_mfma_f32_32x32x16_bf16 v[192:207], a[76:79], v[36:39], v[192:207]
    v_exp_f32 v72, v72
    v_exp_f32 v73, v73
    v_exp_f32 v74, v74
    v_exp_f32 v75, v75
    v_cvt_pk_bf16_f32 v44, v72, v73
    v_exp_f32 v76, v76
    v_exp_f32 v77, v77
    v_cvt_pk_bf16_f32 v45, v74, v75
    v_exp_f32 v78, v78
    v_exp_f32 v79, v79
    v_cvt_pk_bf16_f32 v46, v76, v77
    s_add_u32 m0, s58, 12288
    s_add_u32 s60, s42, 344064
    buffer_load_dwordx4 v15, s[16:19], s60 offen lds
    v_cvt_pk_bf16_f32 v47, v78, v79
    ds_read_b128 a[120:123], v12 offset:30720
    ds_read_b128 a[124:127], v12 offset:31744
    v_pk_add_f32 v[80:81], v[80:81], v[10:11] op_sel_hi:[1,0]
    v_pk_add_f32 v[82:83], v[82:83], v[10:11] op_sel_hi:[1,0]
    v_pk_add_f32 v[84:85], v[84:85], v[10:11] op_sel_hi:[1,0]
    v_pk_add_f32 v[86:87], v[86:87], v[10:11] op_sel_hi:[1,0]
    v_pk_add_f32 v[88:89], v[88:89], v[10:11] op_sel_hi:[1,0]
    v_pk_add_f32 v[90:91], v[90:91], v[10:11] op_sel_hi:[1,0]
    v_pk_add_f32 v[92:93], v[92:93], v[10:11] op_sel_hi:[1,0]
    v_pk_add_f32 v[94:95], v[94:95], v[10:11] op_sel_hi:[1,0]
    s_waitcnt lgkmcnt(10)
    v_mfma_f32_32x32x16_bf16 v[192:207], a[80:83], v[40:43], v[192:207]
    v_exp_f32 v80, v80
    v_exp_f32 v81, v81
    v_exp_f32 v82, v82
    v_exp_f32 v83, v83
    v_cvt_pk_bf16_f32 v32, v80, v81
    v_exp_f32 v84, v84
    v_exp_f32 v85, v85
    v_cvt_pk_bf16_f32 v33, v82, v83
    v_exp_f32 v86, v86
    v_exp_f32 v87, v87
    v_cvt_pk_bf16_f32 v34, v84, v85
    buffer_load_dwordx2 v[238:239], v242, s[32:35], 0 offen offset:1792 sc1
    v_cvt_pk_bf16_f32 v35, v86, v87
    v_mfma_f32_32x32x16_bf16 v[192:207], a[84:87], v[44:47], v[192:207]
    v_exp_f32 v88, v88
    v_exp_f32 v89, v89
    v_exp_f32 v90, v90
    v_exp_f32 v91, v91
    v_cvt_pk_bf16_f32 v36, v88, v89
    v_exp_f32 v92, v92
    v_exp_f32 v93, v93
    v_cvt_pk_bf16_f32 v37, v90, v91
    v_exp_f32 v94, v94
    v_exp_f32 v95, v95
    v_cvt_pk_bf16_f32 v38, v92, v93
    s_add_u32 m0, s58, 69632
    s_add_u32 s60, s42, 344064
    buffer_load_dwordx4 v6, s[20:23], s60 offen lds
    v_cvt_pk_bf16_f32 v39, v94, v95
    ds_read_b128 a[0:3], v12 offset:34816
    ds_read_b128 a[4:7], v12 offset:35840
    v_pk_add_f32 v[96:97], v[96:97], v[10:11] op_sel_hi:[1,0]
    v_pk_add_f32 v[98:99], v[98:99], v[10:11] op_sel_hi:[1,0]
    v_pk_add_f32 v[100:101], v[100:101], v[10:11] op_sel_hi:[1,0]
    v_pk_add_f32 v[102:103], v[102:103], v[10:11] op_sel_hi:[1,0]
    v_pk_add_f32 v[104:105], v[104:105], v[10:11] op_sel_hi:[1,0]
    v_pk_add_f32 v[106:107], v[106:107], v[10:11] op_sel_hi:[1,0]
    v_pk_add_f32 v[108:109], v[108:109], v[10:11] op_sel_hi:[1,0]
    v_pk_add_f32 v[110:111], v[110:111], v[10:11] op_sel_hi:[1,0]
    s_waitcnt lgkmcnt(10)
    v_mfma_f32_32x32x16_bf16 v[192:207], a[88:91], v[32:35], v[192:207]
    v_exp_f32 v96, v96
    v_exp_f32 v97, v97
    v_exp_f32 v98, v98
    v_exp_f32 v99, v99
    v_cvt_pk_bf16_f32 v40, v96, v97
    v_exp_f32 v100, v100
    v_exp_f32 v101, v101
    v_cvt_pk_bf16_f32 v41, v98, v99
    v_exp_f32 v102, v102
    v_exp_f32 v103, v103
    v_cvt_pk_bf16_f32 v42, v100, v101
    s_add_u32 m0, s58, 16384
    s_add_u32 s60, s42, 458752
    buffer_load_dwordx4 v15, s[16:19], s60 offen lds
    v_cvt_pk_bf16_f32 v43, v102, v103
    v_mfma_f32_32x32x16_bf16 v[192:207], a[92:95], v[36:39], v[192:207]
    v_exp_f32 v104, v104
    v_exp_f32 v105, v105
    v_exp_f32 v106, v106
    v_exp_f32 v107, v107
    v_cvt_pk_bf16_f32 v44, v104, v105
    v_exp_f32 v108, v108
    v_exp_f32 v109, v109
    v_cvt_pk_bf16_f32 v45, v106, v107
    v_exp_f32 v110, v110
    v_exp_f32 v111, v111
    v_cvt_pk_bf16_f32 v46, v108, v109
    s_add_u32 m0, s58, 73728
    s_add_u32 s60, s42, 458752
    buffer_load_dwordx4 v6, s[20:23], s60 offen lds
    v_cvt_pk_bf16_f32 v47, v110, v111
    ds_read_b128 a[8:11], v12 offset:2048
    ds_read_b128 a[12:15], v12 offset:3072
    v_pk_add_f32 v[112:113], v[112:113], v[10:11] op_sel_hi:[1,0]
    v_pk_add_f32 v[114:115], v[114:115], v[10:11] op_sel_hi:[1,0]
    v_pk_add_f32 v[116:117], v[116:117], v[10:11] op_sel_hi:[1,0]
    v_pk_add_f32 v[118:119], v[118:119], v[10:11] op_sel_hi:[1,0]
    v_pk_add_f32 v[120:121], v[120:121], v[10:11] op_sel_hi:[1,0]
    v_pk_add_f32 v[122:123], v[122:123], v[10:11] op_sel_hi:[1,0]
    v_pk_add_f32 v[124:125], v[124:125], v[10:11] op_sel_hi:[1,0]
    v_pk_add_f32 v[126:127], v[126:127], v[10:11] op_sel_hi:[1,0]
    s_waitcnt lgkmcnt(10)
    v_mfma_f32_32x32x16_bf16 v[192:207], a[96:99], v[40:43], v[192:207]
    v_exp_f32 v112, v112
    v_exp_f32 v113, v113
    v_exp_f32 v114, v114
    v_exp_f32 v115, v115
    v_cvt_pk_bf16_f32 v32, v112, v113
    v_exp_f32 v116, v116
    v_exp_f32 v117, v117
    v_cvt_pk_bf16_f32 v33, v114, v115
    v_exp_f32 v118, v118
    v_exp_f32 v119, v119
    v_cvt_pk_bf16_f32 v34, v116, v117
    s_add_u32 m0, s58, 20480
    s_add_u32 s60, s42, 573440
    buffer_load_dwordx4 v15, s[16:19], s60 offen lds
    v_cvt_pk_bf16_f32 v35, v118, v119
    v_mfma_f32_32x32x16_bf16 v[192:207], a[100:103], v[44:47], v[192:207]
    v_exp_f32 v120, v120
    v_exp_f32 v121, v121
    v_exp_f32 v122, v122
    v_exp_f32 v123, v123
    v_cvt_pk_bf16_f32 v36, v120, v121
    v_exp_f32 v124, v124
    v_exp_f32 v125, v125
    v_cvt_pk_bf16_f32 v37, v122, v123
    v_exp_f32 v126, v126
    v_exp_f32 v127, v127
    v_cvt_pk_bf16_f32 v38, v124, v125
    s_add_u32 m0, s58, 77824
    s_add_u32 s60, s42, 573440
    buffer_load_dwordx4 v6, s[20:23], s60 offen lds
    v_cvt_pk_bf16_f32 v39, v126, v127
    v_pk_add_f32 v[128:129], v[128:129], v[10:11] op_sel_hi:[1,0]
    v_pk_add_f32 v[130:131], v[130:131], v[10:11] op_sel_hi:[1,0]
    v_pk_add_f32 v[132:133], v[132:133], v[10:11] op_sel_hi:[1,0]
    v_pk_add_f32 v[134:135], v[134:135], v[10:11] op_sel_hi:[1,0]
    v_pk_add_f32 v[136:137], v[136:137], v[10:11] op_sel_hi:[1,0]
    v_pk_add_f32 v[138:139], v[138:139], v[10:11] op_sel_hi:[1,0]
    v_pk_add_f32 v[140:141], v[140:141], v[10:11] op_sel_hi:[1,0]
    v_pk_add_f32 v[142:143], v[142:143], v[10:11] op_sel_hi:[1,0]
    s_waitcnt lgkmcnt(8)
    v_mfma_f32_32x32x16_bf16 v[192:207], a[104:107], v[32:35], v[192:207]
    v_exp_f32 v128, v128
    v_exp_f32 v129, v129
    v_exp_f32 v130, v130
    v_exp_f32 v131, v131
    v_cvt_pk_bf16_f32 v40, v128, v129
    v_exp_f32 v132, v132
    v_exp_f32 v133, v133
    v_cvt_pk_bf16_f32 v41, v130, v131
    v_exp_f32 v134, v134
    v_exp_f32 v135, v135
    v_cvt_pk_bf16_f32 v42, v132, v133
    s_add_u32 m0, s58, 24576
    s_add_u32 s60, s42, 688128
    buffer_load_dwordx4 v15, s[16:19], s60 offen lds
    v_cvt_pk_bf16_f32 v43, v134, v135
    v_mfma_f32_32x32x16_bf16 v[192:207], a[108:111], v[36:39], v[192:207]
    v_exp_f32 v136, v136
    v_exp_f32 v137, v137
    v_exp_f32 v138, v138
    v_exp_f32 v139, v139
    v_cvt_pk_bf16_f32 v44, v136, v137
    v_exp_f32 v140, v140
    v_exp_f32 v141, v141
    v_cvt_pk_bf16_f32 v45, v138, v139
    v_exp_f32 v142, v142
    v_exp_f32 v143, v143
    v_cvt_pk_bf16_f32 v46, v140, v141
    s_add_u32 m0, s58, 81920
    s_add_u32 s60, s42, 688128
    buffer_load_dwordx4 v6, s[20:23], s60 offen lds
    v_cvt_pk_bf16_f32 v47, v142, v143
    v_pk_add_f32 v[144:145], v[144:145], v[10:11] op_sel_hi:[1,0]
    v_pk_add_f32 v[146:147], v[146:147], v[10:11] op_sel_hi:[1,0]
    v_pk_add_f32 v[148:149], v[148:149], v[10:11] op_sel_hi:[1,0]
    v_pk_add_f32 v[150:151], v[150:151], v[10:11] op_sel_hi:[1,0]
    v_pk_add_f32 v[152:153], v[152:153], v[10:11] op_sel_hi:[1,0]
    v_pk_add_f32 v[154:155], v[154:155], v[10:11] op_sel_hi:[1,0]
    v_pk_add_f32 v[156:157], v[156:157], v[10:11] op_sel_hi:[1,0]
    v_pk_add_f32 v[158:159], v[158:159], v[10:11] op_sel_hi:[1,0]
    s_waitcnt lgkmcnt(6)
    v_mfma_f32_32x32x16_bf16 v[192:207], a[112:115], v[40:43], v[192:207]
    v_exp_f32 v144, v144
    v_exp_f32 v145, v145
    v_exp_f32 v146, v146
    v_exp_f32 v147, v147
    v_cvt_pk_bf16_f32 v32, v144, v145
    v_exp_f32 v148, v148
    v_exp_f32 v149, v149
    v_cvt_pk_bf16_f32 v33, v146, v147
    v_exp_f32 v150, v150
    v_exp_f32 v151, v151
    v_cvt_pk_bf16_f32 v34, v148, v149
    v_cvt_pk_bf16_f32 v35, v150, v151
    v_mfma_f32_32x32x16_bf16 v[192:207], a[116:119], v[44:47], v[192:207]
    v_exp_f32 v152, v152
    v_exp_f32 v153, v153
    v_exp_f32 v154, v154
    v_exp_f32 v155, v155
    v_cvt_pk_bf16_f32 v36, v152, v153
    v_exp_f32 v156, v156
    v_exp_f32 v157, v157
    v_cvt_pk_bf16_f32 v37, v154, v155
    v_exp_f32 v158, v158
    v_exp_f32 v159, v159
    v_cvt_pk_bf16_f32 v38, v156, v157
    v_cvt_pk_bf16_f32 v39, v158, v159
    v_pk_add_f32 v[160:161], v[160:161], v[10:11] op_sel_hi:[1,0]
    v_pk_add_f32 v[162:163], v[162:163], v[10:11] op_sel_hi:[1,0]
    v_pk_add_f32 v[164:165], v[164:165], v[10:11] op_sel_hi:[1,0]
    v_pk_add_f32 v[166:167], v[166:167], v[10:11] op_sel_hi:[1,0]
    v_pk_add_f32 v[168:169], v[168:169], v[10:11] op_sel_hi:[1,0]
    v_pk_add_f32 v[170:171], v[170:171], v[10:11] op_sel_hi:[1,0]
    v_pk_add_f32 v[172:173], v[172:173], v[10:11] op_sel_hi:[1,0]
    v_pk_add_f32 v[174:175], v[174:175], v[10:11] op_sel_hi:[1,0]
    s_waitcnt lgkmcnt(4)
    v_mfma_f32_32x32x16_bf16 v[192:207], a[120:123], v[32:35], v[192:207]
    v_exp_f32 v160, v160
    v_exp_f32 v161, v161
    v_exp_f32 v162, v162
    v_exp_f32 v163, v163
    v_cvt_pk_bf16_f32 v40, v160, v161
    v_exp_f32 v164, v164
    v_exp_f32 v165, v165
    v_cvt_pk_bf16_f32 v41, v162, v163
    v_exp_f32 v166, v166
    v_exp_f32 v167, v167
    v_cvt_pk_bf16_f32 v42, v164, v165
    v_cvt_pk_bf16_f32 v43, v166, v167
    v_mfma_f32_32x32x16_bf16 v[192:207], a[124:127], v[36:39], v[192:207]
    v_exp_f32 v168, v168
    v_exp_f32 v169, v169
    v_exp_f32 v170, v170
    v_exp_f32 v171, v171
    v_cvt_pk_bf16_f32 v44, v168, v169
    v_exp_f32 v172, v172
    v_exp_f32 v173, v173
    v_cvt_pk_bf16_f32 v45, v170, v171
    v_exp_f32 v174, v174
    v_exp_f32 v175, v175
    v_cvt_pk_bf16_f32 v46, v172, v173
    v_cvt_pk_bf16_f32 v47, v174, v175
    v_and_b32 v176, v40, v16
    v_xor_b32 v184, v40, v176
    v_and_b32 v177, v41, v17
    v_xor_b32 v185, v41, v177
    v_and_b32 v178, v42, v18
    v_xor_b32 v186, v42, v178
    v_and_b32 v179, v43, v19
    v_xor_b32 v187, v43, v179
    s_waitcnt lgkmcnt(2)
    v_mfma_f32_32x32x16_bf16 v[192:207], a[0:3], v[176:179], v[192:207]
    v_and_b32 v180, v44, v20
    v_xor_b32 v188, v44, v180
    v_and_b32 v181, v45, v21
    v_xor_b32 v189, v45, v181
    v_and_b32 v182, v46, v22
    v_xor_b32 v190, v46, v182
    v_and_b32 v183, v47, v23
    v_xor_b32 v191, v47, v183
    s_waitcnt lgkmcnt(0)
    v_mfma_f32_32x32x16_bf16 v[192:207], a[8:11], v[184:187], v[192:207]
    v_mfma_f32_32x32x16_bf16 v[192:207], a[4:7], v[180:183], v[192:207]
    v_mfma_f32_32x32x16_bf16 v[192:207], a[12:15], v[188:191], v[192:207]
    s_lshl_b32 s54, s38, 9
    s_add_u32 s54, s54, s40
    s_add_u32 s54, s54, 0
    s_bitcmp1_b32 s36, 0
    s_cselect_b64 s[98:99], -1, 0
    s_nop 6
    v_cndmask_b32 v8, v204, v192, s[98:99]
    v_mov_b32 v9, v8
    s_nop 1
    v_permlane32_swap_b32 v9, v8
    v_cndmask_b32 v8, v8, v9, s[98:99]
    v_rcp_f32 v8, v8
    s_nop 0
    v_mul_f32 v192, v8, v192
    v_mul_f32 v193, v8, v193
    v_mul_f32 v194, v8, v194
    v_mul_f32 v195, v8, v195
    v_mul_f32 v196, v8, v196
    v_mul_f32 v197, v8, v197
    v_mul_f32 v198, v8, v198
    v_mul_f32 v199, v8, v199
    v_mul_f32 v200, v8, v200
    v_mul_f32 v201, v8, v201
    v_mul_f32 v202, v8, v202
    v_mul_f32 v203, v8, v203
    v_mul_f32 v204, v8, v204
    v_mul_f32 v205, v8, v205
    v_mul_f32 v206, v8, v206
    v_mul_f32 v207, v8, v207
    v_cvt_pk_bf16_f32 v176, v192, v193
    v_cvt_pk_bf16_f32 v177, v194, v195
    v_cvt_pk_bf16_f32 v178, v196, v197
    v_cvt_pk_bf16_f32 v179, v198, v199
    v_cvt_pk_bf16_f32 v180, v200, v201
    v_cvt_pk_bf16_f32 v181, v202, v203
    v_cvt_pk_bf16_f32 v182, v204, v205
    v_cvt_pk_bf16_f32 v183, v206, v207
    s_cbranch_scc1 L_odd_11
    buffer_store_dwordx4 v[176:179], v1, s[32:35], s54 offen
    s_mov_b32 exec_hi, 0
    buffer_store_dwordx4 v[180:183], v1, s[32:35], s54 offen offset:1024
    s_not_b64 exec, exec
    buffer_store_dwordx2 v[180:181], v1, s[32:35], s54 offen offset:1024
    s_branch L_ost_12
L_odd_11:
    buffer_store_dwordx4 v[180:183], v1, s[32:35], s54 offen offset:1024
    s_mov_b32 exec_lo, 0
    buffer_store_dwordx4 v[176:179], v1, s[32:35], s54 offen
    s_not_b64 exec, exec
    buffer_store_dwordx2 v[178:179], v1, s[32:35], s54 offen offset:8
L_ost_12:
    s_mov_b64 exec, -1
    s_cmp_lt_u32 s45, 28
    s_cbranch_scc1 L_comp_13
    s_lshl2_add_u32 s53, s45, s46
    s_lshl2_add_u32 s53, s53, 946688
    v_mov_b32 v8, s53
    v_mov_b32 v9, s47
    s_waitcnt vmcnt(0)
    s_mov_b64 exec, 1
    buffer_store_dword v9, v8, s[32:35], s48 offen
    s_mov_b64 exec, -1
    s_branch L_helper_tail
L_comp_13:
    v_mov_b32 v5, v15
    s_lshl2_add_u32 s53, s45, s46
    s_lshl2_add_u32 s53, s53, 946688
    v_mov_b32 v8, s53
    v_mov_b32 v9, s47
    s_waitcnt vmcnt(0)
    s_mov_b64 exec, 1
    buffer_store_dword v9, v8, s[32:35], s48 offen
    s_mov_b64 exec, -1
    v_xor_b32 v255, s47, v233
    v_bitop3_b32 v255, v255, v235, s47 bitop3:0xf6
    v_bitop3_b32 v255, v255, v237, s47 bitop3:0xf6
    v_bitop3_b32 v255, v255, v239, s47 bitop3:0xf6
    v_cmp_ne_u32 vcc, 0, v255
    s_cbranch_vccnz L_chk_14
L_chk_14_back:
    v_lshlrev_b32 v18, 16, v236
    v_and_b32 v19, 0xffff0000, v236
    v_add_f32 v18, 1.0, v18
    v_add_f32 v19, 1.0, v19
    v_cvt_pk_bf16_f32 v236, v18, v19
    v_lshrrev_b32 v10, 1, v240
    v_add_u32 v10, 159744, v10
    s_barrier
    ds_write_b32 v10, v232 offset:0
    ds_write_b32 v10, v234 offset:896
    ds_write_b32 v10, v236 offset:1792
    ds_write_b32 v10, v238 offset:2688
    s_lshl_b32 s54, s50, 1
    s_add_u32 s54, s54, s62
    s_lshl_b32 s54, s54, 6
    s_mul_i32 s55, s63, 28672
    s_add_u32 s55, s55, s48
    s_mul_i32 s56, s62, 14336
    s_add_u32 s56, s56, s55
    s_add_u32 s56, s56, 0
    v_and_b32 v8, 0xf0, v1
    s_lshr_b32 s53, s63, 2
    s_lshl_b32 s53, s53, 6
    s_and_b32 s59, s63, 3
    s_add_u32 s53, s53, s59
    s_lshl2_add_u32 s53, s53, s48
    s_add_u32 s53, s53, 946688
    s_mov_b32 s52, 0
    buffer_load_dword v10, v8, s[32:35], s53 offen sc1
L_poll_15:
    s_waitcnt vmcnt(0)
    v_cmp_ne_u32 vcc, s47, v10
    s_cbranch_vccnz L_poll_15_again
    buffer_load_dwordx4 a[0:3], v1, s[32:35], s56 offen offset:0 sc1
    buffer_load_dwordx4 a[4:7], v1, s[32:35], s56 offen offset:1024 sc1
    buffer_load_dwordx4 a[8:11], v1, s[32:35], s56 offen offset:2048 sc1
    buffer_load_dwordx4 a[12:15], v1, s[32:35], s56 offen offset:3072 sc1
    s_add_u32 s56, s56, 4096
    buffer_load_dwordx4 a[16:19], v1, s[32:35], s56 offen offset:0 sc1
    buffer_load_dwordx4 a[20:23], v1, s[32:35], s56 offen offset:1024 sc1
    buffer_load_dwordx4 a[24:27], v1, s[32:35], s56 offen offset:2048 sc1
    buffer_load_dwordx4 a[28:31], v1, s[32:35], s56 offen offset:3072 sc1
    s_waitcnt lgkmcnt(0)
    s_barrier
    v_lshl_add_u32 v8, v4, 4, s54
    v_add_u32 v8, 159744, v8
    ds_read_b128 v[12:15], v8 offset:0
    ds_read_b128 v[20:23], v8 offset:1792
    ds_read_b128 v[16:19], v8 offset:32
    ds_read_b128 v[24:27], v8 offset:1824
    s_lshl_b32 s53, s61, 5
    v_add_u32 v8, s53, v8
    ds_read_b128 v[248:251], v8 offset:2688
    s_waitcnt vmcnt(7)
    v_mfma_f32_32x32x16_bf16 v[32:47], a[128:131], a[0:3], 0
    s_add_u32 s56, s56, 4096
    buffer_load_dwordx4 a[32:35], v1, s[32:35], s56 offen offset:0 sc1
    v_lshlrev_b32 v104, 16, v224
    v_and_b32 v105, 0xffff0000, v224
    v_lshlrev_b32 v106, 16, v225
    v_mfma_f32_32x32x16_bf16 v[48:63], a[132:135], a[0:3], 0
    v_and_b32 v107, 0xffff0000, v225
    v_lshlrev_b32 v108, 16, v226
    v_and_b32 v109, 0xffff0000, v226
    s_waitcnt vmcnt(7)
    v_mfma_f32_32x32x16_bf16 v[32:47], a[136:139], a[4:7], v[32:47]
    buffer_load_dwordx4 a[36:39], v1, s[32:35], s56 offen offset:1024 sc1
    v_lshlrev_b32 v110, 16, v227
    v_and_b32 v111, 0xffff0000, v227
    v_lshlrev_b32 v112, 16, v228
    v_mfma_f32_32x32x16_bf16 v[48:63], a[140:143], a[4:7], v[48:63]
    v_and_b32 v113, 0xffff0000, v228
    v_lshlrev_b32 v114, 16, v229
    v_and_b32 v115, 0xffff0000, v229
    s_waitcnt vmcnt(7)
    v_mfma_f32_32x32x16_bf16 v[32:47], a[144:147], a[8:11], v[32:47]
    buffer_load_dwordx4 a[40:43], v1, s[32:35], s56 offen offset:2048 sc1
    v_lshlrev_b32 v116, 16, v230
    v_and_b32 v117, 0xffff0000, v230
    v_lshlrev_b32 v118, 16, v231
    v_mfma_f32_32x32x16_bf16 v[48:63], a[148:151], a[8:11], v[48:63]
    v_and_b32 v119, 0xffff0000, v231
    s_waitcnt lgkmcnt(0)
    v_lshlrev_b32 v64, 16, v12
    s_waitcnt vmcnt(7)
    v_mfma_f32_32x32x16_bf16 v[32:47], a[152:155], a[12:15], v[32:47]
    buffer_load_dwordx4 a[44:47], v1, s[32:35], s56 offen offset:3072 sc1
    v_and_b32 v65, 0xffff0000, v12
    v_lshlrev_b32 v66, 16, v13
    v_and_b32 v67, 0xffff0000, v13
    v_mfma_f32_32x32x16_bf16 v[48:63], a[156:159], a[12:15], v[48:63]
    v_lshlrev_b32 v68, 16, v14
    v_and_b32 v69, 0xffff0000, v14
    v_lshlrev_b32 v70, 16, v15
    s_waitcnt vmcnt(7)
    v_mfma_f32_32x32x16_bf16 v[32:47], a[160:163], a[16:19], v[32:47]
    s_add_u32 s56, s56, 4096
    buffer_load_dwordx4 a[48:51], v1, s[32:35], s56 offen offset:0 sc1
    v_and_b32 v71, 0xffff0000, v15
    v_lshlrev_b32 v72, 16, v16
    v_and_b32 v73, 0xffff0000, v16
    v_mfma_f32_32x32x16_bf16 v[48:63], a[164:167], a[16:19], v[48:63]
    v_lshlrev_b32 v74, 16, v17
    v_and_b32 v75, 0xffff0000, v17
    v_lshlrev_b32 v76, 16, v18
    s_waitcnt vmcnt(7)
    v_mfma_f32_32x32x16_bf16 v[32:47], a[168:171], a[20:23], v[32:47]
    buffer_load_dwordx4 a[52:55], v1, s[32:35], s56 offen offset:1024 sc1
    v_and_b32 v77, 0xffff0000, v18
    v_lshlrev_b32 v78, 16, v19
    v_and_b32 v79, 0xffff0000, v19
    v_mfma_f32_32x32x16_bf16 v[48:63], a[172:175], a[20:23], v[48:63]
    v_lshlrev_b32 v80, 16, v20
    v_and_b32 v81, 0xffff0000, v20
    v_lshlrev_b32 v82, 16, v21
    s_waitcnt vmcnt(7)
    v_mfma_f32_32x32x16_bf16 v[32:47], a[176:179], a[24:27], v[32:47]
    s_add_u32 m0, s58, 28672
    s_add_u32 s60, s42, 802816
    buffer_load_dwordx4 v5, s[16:19], s60 offen lds
    v_and_b32 v83, 0xffff0000, v21
    v_lshlrev_b32 v84, 16, v22
    v_and_b32 v85, 0xffff0000, v22
    v_mfma_f32_32x32x16_bf16 v[48:63], a[180:183], a[24:27], v[48:63]
    s_add_u32 m0, s58, 86016
    s_add_u32 s60, s42, 802816
    buffer_load_dwordx4 v6, s[20:23], s60 offen lds
    v_lshlrev_b32 v86, 16, v23
    v_and_b32 v87, 0xffff0000, v23
    v_lshlrev_b32 v88, 16, v24
    s_waitcnt vmcnt(8)
    v_mfma_f32_32x32x16_bf16 v[32:47], a[184:187], a[28:31], v[32:47]
    s_add_u32 m0, s58, 32768
    s_add_u32 s60, s42, 917504
    buffer_load_dwordx4 v5, s[16:19], s60 offen lds
    v_and_b32 v89, 0xffff0000, v24
    v_lshlrev_b32 v90, 16, v25
    v_and_b32 v91, 0xffff0000, v25
    v_mfma_f32_32x32x16_bf16 v[48:63], a[188:191], a[28:31], v[48:63]
    s_add_u32 m0, s58, 90112
    s_add_u32 s60, s42, 917504
    buffer_load_dwordx4 v6, s[20:23], s60 offen lds
    v_lshlrev_b32 v92, 16, v26
    v_and_b32 v93, 0xffff0000, v26
    v_lshlrev_b32 v94, 16, v27
    s_waitcnt vmcnt(9)
    v_mfma_f32_32x32x16_bf16 v[32:47], a[192:195], a[32:35], v[32:47]
    v_and_b32 v95, 0xffff0000, v27
    s_lshl_b32 s53, s46, 12
    s_add_u32 s53, s53, 114688
    v_mfma_f32_32x32x16_bf16 v[48:63], a[196:199], a[32:35], v[48:63]
    v_add_u32 v26, s53, v1
    v_xor_b32 v27, 4096, v26
    s_lshl_b32 s53, s46, 11
    s_waitcnt vmcnt(8)
    v_mfma_f32_32x32x16_bf16 v[32:47], a[200:203], a[36:39], v[32:47]
    s_add_u32 s53, s53, 131072
    v_add_u32 v29, s53, v1
    s_lshl_b32 s53, s54, 5
    v_mfma_f32_32x32x16_bf16 v[48:63], a[204:207], a[36:39], v[48:63]
    s_add_u32 s57, s53, s55
    s_add_u32 s57, s57, 688128
    s_lshl_b32 s59, s63, 8
    s_waitcnt vmcnt(7)
    v_mfma_f32_32x32x16_bf16 v[32:47], a[208:211], a[40:43], v[32:47]
    s_add_u32 s59, s59, s53
    s_add_u32 s59, s59, s48
    s_add_u32 s59, s59, 917504
    v_mfma_f32_32x32x16_bf16 v[48:63], a[212:215], a[40:43], v[48:63]
    v_bfe_u32 v28, v1, 1, 8
    v_lshl_add_u32 v28, v4, 2, v28
    s_waitcnt vmcnt(6)
    v_mfma_f32_32x32x16_bf16 v[32:47], a[216:219], a[44:47], v[32:47]
    v_mfma_f32_32x32x16_bf16 v[48:63], a[220:223], a[44:47], v[48:63]
    s_waitcnt vmcnt(5)
    v_mfma_f32_32x32x16_bf16 v[32:47], a[224:227], a[48:51], v[32:47]
    v_mfma_f32_32x32x16_bf16 v[48:63], a[228:231], a[48:51], v[48:63]
    s_waitcnt vmcnt(4)
    v_mfma_f32_32x32x16_bf16 v[32:47], a[232:235], a[52:55], v[32:47]
    v_mfma_f32_32x32x16_bf16 v[48:63], a[236:239], a[52:55], v[48:63]
    s_nop 11
    ds_write_b128 v26, v[48:51] offset:0
    ds_write_b128 v26, v[52:55] offset:1024
    ds_write_b128 v26, v[56:59] offset:2048
    ds_write_b128 v26, v[60:63] offset:3072
    s_waitcnt lgkmcnt(0)
    s_barrier
    ds_read_b128 v[48:51], v27 offset:0
    ds_read_b128 v[52:55], v27 offset:1024
    ds_read_b128 v[56:59], v27 offset:2048
    ds_read_b128 v[60:63], v27 offset:3072
    s_waitcnt lgkmcnt(3)
    v_pk_add_f32 v[32:33], v[32:33], v[48:49]
    v_pk_add_f32 v[34:35], v[34:35], v[50:51]
    s_waitcnt lgkmcnt(2)
    v_pk_add_f32 v[36:37], v[36:37], v[52:53]
    v_pk_add_f32 v[38:39], v[38:39], v[54:55]
    s_waitcnt lgkmcnt(1)
    v_pk_add_f32 v[40:41], v[40:41], v[56:57]
    v_pk_add_f32 v[42:43], v[42:43], v[58:59]
    s_waitcnt lgkmcnt(0)
    v_pk_add_f32 v[44:45], v[44:45], v[60:61]
    v_pk_add_f32 v[46:47], v[46:47], v[62:63]
    v_pk_fma_f32 v[32:33], v[32:33], v[64:65], v[104:105]
    v_pk_fma_f32 v[34:35], v[34:35], v[66:67], v[106:107]
    v_pk_fma_f32 v[36:37], v[36:37], v[68:69], v[108:109]
    v_pk_fma_f32 v[38:39], v[38:39], v[70:71], v[110:111]
    v_pk_fma_f32 v[40:41], v[40:41], v[72:73], v[112:113]
    v_pk_fma_f32 v[42:43], v[42:43], v[74:75], v[114:115]
    v_pk_fma_f32 v[44:45], v[44:45], v[76:77], v[116:117]
    v_pk_fma_f32 v[46:47], v[46:47], v[78:79], v[118:119]
    v_pk_mul_f32 v[48:49], v[32:33], v[80:81]
    v_pk_mul_f32 v[50:51], v[34:35], v[82:83]
    v_pk_mul_f32 v[52:53], v[36:37], v[84:85]
    v_pk_mul_f32 v[54:55], v[38:39], v[86:87]
    v_pk_mul_f32 v[56:57], v[40:41], v[88:89]
    v_pk_mul_f32 v[58:59], v[42:43], v[90:91]
    v_pk_mul_f32 v[60:61], v[44:45], v[92:93]
    v_pk_mul_f32 v[62:63], v[46:47], v[94:95]
    v_cvt_pk_bf16_f32 v12, v48, v49
    v_cvt_pk_bf16_f32 v13, v50, v51
    v_cvt_pk_bf16_f32 v14, v52, v53
    v_cvt_pk_bf16_f32 v15, v54, v55
    buffer_store_dwordx4 v[12:15], v1, s[32:35], s57 offen offset:0
    v_cvt_pk_bf16_f32 v16, v56, v57
    v_cvt_pk_bf16_f32 v17, v58, v59
    v_cvt_pk_bf16_f32 v18, v60, v61
    v_cvt_pk_bf16_f32 v19, v62, v63
    buffer_store_dwordx4 v[16:19], v1, s[32:35], s57 offen offset:1024
    v_pk_mul_f32 v[22:23], v[32:33], v[32:33]
    v_pk_add_f32 v[20:21], v[32:33], v[34:35]
    v_pk_fma_f32 v[22:23], v[34:35], v[34:35], v[22:23]
    v_pk_add_f32 v[20:21], v[20:21], v[36:37]
    v_pk_fma_f32 v[22:23], v[36:37], v[36:37], v[22:23]
    v_pk_add_f32 v[20:21], v[20:21], v[38:39]
    v_pk_fma_f32 v[22:23], v[38:39], v[38:39], v[22:23]
    v_pk_add_f32 v[20:21], v[20:21], v[40:41]
    v_pk_fma_f32 v[22:23], v[40:41], v[40:41], v[22:23]
    v_pk_add_f32 v[20:21], v[20:21], v[42:43]
    v_pk_fma_f32 v[22:23], v[42:43], v[42:43], v[22:23]
    v_pk_add_f32 v[20:21], v[20:21], v[44:45]
    v_pk_fma_f32 v[22:23], v[44:45], v[44:45], v[22:23]
    v_pk_add_f32 v[20:21], v[20:21], v[46:47]
    v_pk_fma_f32 v[22:23], v[46:47], v[46:47], v[22:23]
    v_add_f32 v20, v20, v21
    v_add_f32 v21, v22, v23
    s_nop 1
    v_permlane32_swap_b32 v20, v21
    v_add_f32 v20, v20, v21
    buffer_store_dword v20, v28, s[32:35], s59 offen
    v_cvt_pk_bf16_f32 v240, v32, v33
    v_cvt_pk_bf16_f32 v241, v34, v35
    v_cvt_pk_bf16_f32 v242, v36, v37
    v_cvt_pk_bf16_f32 v243, v38, v39
    v_cvt_pk_bf16_f32 v244, v40, v41
    v_cvt_pk_bf16_f32 v245, v42, v43
    v_cvt_pk_bf16_f32 v246, v44, v45
    v_cvt_pk_bf16_f32 v247, v46, v47
    ds_write_b128 v29, v[240:243] offset:0
    ds_write_b128 v29, v[244:247] offset:1024
    s_lshl2_add_u32 s53, s45, s46
    s_lshl2_add_u32 s53, s53, 947200
    v_mov_b32 v8, s53
    v_mov_b32 v9, s47
    s_waitcnt vmcnt(0)
    s_mov_b64 exec, 1
    buffer_store_dword v9, v8, s[32:35], s48 offen
    s_mov_b64 exec, -1
    v_lshrrev_b32 v8, 4, v1
    v_bfe_u32 v9, v8, 2, 2
    v_lshrrev_b32 v10, 5, v8
    v_lshl_add_u32 v10, v10, 3, v9
    v_lshlrev_b32 v12, 7, v10
    v_lshrrev_b32 v9, 1, v9
    v_lshlrev_b32 v9, 6, v9
    v_and_b32 v10, 1, v8
    v_lshlrev_b32 v10, 4, v10
    v_xor_b32 v9, v9, v10
    v_and_b32 v10, 2, v8
    v_lshlrev_b32 v10, 2, v10
    v_xor_b32 v9, v9, v10
    v_and_b32 v10, 16, v8
    v_lshlrev_b32 v10, 1, v10
    v_xor_b32 v9, v9, v10
    v_add_u32 v12, v12, v9
    v_bfe_u32 v8, v1, 8, 1
    v_mul_u32_u24 v8, 57344, v8
    s_mul_i32 s53, s46, 10240
    s_add_u32 s37, s53, 114688
    s_lshl_b32 s53, s62, 6
    s_lshl_b32 s54, s61, 5
    s_add_u32 s53, s53, s54
    v_xor_b32 v28, s53, v12
    v_add_u32 v28, s37, v28
    v_xor_b32 v29, 64, v28
    v_add_u32 v12, v12, v8
    v_xor_b32 v13, 32, v12
    v_xor_b32 v14, 64, v12
    v_xor_b32 v15, 96, v12
    s_lshl_b32 s53, s62, 11
    s_lshl_b32 s54, s61, 10
    s_add_u32 s53, s53, s54
    s_add_u32 s53, s53, 131072
    v_add_u32 v8, s53, v1
    s_waitcnt lgkmcnt(0)
    s_barrier
    ds_read_b128 v[240:243], v8 offset:0
    ds_read_b128 v[244:247], v8 offset:4096
    v_lshrrev_b32 v8, 7, v1
    v_mul_u32_u24 v2, 896, v8
    v_and_b32 v8, 2, v8
    v_lshlrev_b32 v8, 5, v8
    v_and_b32 v9, 0x70, v1
    v_xor_b32 v8, v8, v9
    v_add_u32 v2, v2, v8
    s_lshl_b32 s53, s50, 7
    s_mul_i32 s54, s46, 401408
    s_add_u32 s57, s53, s54
    s_sub_u32 s57, s57, 14336
    v_add_u32 v0, 6144, v2
    s_mul_i32 s40, s46, 57344
    s_add_u32 s40, s40, s48
    s_add_u32 s40, s40, 688128
    v_and_b32 v30, 0x1f0, v1
    v_lshrrev_b32 v30, 1, v30
    v_mul_u32_u24 v8, 14336, v4
    v_add_u32 v30, v30, v8
    s_lshl_b32 s54, s46, 9
    s_add_u32 s54, s54, s48
    s_add_u32 s41, s54, 917504
    s_mov_b32 s100, 0x01000100
    s_mov_b32 s101, 0x07060302
    s_lshl_b32 s36, s45, 12
    s_add_u32 s36, s36, 131072
    s_mov_b32 s55, 0xffff
    s_mul_i32 s56, s46, 229376
    s_add_u32 s56, s56, s48
    s_lshl_b32 s54, s45, 12
    s_add_u32 s56, s56, s54
    s_add_u32 s56, s56, 1048576
    s_mul_i32 s59, s49, 229376
    s_mul_i32 s54, s46, 28672
    s_add_u32 s59, s59, s54
    s_add_u32 s59, s59, s48
    s_add_u32 s59, s59, 1048576
    v_min_u32 v31, 96, v1
    s_mul_i32 s53, s46, 112
    s_lshl_b32 s54, s49, 2
    s_add_u32 s53, s53, s54
    s_add_u32 s53, s53, 947712
    v_add_u32 v31, s53, v31
    s_mul_i32 s53, s61, 28640
    s_sub_u32 s51, s51, s53
    s_waitcnt lgkmcnt(0)
    s_barrier
    v_lshrrev_b32 v8, 2, v1
    v_min_u32 v8, 108, v8
    s_mul_i32 s53, s46, 112
    s_add_u32 s53, s53, s48
    s_add_u32 s53, s53, 947200
    s_mov_b32 s52, 0
    buffer_load_dword v10, v8, s[32:35], s53 offen sc1
L_poll_16:
    s_waitcnt vmcnt(0)
    v_cmp_ne_u32 vcc, s47, v10
    s_cbranch_vccnz L_poll_16_again
    s_lshl_b32 s53, s45, 4
    s_lshl_b32 s54, s46, 2
    s_add_u32 s53, s53, s54
    s_add_u32 s53, s53, 947712
    v_mov_b32 v10, s53
    v_mov_b32 v11, s47
    buffer_load_dwordx4 a[252:255], v1, s[32:35], s40 offen offset:0 sc1
    buffer_load_dwordx4 a[248:251], v1, s[32:35], s40 offen offset:1024 sc1
    buffer_load_dwordx4 a[244:247], v1, s[32:35], s40 offen offset:2048 sc1
    buffer_load_dwordx4 a[240:243], v1, s[32:35], s40 offen offset:3072 sc1
    s_add_u32 s40, s40, 4096
    buffer_load_dwordx4 a[236:239], v1, s[32:35], s40 offen offset:0 sc1
    ds_read_b64_tr_b16 v[160:161], v12 offset:0
    ds_read_b64_tr_b16 v[162:163], v12 offset:512
    ds_read_b64_tr_b16 v[164:165], v13 offset:0
    ds_read_b64_tr_b16 v[166:167], v13 offset:512
    ds_read_b64_tr_b16 v[168:169], v14 offset:0
    ds_read_b64_tr_b16 v[170:171], v14 offset:512
    ds_read_b64_tr_b16 v[172:173], v15 offset:0
    ds_read_b64_tr_b16 v[174:175], v15 offset:512
    ds_read_b64_tr_b16 v[176:177], v12 offset:2048
    ds_read_b64_tr_b16 v[178:179], v12 offset:2560
    ds_read_b64_tr_b16 v[180:181], v13 offset:2048
    ds_read_b64_tr_b16 v[182:183], v13 offset:2560
    s_waitcnt vmcnt(4) lgkmcnt(8)
    v_mfma_f32_32x32x16_bf16 v[32:47], v[160:163], a[252:255], 0
    buffer_load_dwordx4 a[232:235], v1, s[32:35], s40 offen offset:1024 sc1
    ds_read_b64_tr_b16 v[184:185], v14 offset:2048
    ds_read_b64_tr_b16 v[186:187], v14 offset:2560
    v_mfma_f32_32x32x16_bf16 v[48:63], v[164:167], a[252:255], 0
    buffer_load_dwordx4 a[228:231], v1, s[32:35], s40 offen offset:2048 sc1
    ds_read_b64_tr_b16 v[188:189], v15 offset:2048
    ds_read_b64_tr_b16 v[190:191], v15 offset:2560
    s_waitcnt lgkmcnt(8)
    v_mfma_f32_32x32x16_bf16 v[64:79], v[168:171], a[252:255], 0
    s_add_u32 m0, s58, 36864
    s_add_u32 s60, s42, 1032192
    ds_read_b64_tr_b16 v[192:193], v12 offset:4096
    ds_read_b64_tr_b16 v[194:195], v12 offset:4608
    buffer_load_dwordx4 v5, s[16:19], s60 offen lds
    s_add_u32 m0, s58, 94208
    s_nop 0
    v_mfma_f32_32x32x16_bf16 v[80:95], v[172:175], a[252:255], 0
    buffer_load_dwordx4 v6, s[20:23], s60 offen lds
    s_add_u32 m0, s58, 40960
    ds_read_b64_tr_b16 v[196:197], v13 offset:4096
    ds_read_b64_tr_b16 v[198:199], v13 offset:4608
    s_add_u32 s60, s42, 1146880
    s_waitcnt vmcnt(7) lgkmcnt(8)
    v_mfma_f32_32x32x16_bf16 v[32:47], v[176:179], a[248:251], v[32:47]
    buffer_load_dwordx4 v5, s[16:19], s60 offen lds
    s_add_u32 m0, s58, 98304
    s_nop 0
    ds_read_b64_tr_b16 v[200:201], v14 offset:4096
    ds_read_b64_tr_b16 v[202:203], v14 offset:4608
    buffer_load_dwordx4 v6, s[20:23], s60 offen lds
    v_mfma_f32_32x32x16_bf16 v[48:63], v[180:183], a[248:251], v[48:63]
    buffer_load_dwordx4 a[252:255], v1, s[32:35], s40 offen offset:3072 sc1
    ds_read_b64_tr_b16 v[204:205], v15 offset:4096
    ds_read_b64_tr_b16 v[206:207], v15 offset:4608
    s_waitcnt lgkmcnt(8)
    v_mfma_f32_32x32x16_bf16 v[64:79], v[184:187], a[248:251], v[64:79]
    s_add_u32 m0, s58, 45056
    s_add_u32 s60, s42, 1261568
    ds_read_b64_tr_b16 v[160:161], v12 offset:6144
    ds_read_b64_tr_b16 v[162:163], v12 offset:6656
    buffer_load_dwordx4 v5, s[16:19], s60 offen lds
    s_add_u32 m0, s58, 102400
    s_nop 0
    v_mfma_f32_32x32x16_bf16 v[80:95], v[188:191], a[248:251], v[80:95]
    buffer_load_dwordx4 v6, s[20:23], s60 offen lds
    ds_read_b64_tr_b16 v[164:165], v13 offset:6144
    ds_read_b64_tr_b16 v[166:167], v13 offset:6656
    s_waitcnt vmcnt(11) lgkmcnt(8)
    v_mfma_f32_32x32x16_bf16 v[32:47], v[192:195], a[244:247], v[32:47]
    ds_read_b64_tr_b16 v[168:169], v14 offset:6144
    ds_read_b64_tr_b16 v[170:171], v14 offset:6656
    v_mfma_f32_32x32x16_bf16 v[48:63], v[196:199], a[244:247], v[48:63]
    s_add_u32 s40, s40, 4096
    buffer_load_dwordx4 a[248:251], v1, s[32:35], s40 offen offset:0 sc1
    ds_read_b64_tr_b16 v[172:173], v15 offset:6144
    ds_read_b64_tr_b16 v[174:175], v15 offset:6656
    s_waitcnt lgkmcnt(8)
    v_mfma_f32_32x32x16_bf16 v[64:79], v[200:203], a[244:247], v[64:79]
    ds_read_b64_tr_b16 v[176:177], v12 offset:8192
    ds_read_b64_tr_b16 v[178:179], v12 offset:8704
    v_mfma_f32_32x32x16_bf16 v[80:95], v[204:207], a[244:247], v[80:95]
    ds_read_b64_tr_b16 v[180:181], v13 offset:8192
    ds_read_b64_tr_b16 v[182:183], v13 offset:8704
    s_waitcnt vmcnt(11) lgkmcnt(8)
    v_mfma_f32_32x32x16_bf16 v[32:47], v[160:163], a[240:243], v[32:47]
    ds_read_b64_tr_b16 v[184:185], v14 offset:8192
    ds_read_b64_tr_b16 v[186:187], v14 offset:8704
    v_mfma_f32_32x32x16_bf16 v[48:63], v[164:167], a[240:243], v[48:63]
    ds_read_b64_tr_b16 v[188:189], v15 offset:8192
    ds_read_b64_tr_b16 v[190:191], v15 offset:8704
    s_waitcnt lgkmcnt(8)
    v_mfma_f32_32x32x16_bf16 v[64:79], v[168:171], a[240:243], v[64:79]
    buffer_load_dwordx4 a[244:247], v1, s[32:35], s40 offen offset:1024 sc1
    ds_read_b64_tr_b16 v[192:193], v12 offset:10240
    ds_read_b64_tr_b16 v[194:195], v12 offset:10752
    v_mfma_f32_32x32x16_bf16 v[80:95], v[172:175], a[240:243], v[80:95]
    s_add_u32 m0, s58, 49152
    s_add_u32 s60, s42, 1376256
    ds_read_b64_tr_b16 v[196:197], v13 offset:10240
    ds_read_b64_tr_b16 v[198:199], v13 offset:10752
    buffer_load_dwordx4 v5, s[16:19], s60 offen lds
    s_waitcnt vmcnt(12) lgkmcnt(8)
    v_mfma_f32_32x32x16_bf16 v[32:47], v[176:179], a[236:239], v[32:47]
    s_add_u32 m0, s58, 106496
    s_nop 0
    ds_read_b64_tr_b16 v[200:201], v14 offset:10240
    ds_read_b64_tr_b16 v[202:203], v14 offset:10752
    buffer_load_dwordx4 v6, s[20:23], s60 offen lds
    v_mfma_f32_32x32x16_bf16 v[48:63], v[180:183], a[236:239], v[48:63]
    ds_read_b64_tr_b16 v[204:205], v15 offset:10240
    ds_read_b64_tr_b16 v[206:207], v15 offset:10752
    s_waitcnt lgkmcnt(8)
    v_mfma_f32_32x32x16_bf16 v[64:79], v[184:187], a[236:239], v[64:79]
    ds_read_b64_tr_b16 v[160:161], v12 offset:12288
    ds_read_b64_tr_b16 v[162:163], v12 offset:12800
    v_mfma_f32_32x32x16_bf16 v[80:95], v[188:191], a[236:239], v[80:95]
    buffer_load_dwordx4 a[240:243], v1, s[32:35], s40 offen offset:2048 sc1
    ds_read_b64_tr_b16 v[164:165], v13 offset:12288
    ds_read_b64_tr_b16 v[166:167], v13 offset:12800
    s_waitcnt vmcnt(13) lgkmcnt(8)
    v_mfma_f32_32x32x16_bf16 v[32:47], v[192:195], a[232:235], v[32:47]
    ds_read_b64_tr_b16 v[168:169], v14 offset:12288
    ds_read_b64_tr_b16 v[170:171], v14 offset:12800
    v_mfma_f32_32x32x16_bf16 v[48:63], v[196:199], a[232:235], v[48:63]
    buffer_load_dwordx4 a[236:239], v1, s[32:35], s40 offen offset:3072 sc1
    ds_read_b64_tr_b16 v[172:173], v15 offset:12288
    ds_read_b64_tr_b16 v[174:175], v15 offset:12800
    s_waitcnt lgkmcnt(8)
    v_mfma_f32_32x32x16_bf16 v[64:79], v[200:203], a[232:235], v[64:79]
    ds_read_b64_tr_b16 v[176:177], v12 offset:14336
    ds_read_b64_tr_b16 v[178:179], v12 offset:14848
    v_mfma_f32_32x32x16_bf16 v[80:95], v[204:207], a[232:235], v[80:95]
    s_add_u32 m0, s58, 53248
    s_add_u32 s60, s42, 1490944
    ds_read_b64_tr_b16 v[180:181], v13 offset:14336
    ds_read_b64_tr_b16 v[182:183], v13 offset:14848
    buffer_load_dwordx4 v5, s[16:19], s60 offen lds
    s_waitcnt vmcnt(14) lgkmcnt(8)
    v_mfma_f32_32x32x16_bf16 v[32:47], v[160:163], a[228:231], v[32:47]
    s_add_u32 m0, s58, 110592
    s_nop 0
    ds_read_b64_tr_b16 v[184:185], v14 offset:14336
    ds_read_b64_tr_b16 v[186:187], v14 offset:14848
    buffer_load_dwordx4 v6, s[20:23], s60 offen lds
    v_mfma_f32_32x32x16_bf16 v[48:63], v[164:167], a[228:231], v[48:63]
    ds_read_b64_tr_b16 v[188:189], v15 offset:14336
    ds_read_b64_tr_b16 v[190:191], v15 offset:14848
    s_waitcnt lgkmcnt(8)
    v_mfma_f32_32x32x16_bf16 v[64:79], v[168:171], a[228:231], v[64:79]
    s_add_u32 s40, s40, 4096
    buffer_load_dwordx4 a[232:235], v1, s[32:35], s40 offen offset:0 sc1
    ds_read_b64_tr_b16 v[192:193], v12 offset:16384
    ds_read_b64_tr_b16 v[194:195], v12 offset:16896
    v_mfma_f32_32x32x16_bf16 v[80:95], v[172:175], a[228:231], v[80:95]
    ds_read_b64_tr_b16 v[196:197], v13 offset:16384
    ds_read_b64_tr_b16 v[198:199], v13 offset:16896
    s_waitcnt vmcnt(11) lgkmcnt(8)
    v_mfma_f32_32x32x16_bf16 v[32:47], v[176:179], a[252:255], v[32:47]
    buffer_load_dwordx4 a[228:231], v1, s[32:35], s40 offen offset:1024 sc1
    ds_read_b64_tr_b16 v[200:201], v14 offset:16384
    ds_read_b64_tr_b16 v[202:203], v14 offset:16896
    v_mfma_f32_32x32x16_bf16 v[48:63], v[180:183], a[252:255], v[48:63]
    ds_read_b64_tr_b16 v[204:205], v15 offset:16384
    ds_read_b64_tr_b16 v[206:207], v15 offset:16896
    s_waitcnt lgkmcnt(8)
    v_mfma_f32_32x32x16_bf16 v[64:79], v[184:187], a[252:255], v[64:79]
    buffer_load_dwordx2 v[96:97], v30, s[32:35], s41 offen offset:0 sc1
    buffer_load_dwordx2 v[110:111], v30, s[32:35], s41 offen offset:256 sc1
    ds_read_b64_tr_b16 v[160:161], v12 offset:18432
    ds_read_b64_tr_b16 v[162:163], v12 offset:18944
    v_mfma_f32_32x32x16_bf16 v[80:95], v[188:191], a[252:255], v[80:95]
    ds_read_b64_tr_b16 v[164:165], v13 offset:18432
    ds_read_b64_tr_b16 v[166:167], v13 offset:18944
    s_waitcnt vmcnt(11) lgkmcnt(8)
    v_mfma_f32_32x32x16_bf16 v[32:47], v[192:195], a[248:251], v[32:47]
    ds_read_b64_tr_b16 v[168:169], v14 offset:18432
    ds_read_b64_tr_b16 v[170:171], v14 offset:18944
    v_mfma_f32_32x32x16_bf16 v[48:63], v[196:199], a[248:251], v[48:63]
    buffer_load_dwordx4 a[252:255], v1, s[32:35], s40 offen offset:2048 sc1
    ds_read_b64_tr_b16 v[172:173], v15 offset:18432
    ds_read_b64_tr_b16 v[174:175], v15 offset:18944
    s_waitcnt lgkmcnt(8)
    v_mfma_f32_32x32x16_bf16 v[64:79], v[200:203], a[248:251], v[64:79]
    ds_read_b64_tr_b16 v[176:177], v12 offset:20480
    ds_read_b64_tr_b16 v[178:179], v12 offset:20992
    v_mfma_f32_32x32x16_bf16 v[80:95], v[204:207], a[248:251], v[80:95]
    buffer_load_dwordx2 v[98:99], v30, s[32:35], s41 offen offset:2048 sc1
    buffer_load_dwordx2 v[112:113], v30, s[32:35], s41 offen offset:2304 sc1
    ds_read_b64_tr_b16 v[180:181], v13 offset:20480
    ds_read_b64_tr_b16 v[182:183], v13 offset:20992
    s_add_u32 s41, s41, 4096
    s_waitcnt vmcnt(13) lgkmcnt(8)
    v_mfma_f32_32x32x16_bf16 v[32:47], v[160:163], a[244:247], v[32:47]
    ds_read_b64_tr_b16 v[184:185], v14 offset:20480
    ds_read_b64_tr_b16 v[186:187], v14 offset:20992
    v_mfma_f32_32x32x16_bf16 v[48:63], v[164:167], a[244:247], v[48:63]
    ds_read_b64_tr_b16 v[188:189], v15 offset:20480
    ds_read_b64_tr_b16 v[190:191], v15 offset:20992
    s_waitcnt lgkmcnt(8)
    v_mfma_f32_32x32x16_bf16 v[64:79], v[168:171], a[244:247], v[64:79]
    ds_read_b64_tr_b16 v[192:193], v12 offset:22528
    ds_read_b64_tr_b16 v[194:195], v12 offset:23040
    v_mfma_f32_32x32x16_bf16 v[80:95], v[172:175], a[244:247], v[80:95]
    buffer_load_dwordx4 a[248:251], v1, s[32:35], s40 offen offset:3072 sc1
    ds_read_b64_tr_b16 v[196:197], v13 offset:22528
    ds_read_b64_tr_b16 v[198:199], v13 offset:23040
    s_waitcnt vmcnt(11) lgkmcnt(8)
    v_mfma_f32_32x32x16_bf16 v[32:47], v[176:179], a[240:243], v[32:47]
    ds_read_b64_tr_b16 v[200:201], v14 offset:22528
    ds_read_b64_tr_b16 v[202:203], v14 offset:23040
    v_mfma_f32_32x32x16_bf16 v[48:63], v[180:183], a[240:243], v[48:63]
    s_add_u32 s40, s40, 4096
    buffer_load_dwordx4 a[244:247], v1, s[32:35], s40 offen offset:0 sc1
    ds_read_b64_tr_b16 v[204:205], v15 offset:22528
    ds_read_b64_tr_b16 v[206:207], v15 offset:23040
    s_waitcnt lgkmcnt(8)
    v_mfma_f32_32x32x16_bf16 v[64:79], v[184:187], a[240:243], v[64:79]
    buffer_load_dwordx2 v[100:101], v30, s[32:35], s41 offen offset:0 sc1
    buffer_load_dwordx2 v[114:115], v30, s[32:35], s41 offen offset:256 sc1
    ds_read_b64_tr_b16 v[160:161], v12 offset:24576
    ds_read_b64_tr_b16 v[162:163], v12 offset:25088
    v_mfma_f32_32x32x16_bf16 v[80:95], v[188:191], a[240:243], v[80:95]
    ds_read_b64_tr_b16 v[164:165], v13 offset:24576
    ds_read_b64_tr_b16 v[166:167], v13 offset:25088
    s_waitcnt vmcnt(13) lgkmcnt(8)
    v_mfma_f32_32x32x16_bf16 v[32:47], v[192:195], a[236:239], v[32:47]
    ds_read_b64_tr_b16 v[168:169], v14 offset:24576
    ds_read_b64_tr_b16 v[170:171], v14 offset:25088
    v_mfma_f32_32x32x16_bf16 v[48:63], v[196:199], a[236:239], v[48:63]
    ds_read_b64_tr_b16 v[172:173], v15 offset:24576
    ds_read_b64_tr_b16 v[174:175], v15 offset:25088
    s_waitcnt lgkmcnt(8)
    v_mfma_f32_32x32x16_bf16 v[64:79], v[200:203], a[236:239], v[64:79]
    buffer_load_dwordx2 v[102:103], v30, s[32:35], s41 offen offset:2048 sc1
    buffer_load_dwordx2 v[116:117], v30, s[32:35], s41 offen offset:2304 sc1
    ds_read_b64_tr_b16 v[176:177], v12 offset:26624
    ds_read_b64_tr_b16 v[178:179], v12 offset:27136
    s_add_u32 s41, s41, 4096
    v_mfma_f32_32x32x16_bf16 v[80:95], v[204:207], a[236:239], v[80:95]
    ds_read_b64_tr_b16 v[180:181], v13 offset:26624
    ds_read_b64_tr_b16 v[182:183], v13 offset:27136
    s_waitcnt vmcnt(12) lgkmcnt(8)
    v_mfma_f32_32x32x16_bf16 v[32:47], v[160:163], a[232:235], v[32:47]
    buffer_load_dwordx2 v[104:105], v30, s[32:35], s41 offen offset:0 sc1
    buffer_load_dwordx2 v[118:119], v30, s[32:35], s41 offen offset:256 sc1
    ds_read_b64_tr_b16 v[184:185], v14 offset:26624
    ds_read_b64_tr_b16 v[186:187], v14 offset:27136
    v_mfma_f32_32x32x16_bf16 v[48:63], v[164:167], a[232:235], v[48:63]
    ds_read_b64_tr_b16 v[188:189], v15 offset:26624
    ds_read_b64_tr_b16 v[190:191], v15 offset:27136
    s_waitcnt lgkmcnt(8)
    v_mfma_f32_32x32x16_bf16 v[64:79], v[168:171], a[232:235], v[64:79]
    buffer_load_dwordx2 v[106:107], v30, s[32:35], s41 offen offset:2048 sc1
    buffer_load_dwordx2 v[120:121], v30, s[32:35], s41 offen offset:2304 sc1
    ds_read_b64_tr_b16 v[192:193], v12 offset:28672
    ds_read_b64_tr_b16 v[194:195], v12 offset:29184
    s_add_u32 s41, s41, 4096
    v_mfma_f32_32x32x16_bf16 v[80:95], v[172:175], a[232:235], v[80:95]
    ds_read_b64_tr_b16 v[196:197], v13 offset:28672
    ds_read_b64_tr_b16 v[198:199], v13 offset:29184
    s_waitcnt vmcnt(15) lgkmcnt(8)
    v_mfma_f32_32x32x16_bf16 v[32:47], v[176:179], a[228:231], v[32:47]
    ds_read_b64_tr_b16 v[200:201], v14 offset:28672
    ds_read_b64_tr_b16 v[202:203], v14 offset:29184
    v_mfma_f32_32x32x16_bf16 v[48:63], v[180:183], a[228:231], v[48:63]
    buffer_load_dwordx2 v[108:109], v30, s[32:35], s41 offen offset:0 sc1
    buffer_load_dwordx2 v[122:123], v30, s[32:35], s41 offen offset:256 sc1
    ds_read_b64_tr_b16 v[204:205], v15 offset:28672
    ds_read_b64_tr_b16 v[206:207], v15 offset:29184
    s_waitcnt lgkmcnt(8)
    v_mfma_f32_32x32x16_bf16 v[64:79], v[184:187], a[228:231], v[64:79]
    ds_read_b64_tr_b16 v[160:161], v12 offset:30720
    ds_read_b64_tr_b16 v[162:163], v12 offset:31232
    v_mfma_f32_32x32x16_bf16 v[80:95], v[188:191], a[228:231], v[80:95]
    ds_read_b64_tr_b16 v[164:165], v13 offset:30720
    ds_read_b64_tr_b16 v[166:167], v13 offset:31232
    s_waitcnt vmcnt(14) lgkmcnt(8)
    v_mfma_f32_32x32x16_bf16 v[32:47], v[192:195], a[252:255], v[32:47]
    buffer_load_dwordx4 a[240:243], v1, s[32:35], s40 offen offset:1024 sc1
    ds_read_b64_tr_b16 v[168:169], v14 offset:30720
    ds_read_b64_tr_b16 v[170:171], v14 offset:31232
    v_mfma_f32_32x32x16_bf16 v[48:63], v[196:199], a[252:255], v[48:63]
    buffer_load_dwordx4 a[236:239], v1, s[32:35], s40 offen offset:2048 sc1
    ds_read_b64_tr_b16 v[172:173], v15 offset:30720
    ds_read_b64_tr_b16 v[174:175], v15 offset:31232
    s_waitcnt lgkmcnt(8)
    v_mfma_f32_32x32x16_bf16 v[64:79], v[200:203], a[252:255], v[64:79]
    ds_read_b64_tr_b16 v[176:177], v12 offset:32768
    ds_read_b64_tr_b16 v[178:179], v12 offset:33280
    v_mfma_f32_32x32x16_bf16 v[80:95], v[204:207], a[252:255], v[80:95]
    buffer_load_dwordx4 a[252:255], v1, s[32:35], s40 offen offset:3072 sc1
    ds_read_b64_tr_b16 v[180:181], v13 offset:32768
    ds_read_b64_tr_b16 v[182:183], v13 offset:33280
    s_waitcnt vmcnt(14) lgkmcnt(8)
    v_mfma_f32_32x32x16_bf16 v[32:47], v[160:163], a[248:251], v[32:47]
    s_add_u32 s40, s40, 4096
    buffer_load_dwordx4 a[232:235], v1, s[32:35], s40 offen offset:0 sc1
    ds_read_b64_tr_b16 v[184:185], v14 offset:32768
    ds_read_b64_tr_b16 v[186:187], v14 offset:33280
    v_mfma_f32_32x32x16_bf16 v[48:63], v[164:167], a[248:251], v[48:63]
    buffer_load_dwordx4 a[228:231], v1, s[32:35], s40 offen offset:1024 sc1
    ds_read_b64_tr_b16 v[188:189], v15 offset:32768
    ds_read_b64_tr_b16 v[190:191], v15 offset:33280
    s_waitcnt lgkmcnt(8)
    v_mfma_f32_32x32x16_bf16 v[64:79], v[168:171], a[248:251], v[64:79]
    s_add_u32 m0, s37, 0
    s_add_u32 s57, s57, 14336
    ds_read_b64_tr_b16 v[192:193], v12 offset:34816
    ds_read_b64_tr_b16 v[194:195], v12 offset:35328
    buffer_load_dwordx4 v2, s[24:27], s57 offen lds
    buffer_load_dwordx4 v0, s[24:27], s57 offen offset:1024 lds
    v_mfma_f32_32x32x16_bf16 v[80:95], v[172:175], a[248:251], v[80:95]
    ds_read_b64_tr_b16 v[196:197], v13 offset:34816
    ds_read_b64_tr_b16 v[198:199], v13 offset:35328
    s_barrier
    s_waitcnt vmcnt(17) lgkmcnt(8)
    v_mfma_f32_32x32x16_bf16 v[32:47], v[176:179], a[244:247], v[32:47]
    s_lshl4_add_u32 s53, s45, 16384
    v_bfe_u32 v8, v1, 2, 4
    ds_read_b64_tr_b16 v[200:201], v14 offset:34816
    ds_read_b64_tr_b16 v[202:203], v14 offset:35328
    buffer_load_dword v9, v8, s[32:35], s53 offen sc1
    v_mfma_f32_32x32x16_bf16 v[48:63], v[180:183], a[244:247], v[48:63]
    ds_read_b64_tr_b16 v[204:205], v15 offset:34816
    ds_read_b64_tr_b16 v[206:207], v15 offset:35328
    s_waitcnt lgkmcnt(8)
    v_mfma_f32_32x32x16_bf16 v[64:79], v[184:187], a[244:247], v[64:79]
    buffer_load_dwordx4 a[248:251], v1, s[32:35], s40 offen offset:2048 sc1
    ds_read_b64_tr_b16 v[160:161], v12 offset:36864
    ds_read_b64_tr_b16 v[162:163], v12 offset:37376
    v_mfma_f32_32x32x16_bf16 v[80:95], v[188:191], a[244:247], v[80:95]
    s_add_u32 m0, s37, 2048
    s_add_u32 s57, s57, 14336
    ds_read_b64_tr_b16 v[164:165], v13 offset:36864
    ds_read_b64_tr_b16 v[166:167], v13 offset:37376
    buffer_load_dwordx4 v2, s[24:27], s57 offen lds
    s_waitcnt vmcnt(10)
    s_waitcnt vmcnt(9) lgkmcnt(8)
    v_mfma_f32_32x32x16_bf16 v[32:47], v[192:195], a[240:243], v[32:47]
    v_add_f32 v96, v96, v98
    v_add_f32 v97, v97, v99
    buffer_load_dwordx4 v0, s[24:27], s57 offen offset:1024 lds
    v_add_f32 v96, v96, v100
    v_add_f32 v97, v97, v101
    v_add_f32 v96, v96, v102
    v_mfma_f32_32x32x16_bf16 v[48:63], v[196:199], a[240:243], v[48:63]
    v_add_f32 v97, v97, v103
    v_add_f32 v96, v96, v104
    buffer_load_dwordx4 a[244:247], v1, s[32:35], s40 offen offset:3072 sc1
    v_add_f32 v97, v97, v105
    v_add_f32 v96, v96, v106
    s_waitcnt lgkmcnt(4)
    v_mfma_f32_32x32x16_bf16 v[64:79], v[200:203], a[240:243], v[64:79]
    v_add_f32 v97, v97, v107
    v_add_f32 v96, v96, v108
    v_add_f32 v97, v97, v109
    v_mov_b32 v98, v96
    v_mov_b32 v99, v97
    s_nop 0
    v_permlane32_swap_b32 v98, v96
    v_mfma_f32_32x32x16_bf16 v[80:95], v[204:207], a[240:243], v[80:95]
    ds_read_b64_tr_b16 v[168:169], v14 offset:36864
    ds_read_b64_tr_b16 v[170:171], v14 offset:37376
    v_permlane32_swap_b32 v99, v97
    v_add_f32 v96, v96, v98
    s_add_u32 m0, s37, 4096
    s_waitcnt vmcnt(10) lgkmcnt(2)
    v_mfma_f32_32x32x16_bf16 v[32:47], v[160:163], a[236:239], v[32:47]
    ds_read_b64_tr_b16 v[172:173], v15 offset:36864
    ds_read_b64_tr_b16 v[174:175], v15 offset:37376
    v_add_f32 v97, v97, v99
    v_mul_f32 v96, 0xbb124925, v96
    s_add_u32 s57, s57, 14336
    buffer_load_dwordx4 v2, s[24:27], s57 offen lds
    v_mfma_f32_32x32x16_bf16 v[48:63], v[164:167], a[236:239], v[48:63]
    ds_read_b64_tr_b16 v[176:177], v12 offset:38912
    ds_read_b64_tr_b16 v[178:179], v12 offset:39424
    v_mul_f32 v97, 0x3b124925, v97
    v_fma_f32 v97, -v96, v96, v97
    buffer_load_dwordx4 v0, s[24:27], s57 offen offset:1024 lds
    s_waitcnt lgkmcnt(2)
    v_mfma_f32_32x32x16_bf16 v[64:79], v[168:171], a[236:239], v[64:79]
    ds_read_b64_tr_b16 v[180:181], v13 offset:38912
    ds_read_b64_tr_b16 v[182:183], v13 offset:39424
    v_max_f32 v97, 0, v97
    v_add_f32 v97, 0x3727c5ac, v97
    v_rcp_f32 v24, v97
    v_sqrt_f32 v97, v97
    v_mfma_f32_32x32x16_bf16 v[80:95], v[172:175], a[236:239], v[80:95]
    ds_read_b64_tr_b16 v[184:185], v14 offset:38912
    ds_read_b64_tr_b16 v[186:187], v14 offset:39424
    v_cvt_pk_bf16_f32 v98, v96, v97
    v_lshlrev_b32 v99, 16, v98
    s_add_u32 s40, s40, 4096
    s_waitcnt vmcnt(11) lgkmcnt(2)
    v_mfma_f32_32x32x16_bf16 v[32:47], v[176:179], a[252:255], v[32:47]
    ds_read_b64_tr_b16 v[188:189], v15 offset:38912
    ds_read_b64_tr_b16 v[190:191], v15 offset:39424
    v_and_b32 v100, 0xffff0000, v98
    v_sub_f32 v99, v96, v99
    buffer_load_dwordx4 a[240:243], v1, s[32:35], s40 offen offset:0 sc1
    buffer_load_dwordx4 a[236:239], v1, s[32:35], s40 offen offset:1024 sc1
    v_mfma_f32_32x32x16_bf16 v[48:63], v[180:183], a[252:255], v[48:63]
    ds_read_b64_tr_b16 v[192:193], v12 offset:40960
    ds_read_b64_tr_b16 v[194:195], v12 offset:41472
    v_sub_f32 v100, v97, v100
    v_cvt_pk_bf16_f32 v99, v99, v100
    v_perm_b32 v16, v98, v98, s100
    s_waitcnt lgkmcnt(2)
    v_mfma_f32_32x32x16_bf16 v[64:79], v[184:187], a[252:255], v[64:79]
    ds_read_b64_tr_b16 v[196:197], v13 offset:40960
    ds_read_b64_tr_b16 v[198:199], v13 offset:41472
    v_bfi_b32 v17, s55, v99, v98
    v_perm_b32 v18, v99, v98, s101
    s_add_u32 m0, s37, 6144
    s_waitcnt vmcnt(9)
    v_mfma_f32_32x32x16_bf16 v[80:95], v[188:191], a[252:255], v[80:95]
    ds_read_b64_tr_b16 v[200:201], v14 offset:40960
    ds_read_b64_tr_b16 v[202:203], v14 offset:41472
    v_mov_b32 v19, 0
    v_add_f32 v110, v110, v112
    s_add_u32 s57, s57, 14336
    s_barrier
    s_waitcnt lgkmcnt(2)
    v_mfma_f32_32x32x16_bf16 v[32:47], v[192:195], a[232:235], v[32:47]
    ds_read_b64_tr_b16 v[204:205], v15 offset:40960
    ds_read_b64_tr_b16 v[206:207], v15 offset:41472
    v_add_f32 v111, v111, v113
    v_add_f32 v110, v110, v114
    buffer_load_dwordx4 v2, s[24:27], s57 offen lds
    buffer_load_dwordx4 v0, s[24:27], s57 offen offset:1024 lds
    v_mfma_f32_32x32x16_bf16 v[48:63], v[196:199], a[232:235], v[48:63]
    ds_read_b64_tr_b16 v[160:161], v12 offset:43008
    ds_read_b64_tr_b16 v[162:163], v12 offset:43520
    v_add_f32 v111, v111, v115
    v_add_f32 v110, v110, v116
    buffer_load_dwordx4 a[252:255], v1, s[32:35], s40 offen offset:2048 sc1
    s_waitcnt lgkmcnt(2)
    v_mfma_f32_32x32x16_bf16 v[64:79], v[200:203], a[232:235], v[64:79]
    ds_read_b64_tr_b16 v[164:165], v13 offset:43008
    ds_read_b64_tr_b16 v[166:167], v13 offset:43520
    v_add_f32 v111, v111, v117
    v_add_f32 v110, v110, v118
    s_add_u32 m0, s37, 8192
    s_add_u32 s57, s57, 14336
    v_mfma_f32_32x32x16_bf16 v[80:95], v[204:207], a[232:235], v[80:95]
    ds_read_b64_tr_b16 v[168:169], v14 offset:43008
    ds_read_b64_tr_b16 v[170:171], v14 offset:43520
    v_add_f32 v111, v111, v119
    v_add_f32 v110, v110, v120
    buffer_load_dwordx4 v2, s[24:27], s57 offen lds
    s_waitcnt vmcnt(12)
    v_cmp_ne_u32 vcc, s47, v9
    s_cbranch_vccnz L_hw_17
L_hw_17_back:
    s_waitcnt lgkmcnt(2)
    v_mfma_f32_32x32x16_bf16 v[32:47], v[160:163], a[228:231], v[32:47]
    ds_read_b64_tr_b16 v[172:173], v15 offset:43008
    ds_read_b64_tr_b16 v[174:175], v15 offset:43520
    v_add_f32 v111, v111, v121
    v_add_f32 v110, v110, v122
    buffer_load_dwordx4 v0, s[24:27], s57 offen offset:1024 lds
    s_waitcnt vmcnt(10)
    v_mfma_f32_32x32x16_bf16 v[48:63], v[164:167], a[228:231], v[48:63]
    ds_read_b64_tr_b16 v[176:177], v12 offset:45056
    ds_read_b64_tr_b16 v[178:179], v12 offset:45568
    v_add_f32 v111, v111, v123
    v_mov_b32 v112, v110
    buffer_load_dwordx4 v[208:211], v1, s[32:35], s36 offen offset:0 sc1
    s_waitcnt lgkmcnt(2)
    v_mfma_f32_32x32x16_bf16 v[64:79], v[168:171], a[228:231], v[64:79]
    ds_read_b64_tr_b16 v[180:181], v13 offset:45056
    ds_read_b64_tr_b16 v[182:183], v13 offset:45568
    v_mov_b32 v113, v111
    v_permlane32_swap_b32 v112, v110
    buffer_load_dwordx4 v[212:215], v1, s[32:35], s36 offen offset:1024 sc1
    buffer_load_dwordx4 v[216:219], v1, s[32:35], s36 offen offset:2048 sc1
    v_mfma_f32_32x32x16_bf16 v[80:95], v[172:175], a[228:231], v[80:95]
    ds_read_b64_tr_b16 v[184:185], v14 offset:45056
    ds_read_b64_tr_b16 v[186:187], v14 offset:45568
    v_permlane32_swap_b32 v113, v111
    v_add_f32 v110, v110, v112
    buffer_load_dwordx4 v[220:223], v1, s[32:35], s36 offen offset:3072 sc1
    s_waitcnt lgkmcnt(2)
    v_mfma_f32_32x32x16_bf16 v[32:47], v[176:179], a[248:251], v[32:47]
    ds_read_b64_tr_b16 v[188:189], v15 offset:45056
    ds_read_b64_tr_b16 v[190:191], v15 offset:45568
    v_add_f32 v111, v111, v113
    v_mul_f32 v110, 0xbb124925, v110
    ds_read_b64_tr_b16 a[0:1], v28 offset:0
    ds_read_b64_tr_b16 a[2:3], v28 offset:512
    v_mfma_f32_32x32x16_bf16 v[48:63], v[180:183], a[248:251], v[48:63]
    ds_read_b64_tr_b16 v[192:193], v12 offset:47104
    ds_read_b64_tr_b16 v[194:195], v12 offset:47616
    v_mul_f32 v111, 0x3b124925, v111
    v_fma_f32 v111, -v110, v110, v111
    ds_read_b64_tr_b16 a[4:5], v29 offset:0
    s_waitcnt lgkmcnt(5)
    v_mfma_f32_32x32x16_bf16 v[64:79], v[184:187], a[248:251], v[64:79]
    ds_read_b64_tr_b16 v[196:197], v13 offset:47104
    ds_read_b64_tr_b16 v[198:199], v13 offset:47616
    v_max_f32 v111, 0, v111
    v_add_f32 v111, 0x3727c5ac, v111
    ds_read_b64_tr_b16 a[6:7], v29 offset:512
    s_waitcnt vmcnt(11)
    v_mfma_f32_32x32x16_bf16 v[80:95], v[188:191], a[248:251], v[80:95]
    ds_read_b64_tr_b16 v[200:201], v14 offset:47104
    ds_read_b64_tr_b16 v[202:203], v14 offset:47616
    v_rcp_f32 v25, v111
    v_sqrt_f32 v111, v111
    ds_read_b64_tr_b16 a[8:9], v28 offset:2048
    s_waitcnt lgkmcnt(4)
    v_mfma_f32_32x32x16_bf16 v[32:47], v[192:195], a[244:247], v[32:47]
    ds_read_b64_tr_b16 v[204:205], v15 offset:47104
    ds_read_b64_tr_b16 v[206:207], v15 offset:47616
    v_cvt_pk_bf16_f32 v112, v110, v111
    v_lshlrev_b32 v113, 16, v112
    ds_read_b64_tr_b16 a[10:11], v28 offset:2560
    ds_read_b64_tr_b16 a[12:13], v29 offset:2048
    v_mfma_f32_32x32x16_bf16 v[48:63], v[196:199], a[244:247], v[48:63]
    ds_read_b64_tr_b16 v[160:161], v12 offset:49152
    ds_read_b64_tr_b16 v[162:163], v12 offset:49664
    v_and_b32 v114, 0xffff0000, v112
    v_sub_f32 v113, v110, v113
    buffer_load_dwordx4 a[248:251], v1, s[32:35], s40 offen offset:3072 sc1
    s_waitcnt lgkmcnt(4)
    v_mfma_f32_32x32x16_bf16 v[64:79], v[200:203], a[244:247], v[64:79]
    ds_read_b64_tr_b16 v[164:165], v13 offset:49152
    ds_read_b64_tr_b16 v[166:167], v13 offset:49664
    v_sub_f32 v114, v111, v114
    v_cvt_pk_bf16_f32 v113, v113, v114
    ds_read_b64_tr_b16 a[14:15], v29 offset:2560
    ds_read_b64_tr_b16 a[16:17], v28 offset:4096
    v_mfma_f32_32x32x16_bf16 v[80:95], v[204:207], a[244:247], v[80:95]
    ds_read_b64_tr_b16 v[168:169], v14 offset:49152
    ds_read_b64_tr_b16 v[170:171], v14 offset:49664
    v_perm_b32 v20, v112, v112, s100
    v_bfi_b32 v21, s55, v113, v112
    s_add_u32 s40, s40, 4096
    s_barrier
    s_waitcnt vmcnt(11) lgkmcnt(4)
    v_mfma_f32_32x32x16_bf16 v[32:47], v[160:163], a[240:243], v[32:47]
    ds_read_b64_tr_b16 v[172:173], v15 offset:49152
    ds_read_b64_tr_b16 v[174:175], v15 offset:49664
    v_perm_b32 v22, v113, v112, s101
    v_mov_b32 v23, 0
    buffer_load_dwordx4 a[244:247], v1, s[32:35], s40 offen offset:0 sc1
    ds_read_b64_tr_b16 a[18:19], v28 offset:4608
    v_mfma_f32_32x32x16_bf16 v[48:63], v[164:167], a[240:243], v[48:63]
    ds_read_b64_tr_b16 v[176:177], v12 offset:51200
    ds_read_b64_tr_b16 v[178:179], v12 offset:51712
    buffer_load_dwordx4 a[232:235], v1, s[32:35], s40 offen offset:1024 sc1
    ds_read_b64_tr_b16 a[20:21], v29 offset:4096
    ds_read_b64_tr_b16 a[22:23], v29 offset:4608
    s_waitcnt vmcnt(10) lgkmcnt(5)
    v_mfma_f32_32x32x16_bf16 v[64:79], v[168:171], a[240:243], v[64:79]
    ds_read_b64_tr_b16 v[180:181], v13 offset:51200
    ds_read_b64_tr_b16 v[182:183], v13 offset:51712
    ds_read_b64_tr_b16 a[24:25], v28 offset:6144
    ds_read_b64_tr_b16 a[26:27], v28 offset:6656
    ds_read_b64_tr_b16 v[184:185], v14 offset:51200
    ds_read_b64_tr_b16 v[186:187], v14 offset:51712
    v_mfma_f32_32x32x16_bf16 v[80:95], v[172:175], a[240:243], v[80:95]
    buffer_load_dwordx4 a[240:243], v1, s[32:35], s40 offen offset:2048 sc1
    ds_read_b64_tr_b16 a[28:29], v29 offset:6144
    ds_read_b64_tr_b16 a[30:31], v29 offset:6656
    ds_read_b64_tr_b16 v[188:189], v15 offset:51200
    ds_read_b64_tr_b16 v[190:191], v15 offset:51712
    s_waitcnt lgkmcnt(8)
    v_mfma_f32_32x32x16_bf16 v[32:47], v[176:179], a[236:239], v[32:47]
    buffer_load_dwordx4 a[228:231], v1, s[32:35], s40 offen offset:3072 sc1
    ds_read_b64_tr_b16 v[192:193], v12 offset:53248
    ds_read_b64_tr_b16 v[194:195], v12 offset:53760
    ds_read_b64_tr_b16 v[196:197], v13 offset:53248
    ds_read_b64_tr_b16 v[198:199], v13 offset:53760
    ds_read_b64_tr_b16 v[200:201], v14 offset:53248
    v_mfma_f32_32x32x16_bf16 v[48:63], v[180:183], a[236:239], v[48:63]
    ds_read_b64_tr_b16 v[202:203], v14 offset:53760
    ds_read_b64_tr_b16 v[204:205], v15 offset:53248
    ds_read_b64_tr_b16 v[206:207], v15 offset:53760
    s_waitcnt lgkmcnt(8)
    v_mfma_f32_32x32x16_bf16 v[64:79], v[184:187], a[236:239], v[64:79]
    s_add_u32 m0, s37, 0
    s_add_u32 s57, s57, 14336
    ds_read_b64_tr_b16 v[160:161], v12 offset:55296
    ds_read_b64_tr_b16 v[162:163], v12 offset:55808
    buffer_load_dwordx4 v2, s[24:27], s57 offen lds
    s_waitcnt vmcnt(10)
    v_mfma_f32_32x32x16_bf16 v[80:95], v[188:191], a[236:239], v[80:95]
    buffer_load_dwordx4 v0, s[24:27], s57 offen offset:1024 lds
    ds_read_b64_tr_b16 a[32:33], v28 offset:8192
    ds_read_b64_tr_b16 a[34:35], v28 offset:8704
    ds_read_b64_tr_b16 v[164:165], v13 offset:55296
    ds_read_b64_tr_b16 v[166:167], v13 offset:55808
    s_waitcnt lgkmcnt(10)
    v_mfma_f32_32x32x16_bf16 v[32:47], v[192:195], a[252:255], v[32:47]
    ds_read_b64_tr_b16 a[36:37], v29 offset:8192
    ds_read_b64_tr_b16 a[38:39], v29 offset:8704
    ds_read_b64_tr_b16 v[168:169], v14 offset:55296
    ds_read_b64_tr_b16 v[170:171], v14 offset:55808
    v_mfma_f32_32x32x16_bf16 v[48:63], v[196:199], a[252:255], v[48:63]
    ds_read_b64_tr_b16 v[172:173], v15 offset:55296
    ds_read_b64_tr_b16 v[174:175], v15 offset:55808
    s_waitcnt lgkmcnt(12)
    v_mfma_f32_32x32x16_bf16 v[64:79], v[200:203], a[252:255], v[64:79]
    s_add_u32 s40, s40, 4096
    buffer_load_dwordx4 a[236:239], v1, s[32:35], s40 offen offset:0 sc1
    v_mfma_f32_32x32x16_bf16 v[80:95], v[204:207], a[252:255], v[80:95]
    s_waitcnt vmcnt(7) lgkmcnt(6)
    v_mfma_f32_32x32x16_bf16 v[32:47], v[160:163], a[248:251], v[32:47]
    buffer_load_dwordx4 a[252:255], v1, s[32:35], s40 offen offset:1024 sc1
    v_mfma_f32_32x32x16_bf16 v[48:63], v[164:167], a[248:251], v[48:63]
    s_add_u32 m0, s37, 2048
    s_add_u32 s57, s57, 14336
    buffer_load_dwordx4 v2, s[24:27], s57 offen lds
    buffer_load_dwordx4 v0, s[24:27], s57 offen offset:1024 lds
    s_waitcnt lgkmcnt(0)
    v_mfma_f32_32x32x16_bf16 v[64:79], v[168:171], a[248:251], v[64:79]
    s_add_u32 m0, s37, 4096
    s_add_u32 s57, s57, 14336
    ds_read_b64_tr_b16 v[176:177], v12 offset:0
    ds_read_b64_tr_b16 v[178:179], v12 offset:512
    buffer_load_dwordx4 v2, s[24:27], s57 offen lds
    buffer_load_dwordx4 v0, s[24:27], s57 offen offset:1024 lds
    v_mfma_f32_32x32x16_bf16 v[80:95], v[172:175], a[248:251], v[80:95]
    ds_read_b64_tr_b16 v[180:181], v13 offset:0
    ds_read_b64_tr_b16 v[182:183], v13 offset:512
    v_mfma_f32_32x32x16_bf16 v[32:47], v[208:211], v[16:19], v[32:47]
    ds_read_b64_tr_b16 v[184:185], v14 offset:0
    ds_read_b64_tr_b16 v[186:187], v14 offset:512
    v_mfma_f32_32x32x16_bf16 v[48:63], v[212:215], v[16:19], v[48:63]
    s_add_u32 m0, s37, 6144
    s_add_u32 s57, s57, 14336
    ds_read_b64_tr_b16 v[188:189], v15 offset:0
    ds_read_b64_tr_b16 v[190:191], v15 offset:512
    buffer_load_dwordx4 v2, s[24:27], s57 offen lds
    v_mfma_f32_32x32x16_bf16 v[64:79], v[216:219], v[16:19], v[64:79]
    buffer_load_dwordx4 v0, s[24:27], s57 offen offset:1024 lds
    ds_read_b64_tr_b16 v[192:193], v12 offset:2048
    ds_read_b64_tr_b16 v[194:195], v12 offset:2560
    v_mfma_f32_32x32x16_bf16 v[80:95], v[220:223], v[16:19], v[80:95]
    ds_read_b64_tr_b16 v[196:197], v13 offset:2048
    ds_read_b64_tr_b16 v[198:199], v13 offset:2560
    s_waitcnt vmcnt(13) lgkmcnt(8)
    v_mfma_f32_32x32x16_bf16 v[96:111], v[176:179], a[244:247], 0
    buffer_load_dwordx4 a[248:251], v1, s[32:35], s40 offen offset:2048 sc1
    ds_read_b64_tr_b16 v[200:201], v14 offset:2048
    ds_read_b64_tr_b16 v[202:203], v14 offset:2560
    v_mfma_f32_32x32x16_bf16 v[112:127], v[180:183], a[244:247], 0
    ds_read_b64_tr_b16 v[204:205], v15 offset:2048
    ds_read_b64_tr_b16 v[206:207], v15 offset:2560
    s_waitcnt lgkmcnt(8)
    v_mfma_f32_32x32x16_bf16 v[128:143], v[184:187], a[244:247], 0
    s_add_u32 m0, s37, 8192
    s_add_u32 s57, s57, 14336
    ds_read_b64_tr_b16 v[160:161], v12 offset:4096
    ds_read_b64_tr_b16 v[162:163], v12 offset:4608
    buffer_load_dwordx4 v2, s[24:27], s57 offen lds
    s_waitcnt vmcnt(10)
    v_mfma_f32_32x32x16_bf16 v[144:159], v[188:191], a[244:247], 0
    buffer_load_dwordx4 v0, s[24:27], s57 offen offset:1024 lds
    ds_read_b64_tr_b16 a[40:41], v28 offset:0
    ds_read_b64_tr_b16 a[42:43], v28 offset:512
    ds_read_b64_tr_b16 v[164:165], v13 offset:4096
    ds_read_b64_tr_b16 v[166:167], v13 offset:4608
    s_waitcnt lgkmcnt(10)
    v_mfma_f32_32x32x16_bf16 v[96:111], v[192:195], a[232:235], v[96:111]
    v_max_f32 v32, 0, v32
    v_mul_f32 v40, v24, v40
    ds_read_b64_tr_b16 a[44:45], v29 offset:0
    ds_read_b64_tr_b16 a[46:47], v29 offset:512
    v_max_f32 v33, 0, v33
    v_mul_f32 v41, v24, v41
    v_mfma_f32_32x32x16_bf16 v[112:127], v[196:199], a[232:235], v[112:127]
    v_max_f32 v34, 0, v34
    v_mul_f32 v42, v24, v42
    v_max_f32 v35, 0, v35
    v_mul_f32 v43, v24, v43
    v_max_f32 v36, 0, v36
    s_waitcnt lgkmcnt(8)
    v_mfma_f32_32x32x16_bf16 v[128:143], v[200:203], a[232:235], v[128:143]
    v_mul_f32 v44, v24, v44
    v_max_f32 v37, 0, v37
    buffer_load_dwordx4 a[244:247], v1, s[32:35], s40 offen offset:3072 sc1
    v_mul_f32 v45, v24, v45
    v_max_f32 v38, 0, v38
    v_mul_f32 v46, v24, v46
    v_mfma_f32_32x32x16_bf16 v[144:159], v[204:207], a[232:235], v[144:159]
    ds_read_b64_tr_b16 v[168:169], v14 offset:4096
    ds_read_b64_tr_b16 v[170:171], v14 offset:4608
    v_max_f32 v39, 0, v39
    v_mul_f32 v47, v24, v47
    v_mul_f32 v32, v32, v40
    s_waitcnt lgkmcnt(4)
    v_mfma_f32_32x32x16_bf16 v[96:111], v[160:163], a[240:243], v[96:111]
    ds_read_b64_tr_b16 v[172:173], v15 offset:4096
    ds_read_b64_tr_b16 v[174:175], v15 offset:4608
    v_mul_f32 v33, v33, v41
    v_mul_f32 v34, v34, v42
    s_add_u32 s40, s40, 4096
    buffer_load_dwordx4 a[232:235], v1, s[32:35], s40 offen offset:0 sc1
    v_mfma_f32_32x32x16_bf16 v[112:127], v[164:167], a[240:243], v[112:127]
    ds_read_b64_tr_b16 v[176:177], v12 offset:6144
    ds_read_b64_tr_b16 v[178:179], v12 offset:6656
    v_mul_f32 v35, v35, v43
    v_mul_f32 v36, v36, v44
    v_mul_f32 v37, v37, v45
    s_waitcnt vmcnt(9) lgkmcnt(2)
    v_mfma_f32_32x32x16_bf16 v[128:143], v[168:171], a[240:243], v[128:143]
    ds_read_b64_tr_b16 v[180:181], v13 offset:6144
    ds_read_b64_tr_b16 v[182:183], v13 offset:6656
    v_mul_f32 v38, v38, v46
    v_mul_f32 v39, v39, v47
    s_add_u32 m0, s37, 0
    s_add_u32 s57, s57, 14336
    v_mfma_f32_32x32x16_bf16 v[144:159], v[172:175], a[240:243], v[144:159]
    ds_read_b64_tr_b16 v[184:185], v14 offset:6144
    ds_read_b64_tr_b16 v[186:187], v14 offset:6656
    v_cvt_pk_bf16_f32 v224, v32, v33
    v_cvt_pk_bf16_f32 v225, v34, v35
    buffer_load_dwordx4 v2, s[24:27], s57 offen lds
    s_waitcnt lgkmcnt(2)
    v_mfma_f32_32x32x16_bf16 v[96:111], v[176:179], a[228:231], v[96:111]
    ds_read_b64_tr_b16 v[188:189], v15 offset:6144
    ds_read_b64_tr_b16 v[190:191], v15 offset:6656
    v_cvt_pk_bf16_f32 v226, v36, v37
    v_cvt_pk_bf16_f32 v227, v38, v39
    buffer_load_dwordx4 v0, s[24:27], s57 offen offset:1024 lds
    ds_read_b64_tr_b16 a[48:49], v28 offset:2048
    v_mfma_f32_32x32x16_bf16 v[112:127], v[180:183], a[228:231], v[112:127]
    ds_read_b64_tr_b16 v[192:193], v12 offset:8192
    ds_read_b64_tr_b16 v[194:195], v12 offset:8704
    v_max_f32 v48, 0, v48
    v_mul_f32 v56, v24, v56
    buffer_load_dwordx4 a[240:243], v1, s[32:35], s40 offen offset:1024 sc1
    s_waitcnt vmcnt(10) lgkmcnt(3)
    v_mfma_f32_32x32x16_bf16 v[128:143], v[184:187], a[228:231], v[128:143]
    ds_read_b64_tr_b16 v[196:197], v13 offset:8192
    ds_read_b64_tr_b16 v[198:199], v13 offset:8704
    v_max_f32 v49, 0, v49
    v_mul_f32 v57, v24, v57
    buffer_store_dwordx4 v[224:227], v1, s[32:35], s56 offen offset:0 sc1
    ds_read_b64_tr_b16 a[50:51], v28 offset:2560
    v_mfma_f32_32x32x16_bf16 v[144:159], v[188:191], a[228:231], v[144:159]
    ds_read_b64_tr_b16 v[200:201], v14 offset:8192
    ds_read_b64_tr_b16 v[202:203], v14 offset:8704
    v_max_f32 v50, 0, v50
    v_mul_f32 v58, v24, v58
    ds_read_b64_tr_b16 a[52:53], v29 offset:2048
    s_waitcnt lgkmcnt(4)
    v_mfma_f32_32x32x16_bf16 v[96:111], v[192:195], a[236:239], v[96:111]
    ds_read_b64_tr_b16 v[204:205], v15 offset:8192
    ds_read_b64_tr_b16 v[206:207], v15 offset:8704
    v_max_f32 v51, 0, v51
    v_mul_f32 v59, v24, v59
    ds_read_b64_tr_b16 a[54:55], v29 offset:2560
    ds_read_b64_tr_b16 a[56:57], v28 offset:4096
    v_mfma_f32_32x32x16_bf16 v[112:127], v[196:199], a[236:239], v[112:127]
    ds_read_b64_tr_b16 v[160:161], v12 offset:10240
    ds_read_b64_tr_b16 v[162:163], v12 offset:10752
    v_max_f32 v52, 0, v52
    v_mul_f32 v60, v24, v60
    buffer_load_dwordx4 a[228:231], v1, s[32:35], s40 offen offset:2048 sc1
    s_waitcnt vmcnt(10) lgkmcnt(4)
    v_mfma_f32_32x32x16_bf16 v[128:143], v[200:203], a[236:239], v[128:143]
    ds_read_b64_tr_b16 v[164:165], v13 offset:10240
    ds_read_b64_tr_b16 v[166:167], v13 offset:10752
    v_max_f32 v53, 0, v53
    v_mul_f32 v61, v24, v61
    ds_read_b64_tr_b16 a[58:59], v28 offset:4608
    ds_read_b64_tr_b16 a[60:61], v29 offset:4096
    v_mfma_f32_32x32x16_bf16 v[144:159], v[204:207], a[236:239], v[144:159]
    ds_read_b64_tr_b16 v[168:169], v14 offset:10240
    ds_read_b64_tr_b16 v[170:171], v14 offset:10752
    v_max_f32 v54, 0, v54
    v_mul_f32 v62, v24, v62
    ds_read_b64_tr_b16 a[62:63], v29 offset:4608
    s_waitcnt lgkmcnt(5)
    v_mfma_f32_32x32x16_bf16 v[96:111], v[160:163], a[252:255], v[96:111]
    ds_read_b64_tr_b16 v[172:173], v15 offset:10240
    ds_read_b64_tr_b16 v[174:175], v15 offset:10752
    v_max_f32 v55, 0, v55
    v_mul_f32 v63, v24, v63
    buffer_load_dwordx4 a[236:239], v1, s[32:35], s40 offen offset:3072 sc1
    ds_read_b64_tr_b16 a[64:65], v28 offset:6144
    v_mfma_f32_32x32x16_bf16 v[112:127], v[164:167], a[252:255], v[112:127]
    ds_read_b64_tr_b16 v[176:177], v12 offset:12288
    ds_read_b64_tr_b16 v[178:179], v12 offset:12800
    v_mul_f32 v48, v48, v56
    v_mul_f32 v49, v49, v57
    s_add_u32 m0, s37, 2048
    s_waitcnt lgkmcnt(3)
    v_mfma_f32_32x32x16_bf16 v[128:143], v[168:171], a[252:255], v[128:143]
    ds_read_b64_tr_b16 v[180:181], v13 offset:12288
    ds_read_b64_tr_b16 v[182:183], v13 offset:12800
    v_mul_f32 v50, v50, v58
    v_mul_f32 v51, v51, v59
    s_add_u32 s57, s57, 14336
    s_waitcnt vmcnt(8)
    v_mfma_f32_32x32x16_bf16 v[144:159], v[172:175], a[252:255], v[144:159]
    ds_read_b64_tr_b16 v[184:185], v14 offset:12288
    ds_read_b64_tr_b16 v[186:187], v14 offset:12800
    v_mul_f32 v52, v52, v60
    v_mul_f32 v53, v53, v61
    buffer_load_dwordx4 v2, s[24:27], s57 offen lds
    s_waitcnt lgkmcnt(2)
    v_mfma_f32_32x32x16_bf16 v[96:111], v[176:179], a[248:251], v[96:111]
    ds_read_b64_tr_b16 v[188:189], v15 offset:12288
    ds_read_b64_tr_b16 v[190:191], v15 offset:12800
    v_mul_f32 v54, v54, v62
    v_mul_f32 v55, v55, v63
    buffer_load_dwordx4 v0, s[24:27], s57 offen offset:1024 lds
    s_add_u32 s40, s40, 4096
    v_mfma_f32_32x32x16_bf16 v[112:127], v[180:183], a[248:251], v[112:127]
    ds_read_b64_tr_b16 v[192:193], v12 offset:14336
    ds_read_b64_tr_b16 v[194:195], v12 offset:14848
    v_cvt_pk_bf16_f32 v228, v48, v49
    v_cvt_pk_bf16_f32 v229, v50, v51
    buffer_load_dwordx4 a[252:255], v1, s[32:35], s40 offen offset:0 sc1
    s_waitcnt lgkmcnt(2)
    v_mfma_f32_32x32x16_bf16 v[128:143], v[184:187], a[248:251], v[128:143]
    ds_read_b64_tr_b16 v[196:197], v13 offset:14336
    ds_read_b64_tr_b16 v[198:199], v13 offset:14848
    v_cvt_pk_bf16_f32 v230, v52, v53
    v_cvt_pk_bf16_f32 v231, v54, v55
    s_add_u32 m0, s37, 4096
    s_add_u32 s57, s57, 14336
    v_mfma_f32_32x32x16_bf16 v[144:159], v[188:191], a[248:251], v[144:159]
    ds_read_b64_tr_b16 v[200:201], v14 offset:14336
    ds_read_b64_tr_b16 v[202:203], v14 offset:14848
    v_max_f32 v64, 0, v64
    v_mul_f32 v72, v24, v72
    buffer_load_dwordx4 v2, s[24:27], s57 offen lds
    s_waitcnt vmcnt(11) lgkmcnt(2)
    v_mfma_f32_32x32x16_bf16 v[96:111], v[192:195], a[244:247], v[96:111]
    ds_read_b64_tr_b16 v[204:205], v15 offset:14336
    ds_read_b64_tr_b16 v[206:207], v15 offset:14848
    v_max_f32 v65, 0, v65
    v_mul_f32 v73, v24, v73
    buffer_load_dwordx4 v0, s[24:27], s57 offen offset:1024 lds
    buffer_store_dwordx4 v[228:231], v1, s[32:35], s56 offen offset:1024 sc1
    v_mfma_f32_32x32x16_bf16 v[112:127], v[196:199], a[244:247], v[112:127]
    ds_read_b64_tr_b16 v[160:161], v12 offset:16384
    ds_read_b64_tr_b16 v[162:163], v12 offset:16896
    v_max_f32 v66, 0, v66
    v_mul_f32 v74, v24, v74
    ds_read_b64_tr_b16 a[66:67], v28 offset:6656
    s_waitcnt vmcnt(10) lgkmcnt(3)
    v_mfma_f32_32x32x16_bf16 v[128:143], v[200:203], a[244:247], v[128:143]
    ds_read_b64_tr_b16 v[164:165], v13 offset:16384
    ds_read_b64_tr_b16 v[166:167], v13 offset:16896
    v_max_f32 v67, 0, v67
    v_mul_f32 v75, v24, v75
    ds_read_b64_tr_b16 a[68:69], v29 offset:6144
    ds_read_b64_tr_b16 a[70:71], v29 offset:6656
    v_mfma_f32_32x32x16_bf16 v[144:159], v[204:207], a[244:247], v[144:159]
    ds_read_b64_tr_b16 v[168:169], v14 offset:16384
    ds_read_b64_tr_b16 v[170:171], v14 offset:16896
    v_max_f32 v68, 0, v68
    v_mul_f32 v76, v24, v76
    ds_read_b64_tr_b16 a[72:73], v28 offset:8192
    s_waitcnt lgkmcnt(5)
    v_mfma_f32_32x32x16_bf16 v[96:111], v[160:163], a[232:235], v[96:111]
    ds_read_b64_tr_b16 v[172:173], v15 offset:16384
    ds_read_b64_tr_b16 v[174:175], v15 offset:16896
    v_max_f32 v69, 0, v69
    v_mul_f32 v77, v24, v77
    buffer_load_dwordx4 a[248:251], v1, s[32:35], s40 offen offset:1024 sc1
    ds_read_b64_tr_b16 a[74:75], v28 offset:8704
    v_mfma_f32_32x32x16_bf16 v[112:127], v[164:167], a[232:235], v[112:127]
    ds_read_b64_tr_b16 v[176:177], v12 offset:18432
    ds_read_b64_tr_b16 v[178:179], v12 offset:18944
    v_max_f32 v70, 0, v70
    v_mul_f32 v78, v24, v78
    ds_read_b64_tr_b16 a[76:77], v29 offset:8192
    s_waitcnt lgkmcnt(4)
    v_mfma_f32_32x32x16_bf16 v[128:143], v[168:171], a[232:235], v[128:143]
    ds_read_b64_tr_b16 v[180:181], v13 offset:18432
    ds_read_b64_tr_b16 v[182:183], v13 offset:18944
    v_max_f32 v71, 0, v71
    v_mul_f32 v79, v24, v79
    ds_read_b64_tr_b16 a[78:79], v29 offset:8704
    ds_read_b64_tr_b16 a[80:81], v28 offset:0
    v_mfma_f32_32x32x16_bf16 v[144:159], v[172:175], a[232:235], v[144:159]
    ds_read_b64_tr_b16 v[184:185], v14 offset:18432
    ds_read_b64_tr_b16 v[186:187], v14 offset:18944
    v_mul_f32 v64, v64, v72
    v_mul_f32 v65, v65, v73
    buffer_load_dwordx4 a[244:247], v1, s[32:35], s40 offen offset:2048 sc1
    s_waitcnt vmcnt(11) lgkmcnt(4)
    v_mfma_f32_32x32x16_bf16 v[96:111], v[176:179], a[240:243], v[96:111]
    ds_read_b64_tr_b16 v[188:189], v15 offset:18432
    ds_read_b64_tr_b16 v[190:191], v15 offset:18944
    v_mul_f32 v66, v66, v74
    v_mul_f32 v67, v67, v75
    buffer_load_dwordx4 a[232:235], v1, s[32:35], s40 offen offset:3072 sc1
    ds_read_b64_tr_b16 a[82:83], v28 offset:512
    v_mfma_f32_32x32x16_bf16 v[112:127], v[180:183], a[240:243], v[112:127]
    ds_read_b64_tr_b16 v[192:193], v12 offset:20480
    ds_read_b64_tr_b16 v[194:195], v12 offset:20992
    v_mul_f32 v68, v68, v76
    v_mul_f32 v69, v69, v77
    ds_read_b64_tr_b16 a[84:85], v29 offset:0
    s_waitcnt lgkmcnt(4)
    v_mfma_f32_32x32x16_bf16 v[128:143], v[184:187], a[240:243], v[128:143]
    ds_read_b64_tr_b16 v[196:197], v13 offset:20480
    ds_read_b64_tr_b16 v[198:199], v13 offset:20992
    v_mul_f32 v70, v70, v78
    v_mul_f32 v71, v71, v79
    s_add_u32 m0, s37, 6144
    s_add_u32 s57, s57, 14336
    v_mfma_f32_32x32x16_bf16 v[144:159], v[188:191], a[240:243], v[144:159]
    ds_read_b64_tr_b16 v[200:201], v14 offset:20480
    ds_read_b64_tr_b16 v[202:203], v14 offset:20992
    v_cvt_pk_bf16_f32 v232, v64, v65
    v_cvt_pk_bf16_f32 v233, v66, v67
    buffer_load_dwordx4 v2, s[24:27], s57 offen lds
    s_waitcnt vmcnt(11) lgkmcnt(2)
    v_mfma_f32_32x32x16_bf16 v[96:111], v[192:195], a[228:231], v[96:111]
    ds_read_b64_tr_b16 v[204:205], v15 offset:20480
    ds_read_b64_tr_b16 v[206:207], v15 offset:20992
    v_cvt_pk_bf16_f32 v234, v68, v69
    v_cvt_pk_bf16_f32 v235, v70, v71
    buffer_load_dwordx4 v0, s[24:27], s57 offen offset:1024 lds
    ds_read_b64_tr_b16 a[86:87], v29 offset:512
    v_mfma_f32_32x32x16_bf16 v[112:127], v[196:199], a[228:231], v[112:127]
    ds_read_b64_tr_b16 v[160:161], v12 offset:22528
    ds_read_b64_tr_b16 v[162:163], v12 offset:23040
    v_max_f32 v80, 0, v80
    v_mul_f32 v88, v24, v88
    buffer_store_dwordx4 v[232:235], v1, s[32:35], s56 offen offset:2048 sc1
    s_waitcnt lgkmcnt(3)
    v_mfma_f32_32x32x16_bf16 v[128:143], v[200:203], a[228:231], v[128:143]
    ds_read_b64_tr_b16 v[164:165], v13 offset:22528
    ds_read_b64_tr_b16 v[166:167], v13 offset:23040
    v_max_f32 v81, 0, v81
    v_mul_f32 v89, v24, v89
    v_max_f32 v82, 0, v82
    s_waitcnt vmcnt(10)
    v_mfma_f32_32x32x16_bf16 v[144:159], v[204:207], a[228:231], v[144:159]
    ds_read_b64_tr_b16 v[168:169], v14 offset:22528
    ds_read_b64_tr_b16 v[170:171], v14 offset:23040
    v_mul_f32 v90, v24, v90
    v_max_f32 v83, 0, v83
    ds_read_b64_tr_b16 a[88:89], v28 offset:2048
    s_waitcnt lgkmcnt(3)
    v_mfma_f32_32x32x16_bf16 v[96:111], v[160:163], a[236:239], v[96:111]
    ds_read_b64_tr_b16 v[172:173], v15 offset:22528
    ds_read_b64_tr_b16 v[174:175], v15 offset:23040
    v_mul_f32 v91, v24, v91
    v_max_f32 v84, 0, v84
    ds_read_b64_tr_b16 a[90:91], v28 offset:2560
    ds_read_b64_tr_b16 a[92:93], v29 offset:2048
    v_mfma_f32_32x32x16_bf16 v[112:127], v[164:167], a[236:239], v[112:127]
    ds_read_b64_tr_b16 v[176:177], v12 offset:24576
    ds_read_b64_tr_b16 v[178:179], v12 offset:25088
    v_mul_f32 v92, v24, v92
    v_max_f32 v85, 0, v85
    s_add_u32 s40, s40, 4096
    s_waitcnt lgkmcnt(4)
    v_mfma_f32_32x32x16_bf16 v[128:143], v[168:171], a[236:239], v[128:143]
    ds_read_b64_tr_b16 v[180:181], v13 offset:24576
    ds_read_b64_tr_b16 v[182:183], v13 offset:25088
    v_mul_f32 v93, v24, v93
    v_max_f32 v86, 0, v86
    buffer_load_dwordx4 a[240:243], v1, s[32:35], s40 offen offset:0 sc1
    ds_read_b64_tr_b16 a[94:95], v29 offset:2560
    v_mfma_f32_32x32x16_bf16 v[144:159], v[172:175], a[236:239], v[144:159]
    ds_read_b64_tr_b16 v[184:185], v14 offset:24576
    ds_read_b64_tr_b16 v[186:187], v14 offset:25088
    v_mul_f32 v94, v24, v94
    v_max_f32 v87, 0, v87
    buffer_load_dwordx4 a[236:239], v1, s[32:35], s40 offen offset:1024 sc1
    s_waitcnt vmcnt(9) lgkmcnt(3)
    v_mfma_f32_32x32x16_bf16 v[96:111], v[176:179], a[252:255], v[96:111]
    ds_read_b64_tr_b16 v[188:189], v15 offset:24576
    ds_read_b64_tr_b16 v[190:191], v15 offset:25088
    v_mul_f32 v95, v24, v95
    v_mul_f32 v80, v80, v88
    buffer_load_dwordx4 a[228:231], v1, s[32:35], s40 offen offset:2048 sc1
    ds_read_b64_tr_b16 a[96:97], v28 offset:4096
    v_mfma_f32_32x32x16_bf16 v[112:127], v[180:183], a[252:255], v[112:127]
    ds_read_b64_tr_b16 v[192:193], v12 offset:26624
    ds_read_b64_tr_b16 v[194:195], v12 offset:27136
    v_mul_f32 v81, v81, v89
    v_mul_f32 v82, v82, v90
    ds_read_b64_tr_b16 a[98:99], v28 offset:4608
    s_waitcnt lgkmcnt(4)
    v_mfma_f32_32x32x16_bf16 v[128:143], v[184:187], a[252:255], v[128:143]
    ds_read_b64_tr_b16 v[196:197], v13 offset:26624
    ds_read_b64_tr_b16 v[198:199], v13 offset:27136
    v_mul_f32 v83, v83, v91
    v_mul_f32 v84, v84, v92
    ds_read_b64_tr_b16 a[100:101], v29 offset:4096
    ds_read_b64_tr_b16 a[102:103], v29 offset:4608
    v_mfma_f32_32x32x16_bf16 v[144:159], v[188:191], a[252:255], v[144:159]
    ds_read_b64_tr_b16 v[200:201], v14 offset:26624
    ds_read_b64_tr_b16 v[202:203], v14 offset:27136
    v_mul_f32 v85, v85, v93
    v_mul_f32 v86, v86, v94
    s_add_u32 m0, s37, 8192
    s_waitcnt vmcnt(8) lgkmcnt(4)
    v_mfma_f32_32x32x16_bf16 v[96:111], v[192:195], a[248:251], v[96:111]
    ds_read_b64_tr_b16 v[204:205], v15 offset:26624
    ds_read_b64_tr_b16 v[206:207], v15 offset:27136
    v_mul_f32 v87, v87, v95
    v_cvt_pk_bf16_f32 v236, v80, v81
    s_add_u32 s57, s57, 14336
    buffer_load_dwordx4 v2, s[24:27], s57 offen lds
    v_mfma_f32_32x32x16_bf16 v[112:127], v[196:199], a[248:251], v[112:127]
    ds_read_b64_tr_b16 v[160:161], v12 offset:28672
    ds_read_b64_tr_b16 v[162:163], v12 offset:29184
    v_cvt_pk_bf16_f32 v237, v82, v83
    v_cvt_pk_bf16_f32 v238, v84, v85
    buffer_load_dwordx4 v0, s[24:27], s57 offen offset:1024 lds
    s_waitcnt lgkmcnt(2)
    v_mfma_f32_32x32x16_bf16 v[128:143], v[200:203], a[248:251], v[128:143]
    ds_read_b64_tr_b16 v[164:165], v13 offset:28672
    ds_read_b64_tr_b16 v[166:167], v13 offset:29184
    v_cvt_pk_bf16_f32 v239, v86, v87
    buffer_load_dwordx4 a[252:255], v1, s[32:35], s40 offen offset:3072 sc1
    buffer_store_dwordx4 v[236:239], v1, s[32:35], s56 offen offset:3072 sc1
    ds_read_b64_tr_b16 v[168:169], v14 offset:28672
    v_mfma_f32_32x32x16_bf16 v[144:159], v[204:207], a[248:251], v[144:159]
    ds_read_b64_tr_b16 v[170:171], v14 offset:29184
    s_add_u32 s56, s56, 114688
    ds_read_b64_tr_b16 v[172:173], v15 offset:28672
    ds_read_b64_tr_b16 v[174:175], v15 offset:29184
    ds_read_b64_tr_b16 v[176:177], v12 offset:30720
    s_waitcnt vmcnt(11) lgkmcnt(5)
    v_mfma_f32_32x32x16_bf16 v[96:111], v[160:163], a[244:247], v[96:111]
    ds_read_b64_tr_b16 v[178:179], v12 offset:31232
    ds_read_b64_tr_b16 v[180:181], v13 offset:30720
    ds_read_b64_tr_b16 v[182:183], v13 offset:31232
    ds_read_b64_tr_b16 v[184:185], v14 offset:30720
    ds_read_b64_tr_b16 v[186:187], v14 offset:31232
    v_mfma_f32_32x32x16_bf16 v[112:127], v[164:167], a[244:247], v[112:127]
    ds_read_b64_tr_b16 v[188:189], v15 offset:30720
    ds_read_b64_tr_b16 v[190:191], v15 offset:31232
    s_waitcnt lgkmcnt(8)
    v_mfma_f32_32x32x16_bf16 v[128:143], v[168:171], a[244:247], v[128:143]
    s_add_u32 s40, s40, 4096
    buffer_load_dwordx4 a[248:251], v1, s[32:35], s40 offen offset:0 sc1
    ds_read_b64_tr_b16 v[192:193], v12 offset:32768
    ds_read_b64_tr_b16 v[194:195], v12 offset:33280
    v_mfma_f32_32x32x16_bf16 v[144:159], v[172:175], a[244:247], v[144:159]
    ds_read_b64_tr_b16 v[196:197], v13 offset:32768
    ds_read_b64_tr_b16 v[198:199], v13 offset:33280
    s_waitcnt vmcnt(9) lgkmcnt(8)
    v_mfma_f32_32x32x16_bf16 v[96:111], v[176:179], a[232:235], v[96:111]
    buffer_load_dwordx4 a[244:247], v1, s[32:35], s40 offen offset:1024 sc1
    ds_read_b64_tr_b16 a[104:105], v28 offset:6144
    ds_read_b64_tr_b16 a[106:107], v28 offset:6656
    ds_read_b64_tr_b16 v[200:201], v14 offset:32768
    ds_read_b64_tr_b16 v[202:203], v14 offset:33280
    v_mfma_f32_32x32x16_bf16 v[112:127], v[180:183], a[232:235], v[112:127]
    ds_read_b64_tr_b16 a[108:109], v29 offset:6144
    ds_read_b64_tr_b16 a[110:111], v29 offset:6656
    ds_read_b64_tr_b16 v[204:205], v15 offset:32768
    ds_read_b64_tr_b16 v[206:207], v15 offset:33280
    s_waitcnt lgkmcnt(12)
    v_mfma_f32_32x32x16_bf16 v[128:143], v[184:187], a[232:235], v[128:143]
    s_add_u32 m0, s37, 0
    s_add_u32 s57, s57, 14336
    ds_read_b64_tr_b16 v[160:161], v12 offset:34816
    ds_read_b64_tr_b16 v[162:163], v12 offset:35328
    buffer_load_dwordx4 v2, s[24:27], s57 offen lds
    buffer_load_dwordx4 v0, s[24:27], s57 offen offset:1024 lds
    v_mfma_f32_32x32x16_bf16 v[144:159], v[188:191], a[232:235], v[144:159]
    ds_read_b64_tr_b16 v[164:165], v13 offset:34816
    ds_read_b64_tr_b16 v[166:167], v13 offset:35328
    s_waitcnt vmcnt(10) lgkmcnt(12)
    v_mfma_f32_32x32x16_bf16 v[96:111], v[192:195], a[240:243], v[96:111]
    ds_read_b64_tr_b16 v[168:169], v14 offset:34816
    ds_read_b64_tr_b16 v[170:171], v14 offset:35328
    v_mfma_f32_32x32x16_bf16 v[112:127], v[196:199], a[240:243], v[112:127]
    buffer_load_dwordx4 a[232:235], v1, s[32:35], s40 offen offset:2048 sc1
    ds_read_b64_tr_b16 v[172:173], v15 offset:34816
    ds_read_b64_tr_b16 v[174:175], v15 offset:35328
    s_waitcnt lgkmcnt(8)
    v_mfma_f32_32x32x16_bf16 v[128:143], v[200:203], a[240:243], v[128:143]
    ds_read_b64_tr_b16 v[176:177], v12 offset:36864
    ds_read_b64_tr_b16 v[178:179], v12 offset:37376
    v_mfma_f32_32x32x16_bf16 v[144:159], v[204:207], a[240:243], v[144:159]
    s_add_u32 m0, s37, 2048
    s_add_u32 s57, s57, 14336
    ds_read_b64_tr_b16 v[180:181], v13 offset:36864
    ds_read_b64_tr_b16 v[182:183], v13 offset:37376
    buffer_load_dwordx4 v2, s[24:27], s57 offen lds
    s_waitcnt vmcnt(11) lgkmcnt(8)
    v_mfma_f32_32x32x16_bf16 v[96:111], v[160:163], a[236:239], v[96:111]
    buffer_load_dwordx4 v0, s[24:27], s57 offen offset:1024 lds
    ds_read_b64_tr_b16 v[184:185], v14 offset:36864
    ds_read_b64_tr_b16 v[186:187], v14 offset:37376
    v_mfma_f32_32x32x16_bf16 v[112:127], v[164:167], a[236:239], v[112:127]
    ds_read_b64_tr_b16 v[188:189], v15 offset:36864
    ds_read_b64_tr_b16 v[190:191], v15 offset:37376
    s_waitcnt lgkmcnt(8)
    v_mfma_f32_32x32x16_bf16 v[128:143], v[168:171], a[236:239], v[128:143]
    ds_read_b64_tr_b16 v[192:193], v12 offset:38912
    ds_read_b64_tr_b16 v[194:195], v12 offset:39424
    v_mfma_f32_32x32x16_bf16 v[144:159], v[172:175], a[236:239], v[144:159]
    buffer_load_dwordx4 a[240:243], v1, s[32:35], s40 offen offset:3072 sc1
    ds_read_b64_tr_b16 v[196:197], v13 offset:38912
    ds_read_b64_tr_b16 v[198:199], v13 offset:39424
    s_waitcnt vmcnt(10) lgkmcnt(8)
    v_mfma_f32_32x32x16_bf16 v[96:111], v[176:179], a[228:231], v[96:111]
    s_add_u32 s40, s40, 4096
    buffer_load_dwordx4 a[236:239], v1, s[32:35], s40 offen offset:0 sc1
    ds_read_b64_tr_b16 a[112:113], v28 offset:8192
    ds_read_b64_tr_b16 a[114:115], v28 offset:8704
    ds_read_b64_tr_b16 v[200:201], v14 offset:38912
    ds_read_b64_tr_b16 v[202:203], v14 offset:39424
    v_mfma_f32_32x32x16_bf16 v[112:127], v[180:183], a[228:231], v[112:127]
    ds_read_b64_tr_b16 a[116:117], v29 offset:8192
    ds_read_b64_tr_b16 a[118:119], v29 offset:8704
    ds_read_b64_tr_b16 v[204:205], v15 offset:38912
    ds_read_b64_tr_b16 v[206:207], v15 offset:39424
    s_waitcnt lgkmcnt(12)
    v_mfma_f32_32x32x16_bf16 v[128:143], v[184:187], a[228:231], v[128:143]
    ds_read_b64_tr_b16 v[160:161], v12 offset:40960
    ds_read_b64_tr_b16 v[162:163], v12 offset:41472
    v_mfma_f32_32x32x16_bf16 v[144:159], v[188:191], a[228:231], v[144:159]
    ds_read_b64_tr_b16 v[164:165], v13 offset:40960
    ds_read_b64_tr_b16 v[166:167], v13 offset:41472
    s_waitcnt vmcnt(10) lgkmcnt(12)
    v_mfma_f32_32x32x16_bf16 v[96:111], v[192:195], a[252:255], v[96:111]
    s_waitcnt vmcnt(9)
    s_mov_b64 exec, 1
    buffer_store_dword v11, v10, s[32:35], s48 offen offset:0
    s_mov_b64 exec, -1
    ds_read_b64_tr_b16 v[168:169], v14 offset:40960
    ds_read_b64_tr_b16 v[170:171], v14 offset:41472
    v_mfma_f32_32x32x16_bf16 v[112:127], v[196:199], a[252:255], v[112:127]
    ds_read_b64_tr_b16 v[172:173], v15 offset:40960
    ds_read_b64_tr_b16 v[174:175], v15 offset:41472
    s_waitcnt lgkmcnt(8)
    v_mfma_f32_32x32x16_bf16 v[128:143], v[200:203], a[252:255], v[128:143]
    buffer_load_dwordx4 a[228:231], v1, s[32:35], s40 offen offset:1024 sc1
    ds_read_b64_tr_b16 v[176:177], v12 offset:43008
    ds_read_b64_tr_b16 v[178:179], v12 offset:43520
    v_mfma_f32_32x32x16_bf16 v[144:159], v[204:207], a[252:255], v[144:159]
    ds_read_b64_tr_b16 v[180:181], v13 offset:43008
    ds_read_b64_tr_b16 v[182:183], v13 offset:43520
    s_waitcnt vmcnt(10) lgkmcnt(8)
    v_mfma_f32_32x32x16_bf16 v[96:111], v[160:163], a[248:251], v[96:111]
    buffer_load_dwordx4 a[252:255], v1, s[32:35], s40 offen offset:2048 sc1
    ds_read_b64_tr_b16 v[184:185], v14 offset:43008
    ds_read_b64_tr_b16 v[186:187], v14 offset:43520
    v_mfma_f32_32x32x16_bf16 v[112:127], v[164:167], a[248:251], v[112:127]
    s_add_u32 m0, s37, 4096
    s_add_u32 s57, s57, 14336
    ds_read_b64_tr_b16 v[188:189], v15 offset:43008
    ds_read_b64_tr_b16 v[190:191], v15 offset:43520
    buffer_load_dwordx4 v2, s[24:27], s57 offen lds
    s_waitcnt lgkmcnt(8)
    v_mfma_f32_32x32x16_bf16 v[128:143], v[168:171], a[248:251], v[128:143]
    buffer_load_dwordx4 v0, s[24:27], s57 offen offset:1024 lds
    ds_read_b64_tr_b16 v[192:193], v12 offset:45056
    ds_read_b64_tr_b16 v[194:195], v12 offset:45568
    v_mfma_f32_32x32x16_bf16 v[144:159], v[172:175], a[248:251], v[144:159]
    ds_read_b64_tr_b16 v[196:197], v13 offset:45056
    ds_read_b64_tr_b16 v[198:199], v13 offset:45568
    s_waitcnt vmcnt(10) lgkmcnt(8)
    v_mfma_f32_32x32x16_bf16 v[96:111], v[176:179], a[244:247], v[96:111]
    buffer_load_dword v9, v31, s[32:35], s48 offen offset:0 sc1
    ds_read_b64_tr_b16 a[120:121], v28 offset:0
    ds_read_b64_tr_b16 a[122:123], v28 offset:512
    ds_read_b64_tr_b16 v[200:201], v14 offset:45056
    ds_read_b64_tr_b16 v[202:203], v14 offset:45568
    v_mfma_f32_32x32x16_bf16 v[112:127], v[180:183], a[244:247], v[112:127]
    ds_read_b64_tr_b16 a[124:125], v29 offset:0
    ds_read_b64_tr_b16 a[126:127], v29 offset:512
    ds_read_b64_tr_b16 v[204:205], v15 offset:45056
    ds_read_b64_tr_b16 v[206:207], v15 offset:45568
    s_waitcnt lgkmcnt(12)
    v_mfma_f32_32x32x16_bf16 v[128:143], v[184:187], a[244:247], v[128:143]
    ds_read_b64_tr_b16 v[160:161], v12 offset:47104
    ds_read_b64_tr_b16 v[162:163], v12 offset:47616
    v_mfma_f32_32x32x16_bf16 v[144:159], v[188:191], a[244:247], v[144:159]
    buffer_load_dwordx4 a[248:251], v1, s[32:35], s40 offen offset:3072 sc1
    ds_read_b64_tr_b16 v[164:165], v13 offset:47104
    ds_read_b64_tr_b16 v[166:167], v13 offset:47616
    s_waitcnt vmcnt(11) lgkmcnt(12)
    v_mfma_f32_32x32x16_bf16 v[96:111], v[192:195], a[232:235], v[96:111]
    ds_read_b64_tr_b16 v[168:169], v14 offset:47104
    ds_read_b64_tr_b16 v[170:171], v14 offset:47616
    v_mfma_f32_32x32x16_bf16 v[112:127], v[196:199], a[232:235], v[112:127]
    s_add_u32 m0, s37, 6144
    s_add_u32 s57, s57, 14336
    ds_read_b64_tr_b16 v[172:173], v15 offset:47104
    ds_read_b64_tr_b16 v[174:175], v15 offset:47616
    buffer_load_dwordx4 v2, s[24:27], s57 offen lds
    s_waitcnt vmcnt(10) lgkmcnt(8)
    v_mfma_f32_32x32x16_bf16 v[128:143], v[200:203], a[232:235], v[128:143]
    buffer_load_dwordx4 v0, s[24:27], s57 offen offset:1024 lds
    ds_read_b64_tr_b16 a[128:129], v28 offset:2048
    ds_read_b64_tr_b16 a[130:131], v28 offset:2560
    ds_read_b64_tr_b16 v[176:177], v12 offset:49152
    ds_read_b64_tr_b16 v[178:179], v12 offset:49664
    v_mfma_f32_32x32x16_bf16 v[144:159], v[204:207], a[232:235], v[144:159]
    ds_read_b64_tr_b16 a[132:133], v29 offset:2048
    ds_read_b64_tr_b16 a[134:135], v29 offset:2560
    ds_read_b64_tr_b16 v[180:181], v13 offset:49152
    ds_read_b64_tr_b16 v[182:183], v13 offset:49664
    s_waitcnt vmcnt(10) lgkmcnt(12)
    v_mfma_f32_32x32x16_bf16 v[96:111], v[160:163], a[240:243], v[96:111]
    s_add_u32 m0, s37, 8192
    s_add_u32 s57, s57, 14336
    ds_read_b64_tr_b16 v[184:185], v14 offset:49152
    ds_read_b64_tr_b16 v[186:187], v14 offset:49664
    buffer_load_dwordx4 v2, s[24:27], s57 offen lds
    buffer_load_dwordx4 v0, s[24:27], s57 offen offset:1024 lds
    v_mfma_f32_32x32x16_bf16 v[112:127], v[164:167], a[240:243], v[112:127]
    ds_read_b64_tr_b16 v[188:189], v15 offset:49152
    ds_read_b64_tr_b16 v[190:191], v15 offset:49664
    s_waitcnt lgkmcnt(12)
    v_mfma_f32_32x32x16_bf16 v[128:143], v[168:171], a[240:243], v[128:143]
    ds_read_b64_tr_b16 v[192:193], v12 offset:51200
    ds_read_b64_tr_b16 v[194:195], v12 offset:51712
    v_mfma_f32_32x32x16_bf16 v[144:159], v[172:175], a[240:243], v[144:159]
    s_add_u32 m0, s37, 0
    s_add_u32 s57, s57, 14336
    ds_read_b64_tr_b16 v[196:197], v13 offset:51200
    ds_read_b64_tr_b16 v[198:199], v13 offset:51712
    buffer_load_dwordx4 v2, s[24:27], s57 offen lds
    s_waitcnt vmcnt(12) lgkmcnt(8)
    v_mfma_f32_32x32x16_bf16 v[96:111], v[176:179], a[236:239], v[96:111]
    buffer_load_dwordx4 v0, s[24:27], s57 offen offset:1024 lds
    ds_read_b64_tr_b16 v[200:201], v14 offset:51200
    ds_read_b64_tr_b16 v[202:203], v14 offset:51712
    v_mfma_f32_32x32x16_bf16 v[112:127], v[180:183], a[236:239], v[112:127]
    ds_read_b64_tr_b16 v[204:205], v15 offset:51200
    ds_read_b64_tr_b16 v[206:207], v15 offset:51712
    s_waitcnt lgkmcnt(8)
    v_mfma_f32_32x32x16_bf16 v[128:143], v[184:187], a[236:239], v[128:143]
    s_add_u32 m0, s37, 2048
    s_add_u32 s57, s57, 14336
    ds_read_b64_tr_b16 v[160:161], v12 offset:53248
    ds_read_b64_tr_b16 v[162:163], v12 offset:53760
    buffer_load_dwordx4 v2, s[24:27], s57 offen lds
    buffer_load_dwordx4 v0, s[24:27], s57 offen offset:1024 lds
    v_mfma_f32_32x32x16_bf16 v[144:159], v[188:191], a[236:239], v[144:159]
    ds_read_b64_tr_b16 v[164:165], v13 offset:53248
    ds_read_b64_tr_b16 v[166:167], v13 offset:53760
    s_waitcnt vmcnt(13) lgkmcnt(8)
    v_mfma_f32_32x32x16_bf16 v[96:111], v[192:195], a[228:231], v[96:111]
    s_waitcnt vmcnt(9)
    v_cmp_ne_u32 vcc, s47, v9
    s_cbranch_vccnz L_hw_18
L_hw_18_back:
    buffer_load_dwordx4 a[244:247], v1, s[32:35], s59 offen offset:0 sc1
    ds_read_b64_tr_b16 v[168:169], v14 offset:53248
    v_mfma_f32_32x32x16_bf16 v[112:127], v[196:199], a[228:231], v[112:127]
    ds_read_b64_tr_b16 a[136:137], v28 offset:4096
    ds_read_b64_tr_b16 a[138:139], v28 offset:4608
    ds_read_b64_tr_b16 v[170:171], v14 offset:53760
    ds_read_b64_tr_b16 v[172:173], v15 offset:53248
    ds_read_b64_tr_b16 v[174:175], v15 offset:53760
    s_waitcnt lgkmcnt(10)
    v_mfma_f32_32x32x16_bf16 v[128:143], v[200:203], a[228:231], v[128:143]
    buffer_load_dwordx4 a[240:243], v1, s[32:35], s59 offen offset:1024 sc1
    ds_read_b64_tr_b16 a[140:141], v29 offset:4096
    ds_read_b64_tr_b16 a[142:143], v29 offset:4608
    ds_read_b64_tr_b16 v[176:177], v12 offset:55296
    ds_read_b64_tr_b16 v[178:179], v12 offset:55808
    v_mfma_f32_32x32x16_bf16 v[144:159], v[204:207], a[228:231], v[144:159]
    ds_read_b64_tr_b16 v[180:181], v13 offset:55296
    ds_read_b64_tr_b16 v[182:183], v13 offset:55808
    s_waitcnt lgkmcnt(12)
    v_mfma_f32_32x32x16_bf16 v[96:111], v[160:163], a[252:255], v[96:111]
    buffer_load_dwordx4 a[236:239], v1, s[32:35], s59 offen offset:2048 sc1
    ds_read_b64_tr_b16 v[184:185], v14 offset:55296
    ds_read_b64_tr_b16 v[186:187], v14 offset:55808
    v_mfma_f32_32x32x16_bf16 v[112:127], v[164:167], a[252:255], v[112:127]
    ds_read_b64_tr_b16 v[188:189], v15 offset:55296
    ds_read_b64_tr_b16 v[190:191], v15 offset:55808
    s_waitcnt lgkmcnt(10)
    v_mfma_f32_32x32x16_bf16 v[128:143], v[168:171], a[252:255], v[128:143]
    buffer_load_dwordx4 a[232:235], v1, s[32:35], s59 offen offset:3072 sc1
    s_waitcnt vmcnt(10)
    v_mfma_f32_32x32x16_bf16 v[144:159], v[172:175], a[252:255], v[144:159]
    ds_read_b64_tr_b16 a[144:145], v28 offset:6144
    ds_read_b64_tr_b16 a[146:147], v28 offset:6656
    s_waitcnt lgkmcnt(6)
    v_mfma_f32_32x32x16_bf16 v[96:111], v[176:179], a[248:251], v[96:111]
    s_add_u32 s59, s59, 4096
    buffer_load_dwordx4 a[252:255], v1, s[32:35], s59 offen offset:0 sc1
    ds_read_b64_tr_b16 a[148:149], v29 offset:6144
    ds_read_b64_tr_b16 a[150:151], v29 offset:6656
    v_mfma_f32_32x32x16_bf16 v[112:127], v[180:183], a[248:251], v[112:127]
    buffer_load_dwordx4 a[228:231], v1, s[32:35], s59 offen offset:1024 sc1
    s_waitcnt vmcnt(10) lgkmcnt(4)
    v_mfma_f32_32x32x16_bf16 v[128:143], v[184:187], a[248:251], v[128:143]
    ds_read_b64_tr_b16 a[152:153], v28 offset:8192
    ds_read_b64_tr_b16 a[154:155], v28 offset:8704
    v_mfma_f32_32x32x16_bf16 v[144:159], v[188:191], a[248:251], v[144:159]
    buffer_load_dwordx4 a[248:251], v1, s[32:35], s59 offen offset:2048 sc1
    ds_read_b64_tr_b16 a[156:157], v29 offset:8192
    ds_read_b64_tr_b16 a[158:159], v29 offset:8704
    v_mfma_f32_32x32x16_bf16 v[96:111], v[208:211], v[20:23], v[96:111]
    v_mfma_f32_32x32x16_bf16 v[112:127], v[212:215], v[20:23], v[112:127]
    buffer_load_dwordx4 a[224:227], v1, s[32:35], s59 offen offset:3072 sc1
    s_waitcnt vmcnt(10)
    v_mfma_f32_32x32x16_bf16 v[128:143], v[216:219], v[20:23], v[128:143]
    ds_read_b64_tr_b16 a[160:161], v28 offset:0
    ds_read_b64_tr_b16 a[162:163], v28 offset:512
    v_mfma_f32_32x32x16_bf16 v[144:159], v[220:223], v[20:23], v[144:159]
    s_add_u32 s59, s59, 4096
    buffer_load_dwordx4 v[160:163], v1, s[32:35], s59 offen offset:0 sc1
    ds_read_b64_tr_b16 a[164:165], v29 offset:0
    ds_read_b64_tr_b16 a[166:167], v29 offset:512
    s_waitcnt vmcnt(8)
    v_mfma_f32_32x32x16_bf16 v[32:47], a[0:3], a[244:247], 0
    buffer_load_dwordx4 v[164:167], v1, s[32:35], s59 offen offset:1024 sc1
    v_mfma_f32_32x32x16_bf16 v[48:63], a[4:7], a[244:247], 0
    buffer_load_dwordx4 v[168:171], v1, s[32:35], s59 offen offset:2048 sc1
    ds_read_b64_tr_b16 a[168:169], v28 offset:2048
    ds_read_b64_tr_b16 a[170:171], v28 offset:2560
    s_waitcnt vmcnt(9)
    v_mfma_f32_32x32x16_bf16 v[32:47], a[8:11], a[240:243], v[32:47]
    v_max_f32 v96, 0, v96
    v_mul_f32 v104, v25, v104
    buffer_load_dwordx4 v[172:175], v1, s[32:35], s59 offen offset:3072 sc1
    ds_read_b64_tr_b16 a[172:173], v29 offset:2048
    ds_read_b64_tr_b16 a[174:175], v29 offset:2560
    v_max_f32 v97, 0, v97
    v_mfma_f32_32x32x16_bf16 v[48:63], a[12:15], a[240:243], v[48:63]
    v_mul_f32 v105, v25, v105
    v_max_f32 v98, 0, v98
    s_add_u32 s59, s59, 4096
    buffer_load_dwordx4 v[176:179], v1, s[32:35], s59 offen offset:0 sc1
    v_mul_f32 v106, v25, v106
    s_waitcnt vmcnt(10)
    v_mfma_f32_32x32x16_bf16 v[32:47], a[16:19], a[236:239], v[32:47]
    v_max_f32 v99, 0, v99
    v_mul_f32 v107, v25, v107
    v_max_f32 v100, 0, v100
    v_mul_f32 v108, v25, v108
    v_max_f32 v101, 0, v101
    v_mul_f32 v109, v25, v109
    v_mfma_f32_32x32x16_bf16 v[48:63], a[20:23], a[236:239], v[48:63]
    v_max_f32 v102, 0, v102
    v_mul_f32 v110, v25, v110
    buffer_load_dwordx4 v[180:183], v1, s[32:35], s59 offen offset:1024 sc1
    v_max_f32 v103, 0, v103
    v_mul_f32 v111, v25, v111
    s_waitcnt vmcnt(10)
    v_mfma_f32_32x32x16_bf16 v[32:47], a[24:27], a[232:235], v[32:47]
    v_mul_f32 v96, v96, v104
    v_mul_f32 v97, v97, v105
    v_mul_f32 v98, v98, v106
    v_mul_f32 v99, v99, v107
    v_mul_f32 v100, v100, v108
    v_mul_f32 v101, v101, v109
    v_mfma_f32_32x32x16_bf16 v[48:63], a[28:31], a[232:235], v[48:63]
    v_mul_f32 v102, v102, v110
    v_mul_f32 v103, v103, v111
    buffer_load_dwordx4 v[184:187], v1, s[32:35], s59 offen offset:2048 sc1
    v_cvt_pk_bf16_f32 v224, v96, v97
    v_cvt_pk_bf16_f32 v225, v98, v99
    s_waitcnt vmcnt(10)
    v_mfma_f32_32x32x16_bf16 v[32:47], a[32:35], a[252:255], v[32:47]
    v_cvt_pk_bf16_f32 v226, v100, v101
    v_cvt_pk_bf16_f32 v227, v102, v103
    v_max_f32 v112, 0, v112
    v_mul_f32 v120, v25, v120
    v_max_f32 v113, 0, v113
    v_mul_f32 v121, v25, v121
    v_mfma_f32_32x32x16_bf16 v[48:63], a[36:39], a[252:255], v[48:63]
    v_max_f32 v114, 0, v114
    v_mul_f32 v122, v25, v122
    buffer_store_dwordx4 v[224:227], v1, s[32:35], s56 offen offset:0 sc1
    v_max_f32 v115, 0, v115
    v_mul_f32 v123, v25, v123
    s_waitcnt vmcnt(10)
    v_mfma_f32_32x32x16_bf16 v[32:47], a[40:43], a[228:231], v[32:47]
    v_max_f32 v116, 0, v116
    v_mul_f32 v124, v25, v124
    v_max_f32 v117, 0, v117
    v_mul_f32 v125, v25, v125
    v_max_f32 v118, 0, v118
    v_mul_f32 v126, v25, v126
    v_mfma_f32_32x32x16_bf16 v[48:63], a[44:47], a[228:231], v[48:63]
    v_max_f32 v119, 0, v119
    v_mul_f32 v127, v25, v127
    buffer_load_dwordx4 v[188:191], v1, s[32:35], s59 offen offset:3072 sc1
    v_mul_f32 v112, v112, v120
    v_mul_f32 v113, v113, v121
    s_waitcnt vmcnt(10)
    v_mfma_f32_32x32x16_bf16 v[32:47], a[48:51], a[248:251], v[32:47]
    v_mul_f32 v114, v114, v122
    v_mul_f32 v115, v115, v123
    v_mul_f32 v116, v116, v124
    v_mul_f32 v117, v117, v125
    v_mul_f32 v118, v118, v126
    v_mul_f32 v119, v119, v127
    v_mfma_f32_32x32x16_bf16 v[48:63], a[52:55], a[248:251], v[48:63]
    v_cvt_pk_bf16_f32 v228, v112, v113
    v_cvt_pk_bf16_f32 v229, v114, v115
    s_add_u32 s59, s59, 4096
    buffer_load_dwordx4 v[192:195], v1, s[32:35], s59 offen offset:0 sc1
    v_cvt_pk_bf16_f32 v230, v116, v117
    s_waitcnt vmcnt(10)
    v_mfma_f32_32x32x16_bf16 v[32:47], a[56:59], a[224:227], v[32:47]
    v_cvt_pk_bf16_f32 v231, v118, v119
    v_max_f32 v128, 0, v128
    buffer_store_dwordx4 v[228:231], v1, s[32:35], s56 offen offset:1024 sc1
    v_mul_f32 v136, v25, v136
    v_max_f32 v129, 0, v129
    v_mul_f32 v137, v25, v137
    v_mfma_f32_32x32x16_bf16 v[48:63], a[60:63], a[224:227], v[48:63]
    v_max_f32 v130, 0, v130
    v_mul_f32 v138, v25, v138
    v_max_f32 v131, 0, v131
    v_mul_f32 v139, v25, v139
    v_max_f32 v132, 0, v132
    s_waitcnt vmcnt(10)
    v_mfma_f32_32x32x16_bf16 v[32:47], a[64:67], v[160:163], v[32:47]
    v_mul_f32 v140, v25, v140
    v_max_f32 v133, 0, v133
    v_mul_f32 v141, v25, v141
    v_max_f32 v134, 0, v134
    v_mul_f32 v142, v25, v142
    v_max_f32 v135, 0, v135
    v_mfma_f32_32x32x16_bf16 v[48:63], a[68:71], v[160:163], v[48:63]
    v_mul_f32 v143, v25, v143
    v_mul_f32 v128, v128, v136
    v_mul_f32 v129, v129, v137
    v_mul_f32 v130, v130, v138
    v_mul_f32 v131, v131, v139
    s_waitcnt vmcnt(9)
    v_mfma_f32_32x32x16_bf16 v[32:47], a[72:75], v[164:167], v[32:47]
    v_mul_f32 v132, v132, v140
    v_mul_f32 v133, v133, v141
    v_mul_f32 v134, v134, v142
    v_mul_f32 v135, v135, v143
    v_cvt_pk_bf16_f32 v232, v128, v129
    v_cvt_pk_bf16_f32 v233, v130, v131
    v_mfma_f32_32x32x16_bf16 v[48:63], a[76:79], v[164:167], v[48:63]
    v_cvt_pk_bf16_f32 v234, v132, v133
    v_cvt_pk_bf16_f32 v235, v134, v135
    buffer_load_dwordx4 v[196:199], v1, s[32:35], s59 offen offset:1024 sc1
    v_max_f32 v144, 0, v144
    v_mul_f32 v152, v25, v152
    s_waitcnt vmcnt(9)
    v_mfma_f32_32x32x16_bf16 v[32:47], a[80:83], v[168:171], v[32:47]
    v_max_f32 v145, 0, v145
    v_mul_f32 v153, v25, v153
    buffer_store_dwordx4 v[232:235], v1, s[32:35], s56 offen offset:2048 sc1
    v_max_f32 v146, 0, v146
    v_mul_f32 v154, v25, v154
    v_max_f32 v147, 0, v147
    v_mfma_f32_32x32x16_bf16 v[48:63], a[84:87], v[168:171], v[48:63]
    v_mul_f32 v155, v25, v155
    v_max_f32 v148, 0, v148
    v_mul_f32 v156, v25, v156
    v_max_f32 v149, 0, v149
    v_mul_f32 v157, v25, v157
    s_waitcnt vmcnt(9)
    v_mfma_f32_32x32x16_bf16 v[32:47], a[88:91], v[172:175], v[32:47]
    v_max_f32 v150, 0, v150
    v_mul_f32 v158, v25, v158
    v_max_f32 v151, 0, v151
    v_mul_f32 v159, v25, v159
    v_mul_f32 v144, v144, v152
    v_mul_f32 v145, v145, v153
    v_mfma_f32_32x32x16_bf16 v[48:63], a[92:95], v[172:175], v[48:63]
    v_mul_f32 v146, v146, v154
    v_mul_f32 v147, v147, v155
    v_mul_f32 v148, v148, v156
    v_mul_f32 v149, v149, v157
    v_mul_f32 v150, v150, v158
    s_waitcnt vmcnt(8)
    v_mfma_f32_32x32x16_bf16 v[32:47], a[96:99], v[176:179], v[32:47]
    v_mul_f32 v151, v151, v159
    v_cvt_pk_bf16_f32 v236, v144, v145
    v_cvt_pk_bf16_f32 v237, v146, v147
    v_cvt_pk_bf16_f32 v238, v148, v149
    v_cvt_pk_bf16_f32 v239, v150, v151
    buffer_store_dwordx4 v[236:239], v1, s[32:35], s56 offen offset:3072 sc1
    v_mfma_f32_32x32x16_bf16 v[48:63], a[100:103], v[176:179], v[48:63]
    s_add_u32 s56, s56, 114688
    s_waitcnt vmcnt(8)
    v_mfma_f32_32x32x16_bf16 v[32:47], a[104:107], v[180:183], v[32:47]
    v_mfma_f32_32x32x16_bf16 v[48:63], a[108:111], v[180:183], v[48:63]
    s_waitcnt vmcnt(7)
    v_mfma_f32_32x32x16_bf16 v[32:47], a[112:115], v[184:187], v[32:47]
    v_mfma_f32_32x32x16_bf16 v[48:63], a[116:119], v[184:187], v[48:63]
    buffer_load_dwordx4 v[200:203], v1, s[32:35], s59 offen offset:2048 sc1
    s_waitcnt vmcnt(6)
    v_mfma_f32_32x32x16_bf16 v[32:47], a[120:123], v[188:191], v[32:47]
    s_add_u32 m0, s37, 4096
    s_add_u32 s57, s57, 14336
    buffer_load_dwordx4 v2, s[24:27], s57 offen lds
    buffer_load_dwordx4 v0, s[24:27], s57 offen offset:1024 lds
    v_mfma_f32_32x32x16_bf16 v[48:63], a[124:127], v[188:191], v[48:63]
    buffer_load_dwordx4 v[204:207], v1, s[32:35], s59 offen offset:3072 sc1
    s_waitcnt vmcnt(8)
    v_mfma_f32_32x32x16_bf16 v[32:47], a[128:131], v[192:195], v[32:47]
    v_mfma_f32_32x32x16_bf16 v[48:63], a[132:135], v[192:195], v[48:63]
    s_add_u32 s59, s59, 4096
    buffer_load_dwordx4 a[244:247], v1, s[32:35], s59 offen offset:0 sc1
    s_waitcnt vmcnt(7)
    v_mfma_f32_32x32x16_bf16 v[32:47], a[136:139], v[196:199], v[32:47]
    buffer_load_dwordx4 a[240:243], v1, s[32:35], s59 offen offset:1024 sc1
    v_mfma_f32_32x32x16_bf16 v[48:63], a[140:143], v[196:199], v[48:63]
    buffer_load_dwordx4 a[236:239], v1, s[32:35], s59 offen offset:2048 sc1
    buffer_load_dwordx4 a[232:235], v1, s[32:35], s59 offen offset:3072 sc1
    s_waitcnt vmcnt(7) lgkmcnt(12)
    v_mfma_f32_32x32x16_bf16 v[32:47], a[144:147], v[200:203], v[32:47]
    s_mov_b64 exec, 1
    buffer_store_dword v11, v10, s[32:35], s48 offen offset:512
    s_mov_b64 exec, -1
    s_add_u32 m0, s37, 6144
    s_add_u32 s57, s57, 14336
    buffer_load_dwordx4 v2, s[24:27], s57 offen lds
    v_mfma_f32_32x32x16_bf16 v[48:63], a[148:151], v[200:203], v[48:63]
    buffer_load_dwordx4 v0, s[24:27], s57 offen offset:1024 lds
    s_add_u32 s59, s59, 4096
    buffer_load_dwordx4 a[252:255], v1, s[32:35], s59 offen offset:0 sc1
    s_waitcnt vmcnt(8) lgkmcnt(8)
    v_mfma_f32_32x32x16_bf16 v[32:47], a[152:155], v[204:207], v[32:47]
    buffer_load_dword v9, v31, s[32:35], s48 offen offset:512 sc1
    s_add_u32 m0, s37, 8192
    s_add_u32 s57, s57, 14336
    buffer_load_dwordx4 v2, s[24:27], s57 offen lds
    buffer_load_dwordx4 v0, s[24:27], s57 offen offset:1024 lds
    v_mfma_f32_32x32x16_bf16 v[48:63], a[156:159], v[204:207], v[48:63]
    ds_read_b64_tr_b16 a[176:177], v28 offset:4096
    ds_read_b64_tr_b16 a[178:179], v28 offset:4608
    s_waitcnt vmcnt(10) lgkmcnt(6)
    v_mfma_f32_32x32x16_bf16 v[32:47], a[160:163], a[244:247], v[32:47]
    ds_read_b64_tr_b16 a[180:181], v29 offset:4096
    ds_read_b64_tr_b16 a[182:183], v29 offset:4608
    v_mfma_f32_32x32x16_bf16 v[48:63], a[164:167], a[244:247], v[48:63]
    s_add_u32 m0, s37, 0
    s_add_u32 s57, s57, 14336
    buffer_load_dwordx4 v2, s[24:27], s57 offen lds
    buffer_load_dwordx4 v0, s[24:27], s57 offen offset:1024 lds
    s_waitcnt vmcnt(11) lgkmcnt(4)
    v_mfma_f32_32x32x16_bf16 v[32:47], a[168:171], a[240:243], v[32:47]
    v_mfma_f32_32x32x16_bf16 v[48:63], a[172:175], a[240:243], v[48:63]
    s_waitcnt vmcnt(10) lgkmcnt(0)
    v_mfma_f32_32x32x16_bf16 v[32:47], a[176:179], a[236:239], v[32:47]
    v_mfma_f32_32x32x16_bf16 v[48:63], a[180:183], a[236:239], v[48:63]
    s_add_u32 m0, s37, 2048
    s_add_u32 s57, s57, 14336
    buffer_load_dwordx4 v2, s[24:27], s57 offen lds
    buffer_load_dwordx4 v0, s[24:27], s57 offen offset:1024 lds
    s_waitcnt vmcnt(8)
    ds_read_b64_tr_b16 a[184:185], v28 offset:6144
    ds_read_b64_tr_b16 a[186:187], v28 offset:6656
    ds_read_b64_tr_b16 a[188:189], v29 offset:6144
    ds_read_b64_tr_b16 a[190:191], v29 offset:6656
    s_waitcnt lgkmcnt(0)
    v_mfma_f32_32x32x16_bf16 v[32:47], a[184:187], a[232:235], v[32:47]
    s_add_u32 m0, s37, 4096
    s_add_u32 s57, s57, 14336
    buffer_load_dwordx4 v2, s[24:27], s57 offen lds
    buffer_load_dwordx4 v0, s[24:27], s57 offen offset:1024 lds
    v_mfma_f32_32x32x16_bf16 v[48:63], a[188:191], a[232:235], v[48:63]
    buffer_load_dwordx4 a[228:231], v1, s[32:35], s59 offen offset:1024 sc1
    s_waitcnt vmcnt(7)
    ds_read_b64_tr_b16 a[192:193], v28 offset:8192
    ds_read_b64_tr_b16 a[194:195], v28 offset:8704
    ds_read_b64_tr_b16 a[196:197], v29 offset:8192
    ds_read_b64_tr_b16 a[198:199], v29 offset:8704
    s_waitcnt lgkmcnt(0)
    v_mfma_f32_32x32x16_bf16 v[32:47], a[192:195], a[252:255], v[32:47]
    v_cmp_ne_u32 vcc, s47, v9
    s_cbranch_vccnz L_hw_19
L_hw_19_back:
    buffer_load_dwordx4 a[248:251], v1, s[32:35], s59 offen offset:2048 sc1
    v_mfma_f32_32x32x16_bf16 v[48:63], a[196:199], a[252:255], v[48:63]
    buffer_load_dwordx4 a[224:227], v1, s[32:35], s59 offen offset:3072 sc1
    s_add_u32 s59, s59, 90112
    buffer_load_dwordx4 v[160:163], v1, s[32:35], s59 offen offset:0 sc1
    buffer_load_dwordx4 v[164:167], v1, s[32:35], s59 offen offset:1024 sc1
    s_waitcnt vmcnt(9)
    ds_read_b64_tr_b16 a[200:201], v28 offset:0
    ds_read_b64_tr_b16 a[202:203], v28 offset:512
    ds_read_b64_tr_b16 a[204:205], v29 offset:0
    ds_read_b64_tr_b16 a[206:207], v29 offset:512
    buffer_load_dwordx4 v[168:171], v1, s[32:35], s59 offen offset:2048 sc1
    s_waitcnt vmcnt(5) lgkmcnt(0)
    v_mfma_f32_32x32x16_bf16 v[32:47], a[200:203], a[228:231], v[32:47]
    buffer_load_dwordx4 v[172:175], v1, s[32:35], s59 offen offset:3072 sc1
    v_mfma_f32_32x32x16_bf16 v[48:63], a[204:207], a[228:231], v[48:63]
    s_add_u32 s59, s59, 4096
    buffer_load_dwordx4 v[176:179], v1, s[32:35], s59 offen offset:0 sc1
    ds_read_b64_tr_b16 a[208:209], v28 offset:2048
    ds_read_b64_tr_b16 a[210:211], v28 offset:2560
    ds_read_b64_tr_b16 a[212:213], v29 offset:2048
    ds_read_b64_tr_b16 a[214:215], v29 offset:2560
    ds_read_b64_tr_b16 a[216:217], v28 offset:4096
    ds_read_b64_tr_b16 a[218:219], v28 offset:4608
    ds_read_b64_tr_b16 a[220:221], v29 offset:4096
    ds_read_b64_tr_b16 a[222:223], v29 offset:4608
    s_waitcnt vmcnt(6) lgkmcnt(4)
    v_mfma_f32_32x32x16_bf16 v[32:47], a[208:211], a[248:251], v[32:47]
    buffer_load_dwordx4 v[180:183], v1, s[32:35], s59 offen offset:1024 sc1
    v_mfma_f32_32x32x16_bf16 v[48:63], a[212:215], a[248:251], v[48:63]
    buffer_load_dwordx4 v[184:187], v1, s[32:35], s59 offen offset:2048 sc1
    s_waitcnt vmcnt(7) lgkmcnt(0)
    v_mfma_f32_32x32x16_bf16 v[32:47], a[216:219], a[224:227], v[32:47]
    buffer_load_dwordx4 v[188:191], v1, s[32:35], s59 offen offset:3072 sc1
    v_mfma_f32_32x32x16_bf16 v[48:63], a[220:223], a[224:227], v[48:63]
    s_add_u32 s59, s59, 4096
    buffer_load_dwordx4 v[192:195], v1, s[32:35], s59 offen offset:0 sc1
    s_waitcnt vmcnt(8)
    v_mfma_f32_32x32x16_bf16 v[64:79], a[0:3], v[160:163], 0
    s_lshl_b32 s53, s46, 13
    v_add_u32 v5, s53, v1
    buffer_load_dwordx4 v[196:199], v1, s[32:35], s59 offen offset:1024 sc1
    v_xor_b32 v12, 8192, v5
    v_xor_b32 v13, 16384, v5
    v_xor_b32 v14, 24576, v5
    v_mfma_f32_32x32x16_bf16 v[80:95], a[4:7], v[160:163], 0
    v_lshlrev_b32 v128, 16, v248
    v_and_b32 v129, 0xffff0000, v248
    buffer_load_dwordx4 v[200:203], v1, s[32:35], s59 offen offset:2048 sc1
    v_lshlrev_b32 v130, 16, v249
    v_and_b32 v131, 0xffff0000, v249
    s_waitcnt vmcnt(9)
    v_mfma_f32_32x32x16_bf16 v[64:79], a[8:11], v[164:167], v[64:79]
    v_lshlrev_b32 v132, 16, v250
    v_and_b32 v133, 0xffff0000, v250
    buffer_load_dwordx4 v[204:207], v1, s[32:35], s59 offen offset:3072 sc1
    v_lshlrev_b32 v134, 16, v251
    v_and_b32 v135, 0xffff0000, v251
    v_lshlrev_b32 v136, 16, v240
    v_mfma_f32_32x32x16_bf16 v[80:95], a[12:15], v[164:167], v[80:95]
    v_and_b32 v137, 0xffff0000, v240
    v_lshlrev_b32 v138, 16, v241
    v_and_b32 v139, 0xffff0000, v241
    v_lshlrev_b32 v140, 16, v242
    v_and_b32 v141, 0xffff0000, v242
    s_waitcnt vmcnt(9)
    v_mfma_f32_32x32x16_bf16 v[64:79], a[16:19], v[168:171], v[64:79]
    v_lshlrev_b32 v142, 16, v243
    v_and_b32 v143, 0xffff0000, v243
    s_add_u32 s59, s59, 4096
    buffer_load_dwordx4 a[244:247], v1, s[32:35], s59 offen offset:0 sc1
    v_lshlrev_b32 v152, 16, v244
    v_and_b32 v153, 0xffff0000, v244
    v_mfma_f32_32x32x16_bf16 v[80:95], a[20:23], v[168:171], v[80:95]
    v_lshlrev_b32 v154, 16, v245
    v_and_b32 v155, 0xffff0000, v245
    v_lshlrev_b32 v156, 16, v246
    v_and_b32 v157, 0xffff0000, v246
    v_lshlrev_b32 v158, 16, v247
    s_waitcnt vmcnt(9)
    v_mfma_f32_32x32x16_bf16 v[64:79], a[24:27], v[172:175], v[64:79]
    v_and_b32 v159, 0xffff0000, v247
    buffer_load_dwordx4 a[240:243], v1, s[32:35], s59 offen offset:1024 sc1
    v_mfma_f32_32x32x16_bf16 v[80:95], a[28:31], v[172:175], v[80:95]
    buffer_load_dwordx4 a[236:239], v1, s[32:35], s59 offen offset:2048 sc1
    s_barrier
    s_waitcnt vmcnt(10)
    v_mfma_f32_32x32x16_bf16 v[64:79], a[32:35], v[176:179], v[64:79]
    ds_write_b128 v13, v[40:43] offset:2048
    v_mfma_f32_32x32x16_bf16 v[80:95], a[36:39], v[176:179], v[80:95]
    buffer_load_dwordx4 a[232:235], v1, s[32:35], s59 offen offset:3072 sc1
    s_waitcnt vmcnt(10)
    v_mfma_f32_32x32x16_bf16 v[64:79], a[40:43], v[180:183], v[64:79]
    ds_write_b128 v13, v[44:47] offset:3072
    v_mfma_f32_32x32x16_bf16 v[80:95], a[44:47], v[180:183], v[80:95]
    s_add_u32 s59, s59, 4096
    buffer_load_dwordx4 a[252:255], v1, s[32:35], s59 offen offset:0 sc1
    s_waitcnt vmcnt(10)
    v_mfma_f32_32x32x16_bf16 v[64:79], a[48:51], v[184:187], v[64:79]
    ds_write_b128 v12, v[48:51] offset:0
    v_mfma_f32_32x32x16_bf16 v[80:95], a[52:55], v[184:187], v[80:95]
    buffer_load_dwordx4 a[228:231], v1, s[32:35], s59 offen offset:1024 sc1
    s_waitcnt vmcnt(10)
    v_mfma_f32_32x32x16_bf16 v[64:79], a[56:59], v[188:191], v[64:79]
    ds_write_b128 v12, v[52:55] offset:1024
    v_mfma_f32_32x32x16_bf16 v[80:95], a[60:63], v[188:191], v[80:95]
    buffer_load_dwordx4 a[248:251], v1, s[32:35], s59 offen offset:2048 sc1
    s_waitcnt vmcnt(10)
    v_mfma_f32_32x32x16_bf16 v[64:79], a[64:67], v[192:195], v[64:79]
    ds_write_b128 v14, v[56:59] offset:4096
    v_mfma_f32_32x32x16_bf16 v[80:95], a[68:71], v[192:195], v[80:95]
    buffer_load_dwordx4 a[224:227], v1, s[32:35], s59 offen offset:3072 sc1
    s_waitcnt vmcnt(10)
    v_mfma_f32_32x32x16_bf16 v[64:79], a[72:75], v[196:199], v[64:79]
    ds_write_b128 v14, v[60:63] offset:5120
    v_mfma_f32_32x32x16_bf16 v[80:95], a[76:79], v[196:199], v[80:95]
    s_add_u32 s59, s59, 4096
    buffer_load_dwordx4 v[160:163], v1, s[32:35], s59 offen offset:0 sc1
    s_waitcnt vmcnt(10)
    v_mfma_f32_32x32x16_bf16 v[64:79], a[80:83], v[200:203], v[64:79]
    v_mfma_f32_32x32x16_bf16 v[80:95], a[84:87], v[200:203], v[80:95]
    buffer_load_dwordx4 v[164:167], v1, s[32:35], s59 offen offset:1024 sc1
    s_waitcnt vmcnt(10)
    v_mfma_f32_32x32x16_bf16 v[64:79], a[88:91], v[204:207], v[64:79]
    v_mfma_f32_32x32x16_bf16 v[80:95], a[92:95], v[204:207], v[80:95]
    buffer_load_dwordx4 v[168:171], v1, s[32:35], s59 offen offset:2048 sc1
    s_waitcnt lgkmcnt(0)
    s_barrier
    s_waitcnt vmcnt(10)
    v_mfma_f32_32x32x16_bf16 v[64:79], a[96:99], a[244:247], v[64:79]
    ds_read_b128 v[96:99], v5 offset:0
    ds_read_b128 v[100:103], v5 offset:1024
    ds_read_b128 v[104:107], v5 offset:2048
    ds_read_b128 v[108:111], v5 offset:3072
    ds_read_b128 v[112:115], v5 offset:4096
    ds_read_b128 v[116:119], v5 offset:5120
    v_mfma_f32_32x32x16_bf16 v[80:95], a[100:103], a[244:247], v[80:95]
    s_waitcnt lgkmcnt(4)
    v_add_f32 v32, v32, v96
    buffer_load_dwordx4 v[172:175], v1, s[32:35], s59 offen offset:3072 sc1
    v_add_f32 v33, v33, v97
    v_add_f32 v34, v34, v98
    s_waitcnt vmcnt(10)
    v_mfma_f32_32x32x16_bf16 v[64:79], a[104:107], a[240:243], v[64:79]
    v_add_f32 v35, v35, v99
    v_add_f32 v36, v36, v100
    v_add_f32 v37, v37, v101
    v_add_f32 v38, v38, v102
    v_add_f32 v39, v39, v103
    s_waitcnt lgkmcnt(0)
    v_mfma_f32_32x32x16_bf16 v[80:95], a[108:111], a[240:243], v[80:95]
    v_add_f32 v104, v104, v112
    v_add_f32 v105, v105, v113
    s_add_u32 s59, s59, 4096
    buffer_load_dwordx4 v[176:179], v1, s[32:35], s59 offen offset:0 sc1
    v_add_f32 v106, v106, v114
    s_waitcnt vmcnt(10)
    v_mfma_f32_32x32x16_bf16 v[64:79], a[112:115], a[236:239], v[64:79]
    v_add_f32 v107, v107, v115
    v_add_f32 v108, v108, v116
    v_add_f32 v109, v109, v117
    v_add_f32 v110, v110, v118
    v_add_f32 v111, v111, v119
    v_add_f32 v32, v32, v104
    v_mfma_f32_32x32x16_bf16 v[80:95], a[116:119], a[236:239], v[80:95]
    v_add_f32 v33, v33, v105
    v_add_f32 v34, v34, v106
    buffer_load_dwordx4 v[180:183], v1, s[32:35], s59 offen offset:1024 sc1
    v_add_f32 v35, v35, v107
    v_add_f32 v36, v36, v108
    s_waitcnt vmcnt(10)
    v_mfma_f32_32x32x16_bf16 v[64:79], a[120:123], a[232:235], v[64:79]
    v_add_f32 v37, v37, v109
    v_add_f32 v38, v38, v110
    v_add_f32 v39, v39, v111
    v_fma_f32 v32, v32, v128, v136
    v_fma_f32 v33, v33, v129, v137
    v_fma_f32 v34, v34, v130, v138
    v_mfma_f32_32x32x16_bf16 v[80:95], a[124:127], a[232:235], v[80:95]
    v_fma_f32 v35, v35, v131, v139
    v_fma_f32 v36, v36, v132, v140
    buffer_load_dwordx4 v[184:187], v1, s[32:35], s59 offen offset:2048 sc1
    v_fma_f32 v37, v37, v133, v141
    v_fma_f32 v38, v38, v134, v142
    s_waitcnt vmcnt(10)
    v_mfma_f32_32x32x16_bf16 v[64:79], a[128:131], a[252:255], v[64:79]
    v_fma_f32 v39, v39, v135, v143
    v_cvt_pk_bf16_f32 v144, v32, v33
    v_cvt_pk_bf16_f32 v145, v34, v35
    v_cvt_pk_bf16_f32 v146, v36, v37
    v_cvt_pk_bf16_f32 v147, v38, v39
    buffer_store_dwordx4 v[144:147], v3, s[28:31], s51 offen
    v_mfma_f32_32x32x16_bf16 v[80:95], a[132:135], a[252:255], v[80:95]
    s_add_u32 s51, s51, 28672
    buffer_load_dwordx4 v[188:191], v1, s[32:35], s59 offen offset:3072 sc1
    s_waitcnt vmcnt(11)
    v_mfma_f32_32x32x16_bf16 v[64:79], a[136:139], a[228:231], v[64:79]
    v_mfma_f32_32x32x16_bf16 v[80:95], a[140:143], a[228:231], v[80:95]
    s_waitcnt vmcnt(10)
    v_mfma_f32_32x32x16_bf16 v[64:79], a[144:147], a[248:251], v[64:79]
    v_mfma_f32_32x32x16_bf16 v[80:95], a[148:151], a[248:251], v[80:95]
    s_waitcnt vmcnt(9)
    v_mfma_f32_32x32x16_bf16 v[64:79], a[152:155], a[224:227], v[64:79]
    v_mfma_f32_32x32x16_bf16 v[80:95], a[156:159], a[224:227], v[80:95]
    s_waitcnt vmcnt(8)
    v_mfma_f32_32x32x16_bf16 v[64:79], a[160:163], v[160:163], v[64:79]
    v_mfma_f32_32x32x16_bf16 v[80:95], a[164:167], v[160:163], v[80:95]
    s_waitcnt vmcnt(7)
    v_mfma_f32_32x32x16_bf16 v[64:79], a[168:171], v[164:167], v[64:79]
    v_mfma_f32_32x32x16_bf16 v[80:95], a[172:175], v[164:167], v[80:95]
    s_waitcnt vmcnt(6)
    v_mfma_f32_32x32x16_bf16 v[64:79], a[176:179], v[168:171], v[64:79]
    v_mfma_f32_32x32x16_bf16 v[80:95], a[180:183], v[168:171], v[80:95]
    s_waitcnt vmcnt(5)
    v_mfma_f32_32x32x16_bf16 v[64:79], a[184:187], v[172:175], v[64:79]
    v_mfma_f32_32x32x16_bf16 v[80:95], a[188:191], v[172:175], v[80:95]
    s_waitcnt vmcnt(4)
    v_mfma_f32_32x32x16_bf16 v[64:79], a[192:195], v[176:179], v[64:79]
    v_mfma_f32_32x32x16_bf16 v[80:95], a[196:199], v[176:179], v[80:95]
    s_waitcnt vmcnt(3)
    v_mfma_f32_32x32x16_bf16 v[64:79], a[200:203], v[180:183], v[64:79]
    v_mfma_f32_32x32x16_bf16 v[80:95], a[204:207], v[180:183], v[80:95]
    s_waitcnt vmcnt(2)
    v_mfma_f32_32x32x16_bf16 v[64:79], a[208:211], v[184:187], v[64:79]
    v_mfma_f32_32x32x16_bf16 v[80:95], a[212:215], v[184:187], v[80:95]
    s_waitcnt vmcnt(0)
    v_mfma_f32_32x32x16_bf16 v[64:79], a[216:219], v[188:191], v[64:79]
    v_mfma_f32_32x32x16_bf16 v[80:95], a[220:223], v[188:191], v[80:95]
    s_nop 10
    ds_write_b128 v13, v[72:75] offset:34816
    ds_write_b128 v13, v[76:79] offset:35840
    ds_write_b128 v12, v[80:83] offset:32768
    ds_write_b128 v12, v[84:87] offset:33792
    ds_write_b128 v14, v[88:91] offset:36864
    ds_write_b128 v14, v[92:95] offset:37888
    s_waitcnt lgkmcnt(0)
    s_barrier
    ds_read_b128 v[96:99], v5 offset:32768
    ds_read_b128 v[100:103], v5 offset:33792
    ds_read_b128 v[104:107], v5 offset:34816
    ds_read_b128 v[108:111], v5 offset:35840
    ds_read_b128 v[112:115], v5 offset:36864
    ds_read_b128 v[116:119], v5 offset:37888
    s_waitcnt lgkmcnt(4)
    v_pk_add_f32 v[64:65], v[64:65], v[96:97]
    v_pk_add_f32 v[66:67], v[66:67], v[98:99]
    v_pk_add_f32 v[68:69], v[68:69], v[100:101]
    v_pk_add_f32 v[70:71], v[70:71], v[102:103]
    s_waitcnt lgkmcnt(0)
    v_pk_add_f32 v[104:105], v[104:105], v[112:113]
    v_pk_add_f32 v[106:107], v[106:107], v[114:115]
    v_pk_add_f32 v[108:109], v[108:109], v[116:117]
    v_pk_add_f32 v[110:111], v[110:111], v[118:119]
    v_pk_add_f32 v[64:65], v[64:65], v[104:105]
    v_pk_add_f32 v[66:67], v[66:67], v[106:107]
    v_pk_add_f32 v[68:69], v[68:69], v[108:109]
    v_pk_add_f32 v[70:71], v[70:71], v[110:111]
    v_pk_fma_f32 v[64:65], v[64:65], v[128:129], v[152:153]
    v_pk_fma_f32 v[66:67], v[66:67], v[130:131], v[154:155]
    v_pk_fma_f32 v[68:69], v[68:69], v[132:133], v[156:157]
    v_pk_fma_f32 v[70:71], v[70:71], v[134:135], v[158:159]
    v_cvt_pk_bf16_f32 v148, v64, v65
    v_cvt_pk_bf16_f32 v149, v66, v67
    v_cvt_pk_bf16_f32 v150, v68, v69
    v_cvt_pk_bf16_f32 v151, v70, v71
    buffer_store_dwordx4 v[148:151], v3, s[28:31], s51 offen
    s_branch L_end
L_helper:
    s_mov_b64 s[32:33], s[86:87]
    s_mov_b32 s34, 0x1200000
    s_mov_b32 s35, 0x20000
    s_mov_b64 s[4:5], s[64:65]
    s_mov_b32 s6, 0x1c0000
    s_mov_b32 s7, 0x20000
    s_mov_b64 s[8:9], s[66:67]
    s_mov_b32 s10, 0x126000
    s_mov_b32 s11, 0x20000
    s_mov_b64 s[12:13], s[68:69]
    s_mov_b32 s14, 0x62000
    s_mov_b32 s15, 0x20000
    s_mov_b64 s[16:17], s[72:73]
    s_mov_b32 s18, 0x188000
    s_mov_b32 s19, 0x20000
    s_mov_b64 s[20:21], s[74:75]
    s_mov_b32 s22, 0x188000
    s_mov_b32 s23, 0x20000
    s_mov_b64 s[24:25], s[76:77]
    s_mov_b32 s26, 0x188000
    s_mov_b32 s27, 0x20000
    s_mov_b64 s[28:29], s[82:83]
    s_mov_b32 s30, 0x1c0000
    s_mov_b32 s31, 0x20000
    s_load_dword s47, s[32:33], 0
    s_getreg_b32 s51, hwreg(HW_REG_XCC_ID, 0, 4)
    s_add_u32 s48, s44, 1
    s_lshl_b32 s48, s48, 21
    s_mul_i32 s53, s49, 7
    s_sub_u32 s50, s45, s53
    s_lshr_b32 s61, s46, 1
    s_and_b32 s62, s46, 1
    s_lshl1_add_u32 s63, s49, s61
    s_waitcnt lgkmcnt(0)
    s_mul_i32 s47, s47, 1664525
    s_add_u32 s47, s47, 1013904223
    s_lshl_b32 s53, s44, 8
    s_lshl_b32 s54, s45, 3
    s_add_u32 s53, s53, s54
    v_mov_b32 v20, s51
    v_mov_b32 v21, s47
    v_mov_b32 v22, 1024
    s_cmp_eq_u32 s46, 0
    s_cselect_b64 exec, 1, 0
    buffer_store_dwordx2 v[20:21], v22, s[32:35], s53 offen sc1
    s_mov_b64 exec, -1
    s_waitcnt vmcnt(8)
    v_lshlrev_b32 v10, 16, v9
    v_and_b32 v11, 0xffff0000, v9
    v_mul_f32 v12, 0xbfb8aa3b, v10
    v_mul_f32 v13, 0xbfb8aa3b, v11
    v_exp_f32 v12, v12
    v_exp_f32 v13, v13
    v_add_f32 v12, 1.0, v12
    v_add_f32 v13, 1.0, v13
    v_rcp_f32 v12, v12
    v_rcp_f32 v13, v13
    v_mul_f32 v10, v10, v12
    v_mul_f32 v11, v11, v13
    v_cvt_pk_bf16_f32 v10, v10, v11
    v_add_u32 v8, 159744, v8
    ds_write_b32 v8, v10
    v_bfe_u32 v11, v3, 2, 2
    v_lshrrev_b32 v12, 4, v3
    v_lshl_add_u32 v13, v12, 3, v11
    v_lshlrev_b32 v2, 7, v13
    v_lshlrev_b32 v5, 6, v13
    v_lshrrev_b32 v11, 1, v11
    v_lshlrev_b32 v11, 6, v11
    v_and_b32 v13, 3, v3
    v_lshlrev_b32 v13, 3, v13
    s_lshl_b32 s53, s62, 5
    v_add3_u32 v5, v5, v13, s53
    v_xor_b32 v11, v11, v13
    s_lshl_b32 s53, s46, 5
    v_xor_b32 v11, s53, v11
    v_add_u32 v2, v2, v11
    v_lshlrev_b32 v12, 4, v12
    v_add_u32 v12, 159744, v12
    v_lshlrev_b32 v4, 2, v3
    s_lshl_b32 s59, s57, 7
    s_lshl_b32 s54, s62, 6
    s_add_u32 s59, s59, s54
    s_add_u32 s59, s59, 4096
    s_cmp_lt_u32 s57, 28
    s_cselect_b32 s59, s59, 2130706432
    s_cmp_lt_u32 s46, 2
    s_cselect_b32 s59, s59, 2130706432
    s_waitcnt lgkmcnt(0)
    s_barrier
    ds_read_b128 v[32:35], v12 offset:0
    ds_read_b128 v[40:43], v12 offset:64
    ds_read_b128 v[48:51], v12 offset:128
    ds_read_b128 v[56:59], v12 offset:192
    ds_read_b128 v[64:67], v12 offset:256
    ds_read_b128 v[72:75], v12 offset:320
    ds_read_b128 v[80:83], v12 offset:384
    ds_read_b128 v[88:91], v12 offset:448
    ds_read_b128 v[96:99], v12 offset:512
    ds_read_b128 v[104:107], v12 offset:576
    ds_read_b128 v[112:115], v12 offset:640
    ds_read_b128 v[120:123], v12 offset:704
    ds_read_b128 v[128:131], v12 offset:768
    ds_read_b128 v[136:139], v12 offset:832
    v_lshrrev_b32 v10, 7, v1
    v_mul_u32_u24 v6, 5376, v10
    v_and_b32 v10, 2, v10
    v_lshlrev_b32 v10, 5, v10
    v_and_b32 v11, 0x70, v1
    v_xor_b32 v10, v10, v11
    v_add_u32 v6, v6, v10
    s_waitcnt vmcnt(0) lgkmcnt(0)
    s_barrier
    ds_read_b64_tr_b16 v[36:37], v5 offset:0
    ds_read_b64_tr_b16 v[38:39], v5 offset:256
    ds_read_b64_tr_b16 v[44:45], v5 offset:2048
    ds_read_b64_tr_b16 v[46:47], v5 offset:2304
    ds_read_b64_tr_b16 v[52:53], v5 offset:4096
    ds_read_b64_tr_b16 v[54:55], v5 offset:4352
    ds_read_b64_tr_b16 v[60:61], v5 offset:6144
    ds_read_b64_tr_b16 v[62:63], v5 offset:6400
    ds_read_b64_tr_b16 v[68:69], v5 offset:8192
    ds_read_b64_tr_b16 v[70:71], v5 offset:8448
    s_waitcnt lgkmcnt(8)
    v_mfma_f32_16x16x32_bf16 v[16:19], v[32:35], v[36:39], 0
    ds_read_b64_tr_b16 v[76:77], v5 offset:10240
    ds_read_b64_tr_b16 v[78:79], v5 offset:10496
    s_waitcnt lgkmcnt(8)
    v_mfma_f32_16x16x32_bf16 v[16:19], v[40:43], v[44:47], v[16:19]
    ds_read_b64_tr_b16 v[84:85], v5 offset:12288
    ds_read_b64_tr_b16 v[86:87], v5 offset:12544
    s_waitcnt lgkmcnt(8)
    v_mfma_f32_16x16x32_bf16 v[16:19], v[48:51], v[52:55], v[16:19]
    ds_read_b64_tr_b16 v[92:93], v5 offset:14336
    ds_read_b64_tr_b16 v[94:95], v5 offset:14592
    s_waitcnt lgkmcnt(8)
    v_mfma_f32_16x16x32_bf16 v[16:19], v[56:59], v[60:63], v[16:19]
    ds_read_b64_tr_b16 v[100:101], v5 offset:16384
    ds_read_b64_tr_b16 v[102:103], v5 offset:16640
    s_waitcnt lgkmcnt(8)
    v_mfma_f32_16x16x32_bf16 v[16:19], v[64:67], v[68:71], v[16:19]
    ds_read_b64_tr_b16 v[108:109], v5 offset:18432
    ds_read_b64_tr_b16 v[110:111], v5 offset:18688
    s_waitcnt lgkmcnt(8)
    v_mfma_f32_16x16x32_bf16 v[16:19], v[72:75], v[76:79], v[16:19]
    ds_read_b64_tr_b16 v[116:117], v5 offset:20480
    ds_read_b64_tr_b16 v[118:119], v5 offset:20736
    s_waitcnt lgkmcnt(8)
    v_mfma_f32_16x16x32_bf16 v[16:19], v[80:83], v[84:87], v[16:19]
    ds_read_b64_tr_b16 v[124:125], v5 offset:22528
    ds_read_b64_tr_b16 v[126:127], v5 offset:22784
    s_waitcnt lgkmcnt(8)
    v_mfma_f32_16x16x32_bf16 v[16:19], v[88:91], v[92:95], v[16:19]
    ds_read_b64_tr_b16 v[132:133], v5 offset:24576
    ds_read_b64_tr_b16 v[134:135], v5 offset:24832
    s_waitcnt lgkmcnt(8)
    v_mfma_f32_16x16x32_bf16 v[16:19], v[96:99], v[100:103], v[16:19]
    ds_read_b64_tr_b16 v[140:141], v5 offset:26624
    ds_read_b64_tr_b16 v[142:143], v5 offset:26880
    s_waitcnt lgkmcnt(8)
    v_mfma_f32_16x16x32_bf16 v[16:19], v[104:107], v[108:111], v[16:19]
    s_waitcnt lgkmcnt(6)
    v_mfma_f32_16x16x32_bf16 v[16:19], v[112:115], v[116:119], v[16:19]
    s_waitcnt lgkmcnt(4)
    v_mfma_f32_16x16x32_bf16 v[16:19], v[120:123], v[124:127], v[16:19]
    s_waitcnt lgkmcnt(2)
    v_mfma_f32_16x16x32_bf16 v[16:19], v[128:131], v[132:135], v[16:19]
    s_waitcnt lgkmcnt(0)
    v_mfma_f32_16x16x32_bf16 v[16:19], v[136:139], v[140:143], v[16:19]
    s_nop 7
    v_mov_b32_dpp v17, v16 quad_perm:[1,0,3,2] row_mask:0xf bank_mask:0xf
    v_cvt_pk_bf16_f32 v20, v16, v17
    s_mov_b64 exec, 0x5555
    buffer_store_dwordx2 v[20:21], v4, s[32:35], s59 offen sc1
    s_mov_b64 exec, -1
    s_sub_u32 s57, s45, 28
    s_lshl_b32 s57, s57, 3
    s_add_u32 s57, s57, s44
    s_cmp_ge_u32 s57, 28
    s_cbranch_scc1 L_jobs_done
    s_mul_i32 s53, s46, 43008
    s_lshl_b32 s54, s57, 7
    s_add_u32 s53, s53, s54
    s_add_u32 s53, s53, 1792
    s_add_u32 s55, s58, 57344
    s_add_u32 s56, s55, 57344
L_mdma2:
    s_mov_b32 m0, s55
    s_add_u32 s55, s55, 4096
    buffer_load_dwordx4 v6, s[36:39], s53 offen lds
    s_add_u32 s53, s53, 172032
    s_cmp_lg_u32 s55, s56
    s_cbranch_scc1 L_mdma2
    v_add_u32 v2, 57344, v2
    s_lshl_b32 s59, s57, 8
    s_lshl_b32 s54, s46, 6
    s_add_u32 s59, s59, s54
    s_add_u32 s59, s59, 7680
    s_waitcnt vmcnt(0) lgkmcnt(0)
    s_barrier
    ds_read_b64_tr_b16 v[36:37], v2 offset:0
    ds_read_b64_tr_b16 v[38:39], v2 offset:512
    ds_read_b64_tr_b16 v[44:45], v2 offset:4096
    ds_read_b64_tr_b16 v[46:47], v2 offset:4608
    ds_read_b64_tr_b16 v[52:53], v2 offset:8192
    ds_read_b64_tr_b16 v[54:55], v2 offset:8704
    ds_read_b64_tr_b16 v[60:61], v2 offset:12288
    ds_read_b64_tr_b16 v[62:63], v2 offset:12800
    ds_read_b64_tr_b16 v[68:69], v2 offset:16384
    ds_read_b64_tr_b16 v[70:71], v2 offset:16896
    s_waitcnt lgkmcnt(8)
    v_mfma_f32_16x16x32_bf16 v[16:19], v[32:35], v[36:39], 0
    ds_read_b64_tr_b16 v[76:77], v2 offset:20480
    ds_read_b64_tr_b16 v[78:79], v2 offset:20992
    s_waitcnt lgkmcnt(8)
    v_mfma_f32_16x16x32_bf16 v[16:19], v[40:43], v[44:47], v[16:19]
    ds_read_b64_tr_b16 v[84:85], v2 offset:24576
    ds_read_b64_tr_b16 v[86:87], v2 offset:25088
    s_waitcnt lgkmcnt(8)
    v_mfma_f32_16x16x32_bf16 v[16:19], v[48:51], v[52:55], v[16:19]
    ds_read_b64_tr_b16 v[92:93], v2 offset:28672
    ds_read_b64_tr_b16 v[94:95], v2 offset:29184
    s_waitcnt lgkmcnt(8)
    v_mfma_f32_16x16x32_bf16 v[16:19], v[56:59], v[60:63], v[16:19]
    ds_read_b64_tr_b16 v[100:101], v2 offset:32768
    ds_read_b64_tr_b16 v[102:103], v2 offset:33280
    s_waitcnt lgkmcnt(8)
    v_mfma_f32_16x16x32_bf16 v[16:19], v[64:67], v[68:71], v[16:19]
    ds_read_b64_tr_b16 v[108:109], v2 offset:36864
    ds_read_b64_tr_b16 v[110:111], v2 offset:37376
    s_waitcnt lgkmcnt(8)
    v_mfma_f32_16x16x32_bf16 v[16:19], v[72:75], v[76:79], v[16:19]
    ds_read_b64_tr_b16 v[116:117], v2 offset:40960
    ds_read_b64_tr_b16 v[118:119], v2 offset:41472
    s_waitcnt lgkmcnt(8)
    v_mfma_f32_16x16x32_bf16 v[16:19], v[80:83], v[84:87], v[16:19]
    ds_read_b64_tr_b16 v[124:125], v2 offset:45056
    ds_read_b64_tr_b16 v[126:127], v2 offset:45568
    s_waitcnt lgkmcnt(8)
    v_mfma_f32_16x16x32_bf16 v[16:19], v[88:91], v[92:95], v[16:19]
    ds_read_b64_tr_b16 v[132:133], v2 offset:49152
    ds_read_b64_tr_b16 v[134:135], v2 offset:49664
    s_waitcnt lgkmcnt(8)
    v_mfma_f32_16x16x32_bf16 v[16:19], v[96:99], v[100:103], v[16:19]
    ds_read_b64_tr_b16 v[140:141], v2 offset:53248
    ds_read_b64_tr_b16 v[142:143], v2 offset:53760
    s_waitcnt lgkmcnt(8)
    v_mfma_f32_16x16x32_bf16 v[16:19], v[104:107], v[108:111], v[16:19]
    s_waitcnt lgkmcnt(6)
    v_mfma_f32_16x16x32_bf16 v[16:19], v[112:115], v[116:119], v[16:19]
    s_waitcnt lgkmcnt(4)
    v_mfma_f32_16x16x32_bf16 v[16:19], v[120:123], v[124:127], v[16:19]
    s_waitcnt lgkmcnt(2)
    v_mfma_f32_16x16x32_bf16 v[16:19], v[128:131], v[132:135], v[16:19]
    s_waitcnt lgkmcnt(0)
    v_mfma_f32_16x16x32_bf16 v[16:19], v[136:139], v[140:143], v[16:19]
    s_nop 7
    v_mov_b32_dpp v17, v16 quad_perm:[1,0,3,2] row_mask:0xf bank_mask:0xf
    v_cvt_pk_bf16_f32 v20, v16, v17
    s_mov_b64 exec, 0x5555
    buffer_store_dwordx2 v[20:21], v4, s[32:35], s59 offen sc1
    s_mov_b64 exec, -1
L_jobs_done:
    s_cmp_lg_u32 s57, 31
    s_cbranch_scc1 L_no_epoch
    v_lshlrev_b32 v8, 3, v0
    s_mov_b32 s53, 1024
    s_mov_b32 s52, 0
    buffer_load_dwordx2 v[10:11], v8, s[32:35], s53 offen sc1
L_poll_20:
    s_waitcnt vmcnt(0)
    v_cmp_ne_u32 vcc, s47, v11
    s_cbranch_vccnz L_poll_20_again
    s_barrier
    v_mov_b32 v8, 0
    s_cmp_eq_u32 s46, 0
    s_cselect_b64 exec, 1, 0
    buffer_store_dword v11, v8, s[32:35], 0 offen sc1
    s_mov_b64 exec, -1
L_no_epoch:
    v_lshlrev_b32 v8, 3, v1
    s_sub_u32 s53, s45, 28
    s_lshl_b32 s53, s53, 2
    s_add_u32 s53, s53, s46
    s_lshl_b32 s53, s53, 11
    s_add_u32 s53, s53, s48
    s_add_u32 s53, s53, 917504
    s_mov_b64 exec, 0xffff
    buffer_load_dword a255, v8, s[32:35], s53 offen
    s_mov_b64 exec, -1
    v_lshlrev_b32 v8, 3, v1
    s_sub_u32 s55, s45, 28
    s_lshl_b32 s55, s55, 2
    s_add_u32 s55, s55, s46
    s_lshl_b32 s55, s55, 13
    s_add_u32 s55, s55, 0
    s_mul_i32 s53, s44, 1
    s_lshr_b32 s53, s53, 3
    s_mov_b32 s56, 1
L_gp_21:
    s_lshl_b32 s54, s53, 17
    s_add_u32 s54, s54, s55
    buffer_load_dword a255, v8, s[16:19], s54 offen
    buffer_load_dword a255, v8, s[20:23], s54 offen
    s_add_u32 s53, s53, 1
    s_cmp_eq_u32 s53, 1
    s_cselect_b32 s53, 0, s53
    s_waitcnt vmcnt(2)
    s_sub_u32 s56, s56, 1
    s_cmp_lg_u32 s56, 0
    s_cbranch_scc1 L_gp_21
    v_and_b32 v10, 0x1f0, v1
    v_lshrrev_b32 v10, 1, v10
    s_lshl_b32 s59, s44, 8
    s_mov_b32 s52, 0
    buffer_load_dwordx2 v[4:5], v10, s[32:35], s59 offen offset:1024 sc1
L_poll_22:
    s_waitcnt vmcnt(0)
    v_cmp_ne_u32 vcc, s47, v5
    s_cbranch_vccnz L_poll_22_again
    s_waitcnt vmcnt(0) lgkmcnt(0)
    s_barrier
    v_mov_b32 v2, 0
    v_mov_b32 v3, 0
    v_mov_b32 v240, 0
    v_mov_b32 v241, 0
    v_mov_b32 v242, 0
    s_and_b32 s36, s45, 15
    s_lshr_b32 s37, s45, 4
    s_mul_i32 s38, s36, 7
    s_lshr_b32 s38, s38, 1
    s_bitcmp1_b32 s36, 0
    s_cselect_b32 s100, 15, 0xf0000000
    s_mov_b32 s101, s100
    s_lshl_b32 s41, s46, 12
    s_add_u32 s41, s41, 114688
    v_add_u32 v12, s41, v1
    v_bfe_u32 v24, v1, 4, 5
    v_lshrrev_b32 v25, 9, v1
    v_lshlrev_b32 v26, 2, v25
    v_sub_u32 v26, v24, v26
    v_cmp_le_i32 s[64:65], 0, v26
    v_cmp_le_i32 s[66:67], 1, v26
    v_cmp_le_i32 s[68:69], 2, v26
    v_cmp_le_i32 s[70:71], 3, v26
    v_cmp_le_i32 s[72:73], 8, v26
    v_cmp_le_i32 s[74:75], 9, v26
    v_cmp_le_i32 s[76:77], 10, v26
    v_cmp_le_i32 s[78:79], 11, v26
    v_cmp_le_i32 s[80:81], 16, v26
    v_cmp_le_i32 s[82:83], 17, v26
    v_cmp_le_i32 s[84:85], 18, v26
    v_cmp_le_i32 s[86:87], 19, v26
    v_cmp_le_i32 s[88:89], 24, v26
    v_cmp_le_i32 s[90:91], 25, v26
    v_cmp_le_i32 s[92:93], 26, v26
    v_cmp_le_i32 s[94:95], 27, v26
    v_mov_b32 v27, 0
    v_mov_b32 v28, 0xffff
    v_mov_b32 v29, 0xffff0000
    v_cndmask_b32 v16, v27, v28, s[64:65]
    v_cndmask_b32 v30, v27, v29, s[66:67]
    v_or_b32 v16, v16, v30
    v_cndmask_b32 v17, v27, v28, s[68:69]
    v_cndmask_b32 v30, v27, v29, s[70:71]
    v_or_b32 v17, v17, v30
    v_cndmask_b32 v18, v27, v28, s[72:73]
    v_cndmask_b32 v30, v27, v29, s[74:75]
    v_or_b32 v18, v18, v30
    v_cndmask_b32 v19, v27, v28, s[76:77]
    v_cndmask_b32 v30, v27, v29, s[78:79]
    v_or_b32 v19, v19, v30
    v_cndmask_b32 v20, v27, v28, s[80:81]
    v_cndmask_b32 v30, v27, v29, s[82:83]
    v_or_b32 v20, v20, v30
    v_cndmask_b32 v21, v27, v28, s[84:85]
    v_cndmask_b32 v30, v27, v29, s[86:87]
    v_or_b32 v21, v21, v30
    v_cndmask_b32 v22, v27, v28, s[88:89]
    v_cndmask_b32 v30, v27, v29, s[90:91]
    v_or_b32 v22, v22, v30
    v_cndmask_b32 v23, v27, v28, s[92:93]
    v_cndmask_b32 v30, v27, v29, s[94:95]
    v_or_b32 v23, v23, v30
    v_and_b32 v26, 0x13, v24
    v_and_b32 v27, 4, v24
    v_lshl_or_b32 v26, v27, 1, v26
    v_and_b32 v27, 8, v24
    v_lshrrev_b32 v27, 1, v27
    v_or_b32 v26, v26, v27
    v_lshlrev_b32 v26, 4, v26
    v_mul_u32_u24 v13, 7168, v25
    v_add_u32 v13, v13, v26
    s_lshl_b32 s53, s37, 2
    s_add_u32 s53, s53, s46
    s_sub_u32 s39, 8, s53
    s_cmp_eq_u32 s44, 0
    s_cselect_b32 s39, s39, 0
    s_mul_i32 s40, s53, 28672
    s_add_u32 s40, s40, s48
    s_lshr_b32 s53, s38, 3
    s_add_u32 s54, s38, 3
    s_lshr_b32 s54, s54, 3
    s_sub_u32 s54, s54, s53
    v_bfe_u32 v25, v24, 3, 1
    v_mul_u32_u24 v25, s54, v25
    v_add_u32 v25, s53, v25
    v_and_b32 v26, 7, v24
    v_min_u32 v26, 5, v26
    s_lshl3_add_u32 s53, s44, 0
    s_lshr_b32 s53, s53, 1
    s_lshl1_add_u32 s53, s37, s53
    v_add_u32 v26, s53, v26
    v_subrev_u32 v26, 4, v26
    v_max_i32 v26, 0, v26
    v_lshrrev_b32 v27, 2, v26
    v_and_b32 v26, 3, v26
    v_mul_u32_u24 v26, 7, v26
    v_lshl_add_u32 v26, v27, 5, v26
    v_add_u32 v26, v26, v25
    v_lshlrev_b32 v26, 7, v26
    v_add_u32 v14, 32768, v26
    v_bfe_u32 v26, v24, 1, 1
    s_lshl_b32 s53, s37, 1
    v_add_u32 v26, s53, v26
    v_mul_u32_u24 v26, 7, v26
    v_add_u32 v26, v26, v25
    v_and_b32 v27, 1, v24
    v_lshlrev_b32 v27, 3, v27
    v_lshl_add_u32 v26, v26, 4, v27
    v_add_u32 v243, 946176, v26
    v_lshrrev_b32 v24, 7, v1
    v_mul_u32_u24 v15, 3584, v24
    v_and_b32 v24, 2, v24
    v_lshlrev_b32 v24, 5, v24
    v_and_b32 v25, 0x70, v1
    v_xor_b32 v24, v24, v25
    v_add_u32 v15, v15, v24
    s_sub_u32 s53, s45, 28
    s_lshl3_add_u32 s53, s53, s44
    s_cmp_lt_u32 s45, 28
    s_cselect_b32 s53, s45, s53
    s_min_u32 s53, s53, 27
    s_lshl_b32 s53, s53, 7
    s_mul_i32 s54, s46, 28672
    s_add_u32 s42, s53, s54
    v_mov_b32 v24, 0x3f803f80
    v_mov_b32 v25, 0x3f803f80
    v_mov_b32 v26, 0x3f803f80
    v_mov_b32 v27, 0x3f803f80
    s_mov_b64 exec, s[100:101]
    ds_write_b128 v12, v[24:27] offset:2048
    ds_write_b128 v12, v[24:27] offset:3072
    ds_write_b128 v12, v[24:27] offset:18432
    ds_write_b128 v12, v[24:27] offset:19456
    ds_write_b128 v12, v[24:27] offset:34816
    ds_write_b128 v12, v[24:27] offset:35840
    s_mov_b64 exec, -1
    v_xor_b32 v6, 32, v15
    s_lshl_b32 s58, s46, 10
    s_lshl_b32 s54, s38, 9
    s_add_u32 s55, s40, s54
    s_mov_b32 s3, s55
    s_lshl_b32 s53, s38, 7
    s_add_u32 s59, s40, s53
    s_add_u32 s59, s59, 458752
    s_add_u32 s55, s55, 229376
    s_cmp_eq_u32 s44, 0
    s_cselect_b32 s60, 2130706432, 0
    s_sub_u32 s60, s60, 1867776
    s_add_u32 s53, s55, s60
    s_sub_u32 s53, s53, 229376
    s_add_u32 s56, s59, s60
    s_sub_u32 s56, s56, 229376
    s_cmp_eq_u32 s37, 0
    s_cselect_b32 s60, s60, 0
    s_add_u32 s54, s55, s60
    s_sub_u32 s54, s54, 114688
    s_add_u32 s57, s59, s60
    s_sub_u32 s57, s57, 114688
    v_cmp_ne_u32 vcc, s51, v4
    s_cbranch_vccnz L_p2_slow
    s_branch L_p2_fast
L_helper_tail:
    s_barrier
    s_add_u32 m0, s58, 28672
    s_add_u32 s60, s42, 802816
    buffer_load_dwordx4 v15, s[16:19], s60 offen lds
    s_add_u32 m0, s58, 86016
    s_add_u32 s60, s42, 802816
    buffer_load_dwordx4 v6, s[20:23], s60 offen lds
    s_add_u32 m0, s58, 32768
    s_add_u32 s60, s42, 917504
    buffer_load_dwordx4 v15, s[16:19], s60 offen lds
    s_add_u32 m0, s58, 90112
    s_add_u32 s60, s42, 917504
    buffer_load_dwordx4 v6, s[20:23], s60 offen lds
    s_add_u32 m0, s58, 36864
    s_add_u32 s60, s42, 1032192
    buffer_load_dwordx4 v15, s[16:19], s60 offen lds
    s_add_u32 m0, s58, 94208
    s_add_u32 s60, s42, 1032192
    buffer_load_dwordx4 v6, s[20:23], s60 offen lds
    s_add_u32 m0, s58, 40960
    s_add_u32 s60, s42, 1146880
    buffer_load_dwordx4 v15, s[16:19], s60 offen lds
    s_add_u32 m0, s58, 98304
    s_add_u32 s60, s42, 1146880
    buffer_load_dwordx4 v6, s[20:23], s60 offen lds
    s_add_u32 m0, s58, 45056
    s_add_u32 s60, s42, 1261568
    buffer_load_dwordx4 v15, s[16:19], s60 offen lds
    s_add_u32 m0, s58, 102400
    s_add_u32 s60, s42, 1261568
    buffer_load_dwordx4 v6, s[20:23], s60 offen lds
    s_add_u32 m0, s58, 49152
    s_add_u32 s60, s42, 1376256
    buffer_load_dwordx4 v15, s[16:19], s60 offen lds
    s_add_u32 m0, s58, 106496
    s_add_u32 s60, s42, 1376256
    buffer_load_dwordx4 v6, s[20:23], s60 offen lds
    s_add_u32 m0, s58, 53248
    s_add_u32 s60, s42, 1490944
    buffer_load_dwordx4 v15, s[16:19], s60 offen lds
    s_add_u32 m0, s58, 110592
    s_add_u32 s60, s42, 1490944
    buffer_load_dwordx4 v6, s[20:23], s60 offen lds
    s_sub_u32 s57, s45, 28
    s_lshl3_add_u32 s57, s57, s44
    s_cmp_ge_u32 s57, 28
    s_cbranch_scc1 L_no_uv
    v_min_u32 v8, 223, v0
    v_lshlrev_b32 v9, 3, v8
    s_mov_b32 s53, 9472
    s_mov_b32 s52, 0
    buffer_load_dwordx2 v[10:11], v9, s[32:35], s53 offen offset:0 sc1
    buffer_load_dwordx2 v[12:13], v9, s[32:35], s53 offen offset:1792 sc1
L_poll_23:
    s_waitcnt vmcnt(0)
    v_cmp_ne_u32 vcc, s47, v11
    v_cmp_ne_u32 s[98:99], s47, v13
    s_nop 0
    s_or_b64 vcc, vcc, s[98:99]
    s_cbranch_vccnz L_poll_23_again
    v_lshlrev_b32 v18, 16, v12
    v_and_b32 v19, 0xffff0000, v12
    v_add_f32 v18, 1.0, v18
    v_add_f32 v19, 1.0, v19
    v_cvt_pk_bf16_f32 v12, v18, v19
    v_lshlrev_b32 v8, 2, v8
    v_add_u32 v8, 159744, v8
    ds_write_b32 v8, v10
    ds_write_b32 v8, v12 offset:896
    v_lshrrev_b32 v8, 4, v1
    v_bfe_u32 v9, v8, 2, 2
    v_lshrrev_b32 v10, 5, v8
    v_lshl_add_u32 v10, v10, 3, v9
    v_lshlrev_b32 v14, 7, v10
    v_lshrrev_b32 v9, 1, v9
    v_lshlrev_b32 v9, 6, v9
    v_and_b32 v10, 1, v8
    v_lshlrev_b32 v10, 4, v10
    v_xor_b32 v9, v9, v10
    v_and_b32 v10, 2, v8
    v_lshlrev_b32 v10, 2, v10
    v_xor_b32 v9, v9, v10
    v_and_b32 v10, 16, v8
    v_lshlrev_b32 v10, 1, v10
    v_xor_b32 v9, v9, v10
    v_add_u32 v14, v14, v9
    v_bfe_u32 v8, v1, 8, 1
    v_mul_u32_u24 v8, 57344, v8
    v_add_u32 v14, v14, v8
    s_lshl_b32 s53, s46, 5
    v_xor_b32 v14, s53, v14
    v_bfe_u32 v8, v1, 4, 5
    v_cmp_eq_u32 vcc, 1, v8
    v_mov_b32 v8, 160640
    v_mov_b32 v9, 159744
    v_cndmask_b32 v8, v8, v9, vcc
    v_lshrrev_b32 v9, 9, v1
    v_lshl_add_u32 v15, v9, 4, v8
    s_waitcnt vmcnt(0) lgkmcnt(0)
    s_barrier
    ds_read_b128 v[32:35], v15 offset:0
    ds_read_b64_tr_b16 v[36:37], v14 offset:0
    ds_read_b64_tr_b16 v[38:39], v14 offset:512
    ds_read_b128 v[40:43], v15 offset:32
    ds_read_b64_tr_b16 v[44:45], v14 offset:2048
    ds_read_b64_tr_b16 v[46:47], v14 offset:2560
    ds_read_b128 v[48:51], v15 offset:64
    ds_read_b64_tr_b16 v[52:53], v14 offset:4096
    ds_read_b64_tr_b16 v[54:55], v14 offset:4608
    ds_read_b128 v[56:59], v15 offset:96
    ds_read_b64_tr_b16 v[60:61], v14 offset:6144
    ds_read_b64_tr_b16 v[62:63], v14 offset:6656
    ds_read_b128 v[64:67], v15 offset:128
    ds_read_b64_tr_b16 v[68:69], v14 offset:8192
    ds_read_b64_tr_b16 v[70:71], v14 offset:8704
    s_waitcnt lgkmcnt(12)
    v_mfma_f32_32x32x16_bf16 v[160:175], v[32:35], v[36:39], 0
    ds_read_b128 v[72:75], v15 offset:160
    ds_read_b64_tr_b16 v[76:77], v14 offset:10240
    ds_read_b64_tr_b16 v[78:79], v14 offset:10752
    s_waitcnt lgkmcnt(12)
    v_mfma_f32_32x32x16_bf16 v[160:175], v[40:43], v[44:47], v[160:175]
    ds_read_b128 v[80:83], v15 offset:192
    ds_read_b64_tr_b16 v[84:85], v14 offset:12288
    ds_read_b64_tr_b16 v[86:87], v14 offset:12800
    s_waitcnt lgkmcnt(12)
    v_mfma_f32_32x32x16_bf16 v[160:175], v[48:51], v[52:55], v[160:175]
    ds_read_b128 v[88:91], v15 offset:224
    ds_read_b64_tr_b16 v[92:93], v14 offset:14336
    ds_read_b64_tr_b16 v[94:95], v14 offset:14848
    s_waitcnt lgkmcnt(12)
    v_mfma_f32_32x32x16_bf16 v[160:175], v[56:59], v[60:63], v[160:175]
    ds_read_b128 v[32:35], v15 offset:256
    ds_read_b64_tr_b16 v[36:37], v14 offset:16384
    ds_read_b64_tr_b16 v[38:39], v14 offset:16896
    s_waitcnt lgkmcnt(12)
    v_mfma_f32_32x32x16_bf16 v[160:175], v[64:67], v[68:71], v[160:175]
    ds_read_b128 v[40:43], v15 offset:288
    ds_read_b64_tr_b16 v[44:45], v14 offset:18432
    ds_read_b64_tr_b16 v[46:47], v14 offset:18944
    s_waitcnt lgkmcnt(12)
    v_mfma_f32_32x32x16_bf16 v[160:175], v[72:75], v[76:79], v[160:175]
    ds_read_b128 v[48:51], v15 offset:320
    ds_read_b64_tr_b16 v[52:53], v14 offset:20480
    ds_read_b64_tr_b16 v[54:55], v14 offset:20992
    s_waitcnt lgkmcnt(12)
    v_mfma_f32_32x32x16_bf16 v[160:175], v[80:83], v[84:87], v[160:175]
    ds_read_b128 v[56:59], v15 offset:352
    ds_read_b64_tr_b16 v[60:61], v14 offset:22528
    ds_read_b64_tr_b16 v[62:63], v14 offset:23040
    s_waitcnt lgkmcnt(12)
    v_mfma_f32_32x32x16_bf16 v[160:175], v[88:91], v[92:95], v[160:175]
    ds_read_b128 v[64:67], v15 offset:384
    ds_read_b64_tr_b16 v[68:69], v14 offset:24576
    ds_read_b64_tr_b16 v[70:71], v14 offset:25088
    s_waitcnt lgkmcnt(12)
    v_mfma_f32_32x32x16_bf16 v[160:175], v[32:35], v[36:39], v[160:175]
    ds_read_b128 v[72:75], v15 offset:416
    ds_read_b64_tr_b16 v[76:77], v14 offset:26624
    ds_read_b64_tr_b16 v[78:79], v14 offset:27136
    s_waitcnt lgkmcnt(12)
    v_mfma_f32_32x32x16_bf16 v[160:175], v[40:43], v[44:47], v[160:175]
    ds_read_b128 v[80:83], v15 offset:448
    ds_read_b64_tr_b16 v[84:85], v14 offset:28672
    ds_read_b64_tr_b16 v[86:87], v14 offset:29184
    s_waitcnt lgkmcnt(12)
    v_mfma_f32_32x32x16_bf16 v[160:175], v[48:51], v[52:55], v[160:175]
    ds_read_b128 v[88:91], v15 offset:480
    ds_read_b64_tr_b16 v[92:93], v14 offset:30720
    ds_read_b64_tr_b16 v[94:95], v14 offset:31232
    s_waitcnt lgkmcnt(12)
    v_mfma_f32_32x32x16_bf16 v[160:175], v[56:59], v[60:63], v[160:175]
    ds_read_b128 v[32:35], v15 offset:512
    ds_read_b64_tr_b16 v[36:37], v14 offset:32768
    ds_read_b64_tr_b16 v[38:39], v14 offset:33280
    s_waitcnt lgkmcnt(12)
    v_mfma_f32_32x32x16_bf16 v[160:175], v[64:67], v[68:71], v[160:175]
    ds_read_b128 v[40:43], v15 offset:544
    ds_read_b64_tr_b16 v[44:45], v14 offset:34816
    ds_read_b64_tr_b16 v[46:47], v14 offset:35328
    s_waitcnt lgkmcnt(12)
    v_mfma_f32_32x32x16_bf16 v[160:175], v[72:75], v[76:79], v[160:175]
    ds_read_b128 v[48:51], v15 offset:576
    ds_read_b64_tr_b16 v[52:53], v14 offset:36864
    ds_read_b64_tr_b16 v[54:55], v14 offset:37376
    s_waitcnt lgkmcnt(12)
    v_mfma_f32_32x32x16_bf16 v[160:175], v[80:83], v[84:87], v[160:175]
    ds_read_b128 v[56:59], v15 offset:608
    ds_read_b64_tr_b16 v[60:61], v14 offset:38912
    ds_read_b64_tr_b16 v[62:63], v14 offset:39424
    s_waitcnt lgkmcnt(12)
    v_mfma_f32_32x32x16_bf16 v[160:175], v[88:91], v[92:95], v[160:175]
    ds_read_b128 v[64:67], v15 offset:640
    ds_read_b64_tr_b16 v[68:69], v14 offset:40960
    ds_read_b64_tr_b16 v[70:71], v14 offset:41472
    s_waitcnt lgkmcnt(12)
    v_mfma_f32_32x32x16_bf16 v[160:175], v[32:35], v[36:39], v[160:175]
    ds_read_b128 v[72:75], v15 offset:672
    ds_read_b64_tr_b16 v[76:77], v14 offset:43008
    ds_read_b64_tr_b16 v[78:79], v14 offset:43520
    s_waitcnt lgkmcnt(12)
    v_mfma_f32_32x32x16_bf16 v[160:175], v[40:43], v[44:47], v[160:175]
    ds_read_b128 v[80:83], v15 offset:704
    ds_read_b64_tr_b16 v[84:85], v14 offset:45056
    ds_read_b64_tr_b16 v[86:87], v14 offset:45568
    s_waitcnt lgkmcnt(12)
    v_mfma_f32_32x32x16_bf16 v[160:175], v[48:51], v[52:55], v[160:175]
    ds_read_b128 v[88:91], v15 offset:736
    ds_read_b64_tr_b16 v[92:93], v14 offset:47104
    ds_read_b64_tr_b16 v[94:95], v14 offset:47616
    s_waitcnt lgkmcnt(12)
    v_mfma_f32_32x32x16_bf16 v[160:175], v[56:59], v[60:63], v[160:175]
    ds_read_b128 v[32:35], v15 offset:768
    ds_read_b64_tr_b16 v[36:37], v14 offset:49152
    ds_read_b64_tr_b16 v[38:39], v14 offset:49664
    s_waitcnt lgkmcnt(12)
    v_mfma_f32_32x32x16_bf16 v[160:175], v[64:67], v[68:71], v[160:175]
    ds_read_b128 v[40:43], v15 offset:800
    ds_read_b64_tr_b16 v[44:45], v14 offset:51200
    ds_read_b64_tr_b16 v[46:47], v14 offset:51712
    s_waitcnt lgkmcnt(12)
    v_mfma_f32_32x32x16_bf16 v[160:175], v[72:75], v[76:79], v[160:175]
    ds_read_b128 v[48:51], v15 offset:832
    ds_read_b64_tr_b16 v[52:53], v14 offset:53248
    ds_read_b64_tr_b16 v[54:55], v14 offset:53760
    s_waitcnt lgkmcnt(12)
    v_mfma_f32_32x32x16_bf16 v[160:175], v[80:83], v[84:87], v[160:175]
    ds_read_b128 v[56:59], v15 offset:864
    ds_read_b64_tr_b16 v[60:61], v14 offset:55296
    ds_read_b64_tr_b16 v[62:63], v14 offset:55808
    s_waitcnt lgkmcnt(12)
    v_mfma_f32_32x32x16_bf16 v[160:175], v[88:91], v[92:95], v[160:175]
    s_waitcnt lgkmcnt(9)
    v_mfma_f32_32x32x16_bf16 v[160:175], v[32:35], v[36:39], v[160:175]
    s_waitcnt lgkmcnt(6)
    v_mfma_f32_32x32x16_bf16 v[160:175], v[40:43], v[44:47], v[160:175]
    s_waitcnt lgkmcnt(3)
    v_mfma_f32_32x32x16_bf16 v[160:175], v[48:51], v[52:55], v[160:175]
    s_waitcnt lgkmcnt(0)
    v_mfma_f32_32x32x16_bf16 v[160:175], v[56:59], v[60:63], v[160:175]
    s_mov_b32 s53, 0x05040100
    s_mov_b32 s54, 0x07060302
    s_lshl2_add_u32 s55, s57, s46
    s_lshl_b32 s56, s55, 10
    s_add_u32 s56, s56, 131072
    s_lshl_b32 s55, s55, 2
    s_nop 5
    v_cvt_pk_bf16_f32 v16, v160, v161
    v_lshlrev_b32 v17, 16, v16
    v_and_b32 v18, 0xffff0000, v16
    v_sub_f32 v17, v160, v17
    v_sub_f32 v18, v161, v18
    v_cvt_pk_bf16_f32 v17, v17, v18
    v_perm_b32 v24, v17, v16, s53
    v_mov_b32 v25, v16
    v_perm_b32 v26, v16, v17, s54
    v_mov_b32 v27, 0
    s_mov_b32 exec_lo, 0
    v_mov_b32 v24, 0
    v_mov_b32 v25, 0
    v_mov_b32 v26, 0
    s_mov_b64 exec, -1
    buffer_store_dwordx4 v[24:27], v1, s[32:35], s56 offen sc1
    v_mov_b32 v8, 16384
    v_mov_b32 v9, s47
    s_waitcnt vmcnt(0)
    s_mov_b64 exec, 1
    buffer_store_dword v9, v8, s[32:35], s55 offen sc1
    s_mov_b64 exec, -1
L_no_uv:
    v_lshlrev_b32 v8, 3, v1
    s_sub_u32 s53, s2, 224
    s_lshl2_add_u32 s53, s53, s46
    s_mul_i32 s53, s53, 12544
    s_mov_b32 exec_hi, 0x1ffff
    buffer_load_dword a255, v8, s[24:27], s53 offen
    s_add_u32 s53, s53, 6272
    buffer_load_dword a255, v8, s[24:27], s53 offen
    s_mov_b64 exec, -1
    s_branch L_end
L_chk_1:
    s_mov_b32 s52, 0
L_chk_1_spin:
    buffer_load_dwordx4 v[160:163], v30, s[32:35], s53 offen offset:0 sc1
    buffer_load_dwordx4 v[164:167], v30, s[32:35], s53 offen offset:16 sc1
    buffer_load_dwordx4 v[168:171], v30, s[32:35], s53 offen offset:1792 sc1
    buffer_load_dwordx4 v[172:175], v30, s[32:35], s53 offen offset:1808 sc1
    buffer_load_dwordx2 v[14:15], v31, s[32:35], s59 offen offset:1024 sc1
    s_add_u32 s52, s52, 1
    s_cmp_gt_u32 s52, 262144
    s_cbranch_scc1 L_abort
    s_waitcnt vmcnt(0)
    v_xor_b32 v255, s47, v161
    v_bitop3_b32 v255, v255, v163, s47 bitop3:0xf6
    v_bitop3_b32 v255, v255, v165, s47 bitop3:0xf6
    v_bitop3_b32 v255, v255, v167, s47 bitop3:0xf6
    v_bitop3_b32 v255, v255, v169, s47 bitop3:0xf6
    v_bitop3_b32 v255, v255, v171, s47 bitop3:0xf6
    v_bitop3_b32 v255, v255, v173, s47 bitop3:0xf6
    v_bitop3_b32 v255, v255, v175, s47 bitop3:0xf6
    v_bitop3_b32 v255, v255, v15, s47 bitop3:0xf6
    v_cmp_ne_u32 vcc, 0, v255
    s_cbranch_vccnz L_chk_1_spin
    s_branch L_chk_1_back
L_poll_2_again:
    buffer_load_dword v8, v14, s[32:35], 0 offen sc1
    buffer_load_dwordx2 v[10:11], v243, s[32:35], s48 offen sc1
    s_add_u32 s52, s52, 1
    s_cmp_gt_u32 s52, 262144
    s_cbranch_scc0 L_poll_2
    s_branch L_abort
L_miss_3:
    s_nop 15
    v_mov_b32 v32, 0xf149f2ca
    v_mov_b32 v33, 0xf149f2ca
    v_mov_b32 v34, 0xf149f2ca
    v_mov_b32 v35, 0xf149f2ca
    v_mov_b32 v36, 0xf149f2ca
    v_mov_b32 v37, 0xf149f2ca
    v_mov_b32 v38, 0xf149f2ca
    v_mov_b32 v39, 0xf149f2ca
    v_mov_b32 v40, 0xf149f2ca
    v_mov_b32 v41, 0xf149f2ca
    v_mov_b32 v42, 0xf149f2ca
    v_mov_b32 v43, 0xf149f2ca
    v_mov_b32 v44, 0xf149f2ca
    v_mov_b32 v45, 0xf149f2ca
    v_mov_b32 v46, 0xf149f2ca
    v_mov_b32 v47, 0xf149f2ca
    s_branch L_miss_3_back
L_miss_4:
    s_nop 15
    v_mov_b32 v48, 0xf149f2ca
    v_mov_b32 v49, 0xf149f2ca
    v_mov_b32 v50, 0xf149f2ca
    v_mov_b32 v51, 0xf149f2ca
    v_mov_b32 v52, 0xf149f2ca
    v_mov_b32 v53, 0xf149f2ca
    v_mov_b32 v54, 0xf149f2ca
    v_mov_b32 v55, 0xf149f2ca
    v_mov_b32 v56, 0xf149f2ca
    v_mov_b32 v57, 0xf149f2ca
    v_mov_b32 v58, 0xf149f2ca
    v_mov_b32 v59, 0xf149f2ca
    v_mov_b32 v60, 0xf149f2ca
    v_mov_b32 v61, 0xf149f2ca
    v_mov_b32 v62, 0xf149f2ca
    v_mov_b32 v63, 0xf149f2ca
    s_branch L_miss_4_back
L_miss_5:
    s_nop 15
    v_mov_b32 v64, 0xf149f2ca
    v_mov_b32 v65, 0xf149f2ca
    v_mov_b32 v66, 0xf149f2ca
    v_mov_b32 v67, 0xf149f2ca
    v_mov_b32 v68, 0xf149f2ca
    v_mov_b32 v69, 0xf149f2ca
    v_mov_b32 v70, 0xf149f2ca
    v_mov_b32 v71, 0xf149f2ca
    v_mov_b32 v72, 0xf149f2ca
    v_mov_b32 v73, 0xf149f2ca
    v_mov_b32 v74, 0xf149f2ca
    v_mov_b32 v75, 0xf149f2ca
    v_mov_b32 v76, 0xf149f2ca
    v_mov_b32 v77, 0xf149f2ca
    v_mov_b32 v78, 0xf149f2ca
    v_mov_b32 v79, 0xf149f2ca
    s_branch L_miss_5_back
L_miss_6:
    s_nop 15
    v_mov_b32 v80, 0xf149f2ca
    v_mov_b32 v81, 0xf149f2ca
    v_mov_b32 v82, 0xf149f2ca
    v_mov_b32 v83, 0xf149f2ca
    v_mov_b32 v84, 0xf149f2ca
    v_mov_b32 v85, 0xf149f2ca
    v_mov_b32 v86, 0xf149f2ca
    v_mov_b32 v87, 0xf149f2ca
    v_mov_b32 v88, 0xf149f2ca
    v_mov_b32 v89, 0xf149f2ca
    v_mov_b32 v90, 0xf149f2ca
    v_mov_b32 v91, 0xf149f2ca
    v_mov_b32 v92, 0xf149f2ca
    v_mov_b32 v93, 0xf149f2ca
    v_mov_b32 v94, 0xf149f2ca
    v_mov_b32 v95, 0xf149f2ca
    s_branch L_miss_6_back
L_miss_7:
    s_nop 15
    v_mov_b32 v96, 0xf149f2ca
    v_mov_b32 v97, 0xf149f2ca
    v_mov_b32 v98, 0xf149f2ca
    v_mov_b32 v99, 0xf149f2ca
    v_mov_b32 v100, 0xf149f2ca
    v_mov_b32 v101, 0xf149f2ca
    v_mov_b32 v102, 0xf149f2ca
    v_mov_b32 v103, 0xf149f2ca
    v_mov_b32 v104, 0xf149f2ca
    v_mov_b32 v105, 0xf149f2ca
    v_mov_b32 v106, 0xf149f2ca
    v_mov_b32 v107, 0xf149f2ca
    v_mov_b32 v108, 0xf149f2ca
    v_mov_b32 v109, 0xf149f2ca
    v_mov_b32 v110, 0xf149f2ca
    v_mov_b32 v111, 0xf149f2ca
    s_branch L_miss_7_back
L_miss_8:
    s_nop 15
    v_mov_b32 v112, 0xf149f2ca
    v_mov_b32 v113, 0xf149f2ca
    v_mov_b32 v114, 0xf149f2ca
    v_mov_b32 v115, 0xf149f2ca
    v_mov_b32 v116, 0xf149f2ca
    v_mov_b32 v117, 0xf149f2ca
    v_mov_b32 v118, 0xf149f2ca
    v_mov_b32 v119, 0xf149f2ca
    v_mov_b32 v120, 0xf149f2ca
    v_mov_b32 v121, 0xf149f2ca
    v_mov_b32 v122, 0xf149f2ca
    v_mov_b32 v123, 0xf149f2ca
    v_mov_b32 v124, 0xf149f2ca
    v_mov_b32 v125, 0xf149f2ca
    v_mov_b32 v126, 0xf149f2ca
    v_mov_b32 v127, 0xf149f2ca
    s_branch L_miss_8_back
L_miss_9:
    s_nop 15
    v_mov_b32 v128, 0xf149f2ca
    v_mov_b32 v129, 0xf149f2ca
    v_mov_b32 v130, 0xf149f2ca
    v_mov_b32 v131, 0xf149f2ca
    v_mov_b32 v132, 0xf149f2ca
    v_mov_b32 v133, 0xf149f2ca
    v_mov_b32 v134, 0xf149f2ca
    v_mov_b32 v135, 0xf149f2ca
    v_mov_b32 v136, 0xf149f2ca
    v_mov_b32 v137, 0xf149f2ca
    v_mov_b32 v138, 0xf149f2ca
    v_mov_b32 v139, 0xf149f2ca
    v_mov_b32 v140, 0xf149f2ca
    v_mov_b32 v141, 0xf149f2ca
    v_mov_b32 v142, 0xf149f2ca
    v_mov_b32 v143, 0xf149f2ca
    s_branch L_miss_9_back
L_miss_10:
    s_nop 15
    v_mov_b32 v144, 0xf149f2ca
    v_mov_b32 v145, 0xf149f2ca
    v_mov_b32 v146, 0xf149f2ca
    v_mov_b32 v147, 0xf149f2ca
    v_mov_b32 v148, 0xf149f2ca
    v_mov_b32 v149, 0xf149f2ca
    v_mov_b32 v150, 0xf149f2ca
    v_mov_b32 v151, 0xf149f2ca
    v_mov_b32 v152, 0xf149f2ca
    v_mov_b32 v153, 0xf149f2ca
    v_mov_b32 v154, 0xf149f2ca
    v_mov_b32 v155, 0xf149f2ca
    v_mov_b32 v156, 0xf149f2ca
    v_mov_b32 v157, 0xf149f2ca
    v_mov_b32 v158, 0xf149f2ca
    v_mov_b32 v159, 0xf149f2ca
    s_branch L_miss_10_back
L_chk_14:
    s_mov_b32 s52, 0
L_chk_14_spin:
    buffer_load_dwordx2 v[232:233], v241, s[32:35], 0 offen offset:0 sc1
    buffer_load_dwordx2 v[234:235], v241, s[32:35], 0 offen offset:1792 sc1
    buffer_load_dwordx2 v[236:237], v242, s[32:35], 0 offen offset:0 sc1
    buffer_load_dwordx2 v[238:239], v242, s[32:35], 0 offen offset:1792 sc1
    s_add_u32 s52, s52, 1
    s_cmp_gt_u32 s52, 262144
    s_cbranch_scc1 L_abort
    s_waitcnt vmcnt(0)
    v_xor_b32 v255, s47, v233
    v_bitop3_b32 v255, v255, v235, s47 bitop3:0xf6
    v_bitop3_b32 v255, v255, v237, s47 bitop3:0xf6
    v_bitop3_b32 v255, v255, v239, s47 bitop3:0xf6
    v_cmp_ne_u32 vcc, 0, v255
    s_cbranch_vccnz L_chk_14_spin
    s_branch L_chk_14_back
L_poll_15_again:
    buffer_load_dword v10, v8, s[32:35], s53 offen sc1
    s_add_u32 s52, s52, 1
    s_cmp_gt_u32 s52, 262144
    s_cbranch_scc0 L_poll_15
    s_branch L_abort
L_poll_16_again:
    buffer_load_dword v10, v8, s[32:35], s53 offen sc1
    s_add_u32 s52, s52, 1
    s_cmp_gt_u32 s52, 262144
    s_cbranch_scc0 L_poll_16
    s_branch L_abort
L_hw_17:
    s_mov_b32 s52, 0
L_hw_17_spin:
    buffer_load_dword v9, v8, s[32:35], s53 offen sc1
    s_add_u32 s52, s52, 1
    s_cmp_gt_u32 s52, 262144
    s_cbranch_scc1 L_abort
    s_waitcnt vmcnt(0)
    v_cmp_ne_u32 vcc, s47, v9
    s_cbranch_vccnz L_hw_17_spin
    s_branch L_hw_17_back
L_hw_18:
    s_mov_b32 s52, 0
L_hw_18_spin:
    buffer_load_dword v9, v31, s[32:35], s48 offen offset:0 sc1
    s_add_u32 s52, s52, 1
    s_cmp_gt_u32 s52, 262144
    s_cbranch_scc1 L_abort
    s_waitcnt vmcnt(0)
    v_cmp_ne_u32 vcc, s47, v9
    s_cbranch_vccnz L_hw_18_spin
    s_branch L_hw_18_back
L_hw_19:
    s_mov_b32 s52, 0
L_hw_19_spin:
    buffer_load_dword v9, v31, s[32:35], s48 offen offset:512 sc1
    s_add_u32 s52, s52, 1
    s_cmp_gt_u32 s52, 262144
    s_cbranch_scc1 L_abort
    s_waitcnt vmcnt(0)
    v_cmp_ne_u32 vcc, s47, v9
    s_cbranch_vccnz L_hw_19_spin
    s_branch L_hw_19_back
L_poll_20_again:
    buffer_load_dwordx2 v[10:11], v8, s[32:35], s53 offen sc1
    s_add_u32 s52, s52, 1
    s_cmp_gt_u32 s52, 262144
    s_cbranch_scc0 L_poll_20
    s_branch L_abort
L_poll_22_again:
    buffer_load_dwordx2 v[4:5], v10, s[32:35], s59 offen offset:1024 sc1
    s_add_u32 s52, s52, 1
    s_cmp_gt_u32 s52, 262144
    s_cbranch_scc0 L_poll_22
    s_branch L_abort
L_poll_23_again:
    buffer_load_dwordx2 v[10:11], v9, s[32:35], s53 offen offset:0 sc1
    buffer_load_dwordx2 v[12:13], v9, s[32:35], s53 offen offset:1792 sc1
    s_add_u32 s52, s52, 1
    s_cmp_gt_u32 s52, 262144
    s_cbranch_scc0 L_poll_23
    s_branch L_abort
L_abort:
    s_mov_b64 exec, -1
L_end:
L_exit:
    s_endpgm
L_fast_end:
L_p1_slow:
    ds_read_b128 v[32:35], v8 offset:0
    ds_read_b64_tr_b16 v[192:193], v2 offset:0
    ds_read_b64_tr_b16 v[194:195], v2 offset:512
    ds_read_b64_tr_b16 v[196:197], v3 offset:0
    ds_read_b64_tr_b16 v[198:199], v3 offset:512
    ds_read_b128 v[36:39], v9 offset:1024
    ds_read_b64_tr_b16 v[200:201], v2 offset:2048
    ds_read_b64_tr_b16 v[202:203], v2 offset:2560
    ds_read_b64_tr_b16 v[204:205], v3 offset:2048
    ds_read_b64_tr_b16 v[206:207], v3 offset:2560
    ds_read_b128 v[40:43], v10 offset:2048
    s_waitcnt lgkmcnt(6)
    v_mfma_f32_32x32x16_bf16 v[144:159], v[192:195], v[32:35], 0
    ds_read_b128 v[44:47], v11 offset:3072
    ds_read_b64_tr_b16 v[208:209], v2 offset:4096
    ds_read_b64_tr_b16 v[210:211], v2 offset:4608
    s_mul_i32 s53, s63, 28672
    s_lshl_b32 s54, s50, 1
    v_mfma_f32_32x32x16_bf16 v[160:175], v[32:35], v[196:199], 0
    ds_read_b64_tr_b16 v[212:213], v3 offset:4096
    ds_read_b64_tr_b16 v[214:215], v3 offset:4608
    s_add_u32 s54, s54, s62
    s_lshl_b32 s55, s54, 11
    s_waitcnt lgkmcnt(6)
    v_mfma_f32_32x32x16_bf16 v[144:159], v[200:203], v[36:39], v[144:159]
    ds_read_b128 v[48:51], v8 offset:4096
    ds_read_b128 v[52:55], v9 offset:5120
    ds_read_b64_tr_b16 v[216:217], v2 offset:6144
    s_add_u32 s55, s55, s53
    s_lshl_b32 s54, s54, 9
    v_mfma_f32_32x32x16_bf16 v[160:175], v[36:39], v[204:207], v[160:175]
    ds_read_b64_tr_b16 v[218:219], v2 offset:6656
    ds_read_b64_tr_b16 v[220:221], v3 offset:6144
    ds_read_b64_tr_b16 v[222:223], v3 offset:6656
    s_add_u32 s54, s54, s53
    s_waitcnt lgkmcnt(6)
    v_mfma_f32_32x32x16_bf16 v[144:159], v[208:211], v[40:43], v[144:159]
    ds_read_b128 v[56:59], v10 offset:6144
    ds_read_b128 v[60:63], v11 offset:7168
    ds_read_b64_tr_b16 v[224:225], v2 offset:8192
    s_add_u32 s55, s55, s48
    s_add_u32 s56, s55, 229376
    v_mfma_f32_32x32x16_bf16 v[160:175], v[40:43], v[212:215], v[160:175]
    ds_read_b64_tr_b16 v[226:227], v2 offset:8704
    ds_read_b64_tr_b16 v[228:229], v3 offset:8192
    ds_read_b64_tr_b16 v[230:231], v3 offset:8704
    s_add_u32 s54, s54, s48
    s_waitcnt lgkmcnt(6)
    v_mfma_f32_32x32x16_bf16 v[144:159], v[216:219], v[44:47], v[144:159]
    ds_read_b128 v[64:67], v8 offset:8192
    ds_read_b128 v[68:71], v9 offset:9216
    ds_read_b64_tr_b16 v[232:233], v2 offset:10240
    s_add_u32 s53, s54, 458752
    v_lshrrev_b32 v4, 9, v1
    v_mfma_f32_32x32x16_bf16 v[160:175], v[44:47], v[220:223], v[160:175]
    ds_read_b64_tr_b16 v[234:235], v2 offset:10752
    ds_read_b64_tr_b16 v[236:237], v3 offset:10240
    ds_read_b64_tr_b16 v[238:239], v3 offset:10752
    v_mul_u32_u24 v4, 7168, v4
    s_waitcnt lgkmcnt(6)
    v_mfma_f32_32x32x16_bf16 v[144:159], v[224:227], v[48:51], v[144:159]
    ds_read_b128 v[72:75], v10 offset:10240
    ds_read_b128 v[76:79], v11 offset:11264
    ds_read_b64_tr_b16 v[240:241], v2 offset:12288
    v_and_b32 v5, 0x1f0, v1
    v_add_u32 v4, v4, v5
    v_mfma_f32_32x32x16_bf16 v[160:175], v[48:51], v[228:231], v[160:175]
    ds_read_b64_tr_b16 v[242:243], v2 offset:12800
    ds_read_b64_tr_b16 v[244:245], v3 offset:12288
    ds_read_b64_tr_b16 v[246:247], v3 offset:12800
    v_add_u32 v5, 14336, v4
    s_waitcnt lgkmcnt(6)
    v_mfma_f32_32x32x16_bf16 v[144:159], v[232:235], v[52:55], v[144:159]
    ds_read_b128 v[80:83], v8 offset:12288
    ds_read_b128 v[84:87], v9 offset:13312
    ds_read_b64_tr_b16 v[248:249], v2 offset:14336
    v_subrev_u32 v31, 57344, v2
    v_lshrrev_b32 v24, 7, v1
    v_mfma_f32_32x32x16_bf16 v[160:175], v[52:55], v[236:239], v[160:175]
    ds_read_b64_tr_b16 v[250:251], v2 offset:14848
    ds_read_b64_tr_b16 v[252:253], v3 offset:14336
    ds_read_b64_tr_b16 v[254:255], v3 offset:14848
    v_mul_u32_u24 v30, 896, v24
    s_waitcnt lgkmcnt(6)
    v_mfma_f32_32x32x16_bf16 v[144:159], v[240:243], v[56:59], v[144:159]
    ds_read_b128 v[88:91], v10 offset:14336
    ds_read_b128 v[92:95], v11 offset:15360
    ds_read_b64_tr_b16 v[192:193], v2 offset:16384
    v_and_b32 v24, 2, v24
    v_lshlrev_b32 v24, 5, v24
    v_mfma_f32_32x32x16_bf16 v[160:175], v[56:59], v[244:247], v[160:175]
    ds_read_b64_tr_b16 v[194:195], v2 offset:16896
    ds_read_b64_tr_b16 v[196:197], v3 offset:16384
    ds_read_b64_tr_b16 v[198:199], v3 offset:16896
    v_and_b32 v25, 0x70, v1
    s_waitcnt lgkmcnt(6)
    v_mfma_f32_32x32x16_bf16 v[144:159], v[248:251], v[60:63], v[144:159]
    ds_read_b128 v[96:99], v8 offset:16384
    ds_read_b128 v[100:103], v9 offset:17408
    ds_read_b64_tr_b16 v[200:201], v2 offset:18432
    v_xor_b32 v24, v24, v25
    v_add_u32 v30, v30, v24
    v_mfma_f32_32x32x16_bf16 v[160:175], v[60:63], v[252:255], v[160:175]
    ds_read_b64_tr_b16 v[202:203], v2 offset:18944
    ds_read_b64_tr_b16 v[204:205], v3 offset:18432
    ds_read_b64_tr_b16 v[206:207], v3 offset:18944
    s_mul_i32 s43, s46, 7168
    s_waitcnt lgkmcnt(6)
    v_mfma_f32_32x32x16_bf16 v[144:159], v[192:195], v[64:67], v[144:159]
    ds_read_b128 v[104:107], v10 offset:18432
    ds_read_b128 v[108:111], v11 offset:19456
    ds_read_b64_tr_b16 v[208:209], v2 offset:20480
    s_lshl_b32 s59, s50, 7
    s_add_u32 s43, s43, s59
    v_mfma_f32_32x32x16_bf16 v[160:175], v[64:67], v[196:199], v[160:175]
    ds_read_b64_tr_b16 v[210:211], v2 offset:20992
    ds_read_b64_tr_b16 v[212:213], v3 offset:20480
    ds_read_b64_tr_b16 v[214:215], v3 offset:20992
    s_waitcnt lgkmcnt(6)
    v_mfma_f32_32x32x16_bf16 v[144:159], v[200:203], v[68:71], v[144:159]
    ds_read_b128 v[112:115], v8 offset:20480
    ds_read_b128 v[116:119], v9 offset:21504
    ds_read_b64_tr_b16 v[216:217], v2 offset:22528
    v_mfma_f32_32x32x16_bf16 v[160:175], v[68:71], v[204:207], v[160:175]
    ds_read_b64_tr_b16 v[218:219], v2 offset:23040
    ds_read_b64_tr_b16 v[220:221], v3 offset:22528
    ds_read_b64_tr_b16 v[222:223], v3 offset:23040
    s_waitcnt lgkmcnt(6)
    v_mfma_f32_32x32x16_bf16 v[144:159], v[208:211], v[72:75], v[144:159]
    ds_read_b128 v[120:123], v10 offset:22528
    ds_read_b128 v[124:127], v11 offset:23552
    ds_read_b64_tr_b16 v[224:225], v2 offset:24576
    v_mfma_f32_32x32x16_bf16 v[160:175], v[72:75], v[212:215], v[160:175]
    ds_read_b64_tr_b16 v[226:227], v2 offset:25088
    ds_read_b64_tr_b16 v[228:229], v3 offset:24576
    ds_read_b64_tr_b16 v[230:231], v3 offset:25088
    s_waitcnt lgkmcnt(6)
    v_mfma_f32_32x32x16_bf16 v[144:159], v[216:219], v[76:79], v[144:159]
    ds_read_b128 v[128:131], v8 offset:24576
    ds_read_b128 v[132:135], v9 offset:25600
    ds_read_b64_tr_b16 v[232:233], v2 offset:26624
    v_mfma_f32_32x32x16_bf16 v[160:175], v[76:79], v[220:223], v[160:175]
    ds_read_b64_tr_b16 v[234:235], v2 offset:27136
    ds_read_b64_tr_b16 v[236:237], v3 offset:26624
    ds_read_b64_tr_b16 v[238:239], v3 offset:27136
    s_waitcnt lgkmcnt(6)
    v_mfma_f32_32x32x16_bf16 v[144:159], v[224:227], v[80:83], v[144:159]
    ds_read_b128 v[136:139], v10 offset:26624
    ds_read_b128 v[140:143], v11 offset:27648
    ds_read_b64_tr_b16 v[240:241], v2 offset:28672
    v_mfma_f32_32x32x16_bf16 v[160:175], v[80:83], v[228:231], v[160:175]
    ds_read_b64_tr_b16 v[242:243], v2 offset:29184
    ds_read_b64_tr_b16 v[244:245], v3 offset:28672
    ds_read_b64_tr_b16 v[246:247], v3 offset:29184
    s_waitcnt lgkmcnt(6)
    v_mfma_f32_32x32x16_bf16 v[144:159], v[232:235], v[84:87], v[144:159]
    ds_read_b64_tr_b16 v[248:249], v2 offset:30720
    ds_read_b64_tr_b16 v[250:251], v2 offset:31232
    ds_read_b64_tr_b16 v[252:253], v3 offset:30720
    v_mfma_f32_32x32x16_bf16 v[160:175], v[84:87], v[236:239], v[160:175]
    ds_read_b64_tr_b16 v[254:255], v3 offset:31232
    s_waitcnt lgkmcnt(4)
    v_mfma_f32_32x32x16_bf16 v[144:159], v[240:243], v[88:91], v[144:159]
    v_mfma_f32_32x32x16_bf16 v[160:175], v[88:91], v[244:247], v[160:175]
    s_barrier
    s_waitcnt lgkmcnt(0)
    v_mfma_f32_32x32x16_bf16 v[144:159], v[248:251], v[92:95], v[144:159]
    ds_read_b64_tr_b16 v[192:193], v2 offset:32768
    ds_read_b64_tr_b16 v[194:195], v2 offset:33280
    ds_read_b64_tr_b16 v[196:197], v3 offset:32768
    s_add_u32 m0, s58, 0
    s_add_u32 s60, s57, 0
    v_mfma_f32_32x32x16_bf16 v[160:175], v[92:95], v[252:255], v[160:175]
    ds_read_b64_tr_b16 v[198:199], v3 offset:33280
    ds_read_b64_tr_b16 v[200:201], v2 offset:34816
    ds_read_b64_tr_b16 v[202:203], v2 offset:35328
    buffer_load_dwordx4 v6, s[8:11], s60 offen lds
    s_waitcnt lgkmcnt(2)
    v_mfma_f32_32x32x16_bf16 v[144:159], v[192:195], v[96:99], v[144:159]
    ds_read_b64_tr_b16 v[204:205], v3 offset:34816
    ds_read_b64_tr_b16 v[206:207], v3 offset:35328
    ds_read_b64_tr_b16 v[208:209], v2 offset:36864
    s_add_u32 m0, s58, 4096
    s_add_u32 s60, s57, 86016
    v_mfma_f32_32x32x16_bf16 v[160:175], v[96:99], v[196:199], v[160:175]
    ds_read_b64_tr_b16 v[210:211], v2 offset:37376
    ds_read_b64_tr_b16 v[212:213], v3 offset:36864
    ds_read_b64_tr_b16 v[214:215], v3 offset:37376
    buffer_load_dwordx4 v6, s[8:11], s60 offen lds
    s_waitcnt lgkmcnt(4)
    v_mfma_f32_32x32x16_bf16 v[144:159], v[200:203], v[100:103], v[144:159]
    ds_read_b64_tr_b16 v[216:217], v2 offset:38912
    ds_read_b64_tr_b16 v[218:219], v2 offset:39424
    ds_read_b64_tr_b16 v[220:221], v3 offset:38912
    s_add_u32 m0, s58, 8192
    s_add_u32 s60, s57, 172032
    v_mfma_f32_32x32x16_bf16 v[160:175], v[100:103], v[204:207], v[160:175]
    ds_read_b64_tr_b16 v[222:223], v3 offset:39424
    ds_read_b64_tr_b16 v[224:225], v2 offset:40960
    ds_read_b64_tr_b16 v[226:227], v2 offset:41472
    buffer_load_dwordx4 v6, s[8:11], s60 offen lds
    s_waitcnt lgkmcnt(6)
    v_mfma_f32_32x32x16_bf16 v[144:159], v[208:211], v[104:107], v[144:159]
    ds_read_b64_tr_b16 v[228:229], v3 offset:40960
    ds_read_b64_tr_b16 v[230:231], v3 offset:41472
    ds_read_b64_tr_b16 v[232:233], v2 offset:43008
    s_add_u32 m0, s58, 12288
    s_add_u32 s60, s57, 258048
    v_mfma_f32_32x32x16_bf16 v[160:175], v[104:107], v[212:215], v[160:175]
    ds_read_b64_tr_b16 v[234:235], v2 offset:43520
    ds_read_b64_tr_b16 v[236:237], v3 offset:43008
    ds_read_b64_tr_b16 v[238:239], v3 offset:43520
    buffer_load_dwordx4 v6, s[8:11], s60 offen lds
    s_waitcnt lgkmcnt(8)
    v_mfma_f32_32x32x16_bf16 v[144:159], v[216:219], v[108:111], v[144:159]
    ds_read_b64_tr_b16 v[240:241], v2 offset:45056
    ds_read_b64_tr_b16 v[242:243], v2 offset:45568
    s_add_u32 m0, s58, 16384
    s_add_u32 s60, s57, 344064
    buffer_load_dwordx4 v6, s[8:11], s60 offen lds
    v_mfma_f32_32x32x16_bf16 v[160:175], v[108:111], v[220:223], v[160:175]
    ds_read_b64_tr_b16 v[244:245], v3 offset:45056
    ds_read_b64_tr_b16 v[246:247], v3 offset:45568
    s_add_u32 m0, s58, 20480
    s_add_u32 s60, s57, 430080
    s_waitcnt lgkmcnt(8)
    v_mfma_f32_32x32x16_bf16 v[144:159], v[224:227], v[112:115], v[144:159]
    ds_read_b64_tr_b16 v[248:249], v2 offset:47104
    ds_read_b64_tr_b16 v[250:251], v2 offset:47616
    buffer_load_dwordx4 v6, s[8:11], s60 offen lds
    s_add_u32 m0, s58, 24576
    s_add_u32 s60, s57, 516096
    v_mfma_f32_32x32x16_bf16 v[160:175], v[112:115], v[228:231], v[160:175]
    ds_read_b64_tr_b16 v[252:253], v3 offset:47104
    ds_read_b64_tr_b16 v[254:255], v3 offset:47616
    buffer_load_dwordx4 v6, s[8:11], s60 offen lds
    s_add_u32 m0, s58, 28672
    s_waitcnt lgkmcnt(8)
    v_mfma_f32_32x32x16_bf16 v[144:159], v[232:235], v[116:119], v[144:159]
    ds_read_b64_tr_b16 v[192:193], v2 offset:49152
    ds_read_b64_tr_b16 v[194:195], v2 offset:49664
    s_add_u32 s60, s57, 602112
    buffer_load_dwordx4 v6, s[8:11], s60 offen lds
    s_add_u32 m0, s58, 32768
    v_mfma_f32_32x32x16_bf16 v[160:175], v[116:119], v[236:239], v[160:175]
    s_add_u32 s60, s57, 688128
    buffer_load_dwordx4 v6, s[8:11], s60 offen lds
    s_add_u32 m0, s58, 36864
    s_add_u32 s60, s57, 774144
    s_waitcnt lgkmcnt(6)
    v_mfma_f32_32x32x16_bf16 v[144:159], v[240:243], v[120:123], v[144:159]
    ds_read_b64_tr_b16 v[200:201], v2 offset:51200
    ds_read_b64_tr_b16 v[202:203], v2 offset:51712
    buffer_load_dwordx4 v6, s[8:11], s60 offen lds
    s_add_u32 m0, s58, 40960
    s_add_u32 s60, s57, 860160
    v_mfma_f32_32x32x16_bf16 v[160:175], v[120:123], v[244:247], v[160:175]
    buffer_load_dwordx4 v6, s[8:11], s60 offen lds
    s_add_u32 m0, s58, 45056
    s_add_u32 s60, s57, 946176
    buffer_load_dwordx4 v6, s[8:11], s60 offen lds
    s_waitcnt lgkmcnt(4)
    v_mfma_f32_32x32x16_bf16 v[144:159], v[248:251], v[124:127], v[144:159]
    ds_read_b64_tr_b16 v[208:209], v2 offset:53248
    ds_read_b64_tr_b16 v[210:211], v2 offset:53760
    s_add_u32 m0, s58, 49152
    s_add_u32 s60, s57, 1032192
    buffer_load_dwordx4 v6, s[8:11], s60 offen lds
    v_mfma_f32_32x32x16_bf16 v[160:175], v[124:127], v[252:255], v[160:175]
    s_add_u32 m0, s58, 53248
    s_add_u32 s60, s57, 1118208
    buffer_load_dwordx4 v6, s[8:11], s60 offen lds
    s_waitcnt lgkmcnt(4)
    v_mfma_f32_32x32x16_bf16 v[144:159], v[192:195], v[128:131], v[144:159]
    ds_read_b64_tr_b16 v[216:217], v2 offset:55296
    ds_read_b64_tr_b16 v[218:219], v2 offset:55808
    v_mfma_f32_32x32x16_bf16 v[160:175], v[128:131], a[0:3], v[160:175]
    s_waitcnt lgkmcnt(4)
    v_mfma_f32_32x32x16_bf16 v[144:159], v[200:203], v[132:135], v[144:159]
    v_mfma_f32_32x32x16_bf16 v[160:175], v[132:135], a[4:7], v[160:175]
    s_waitcnt lgkmcnt(2)
    v_mfma_f32_32x32x16_bf16 v[144:159], v[208:211], v[136:139], v[144:159]
    v_mfma_f32_32x32x16_bf16 v[160:175], v[136:139], a[8:11], v[160:175]
    s_waitcnt lgkmcnt(0)
    v_mfma_f32_32x32x16_bf16 v[144:159], v[216:219], v[140:143], v[144:159]
    v_mfma_f32_32x32x16_bf16 v[160:175], v[140:143], a[12:15], v[160:175]
    s_nop 10
    v_cvt_pk_bf16_f32 v144, v144, v145
    v_cvt_pk_bf16_f32 v145, v146, v147
    v_cvt_pk_bf16_f32 v146, v148, v149
    v_cvt_pk_bf16_f32 v147, v150, v151
    buffer_store_dwordx4 v[144:147], v1, s[32:35], s56 offen offset:0 sc1
    v_cvt_pk_bf16_f32 v152, v152, v153
    v_cvt_pk_bf16_f32 v153, v154, v155
    v_cvt_pk_bf16_f32 v154, v156, v157
    v_cvt_pk_bf16_f32 v155, v158, v159
    buffer_store_dwordx4 v[152:155], v1, s[32:35], s56 offen offset:1024 sc1
    v_cvt_pk_bf16_f32 v160, v160, v161
    v_cvt_pk_bf16_f32 v161, v162, v163
    v_cvt_pk_bf16_f32 v162, v164, v165
    v_cvt_pk_bf16_f32 v163, v166, v167
    buffer_store_dwordx4 v[160:163], v4, s[32:35], s53 offen sc1
    v_cvt_pk_bf16_f32 v168, v168, v169
    v_cvt_pk_bf16_f32 v169, v170, v171
    v_cvt_pk_bf16_f32 v170, v172, v173
    v_cvt_pk_bf16_f32 v171, v174, v175
    buffer_store_dwordx4 v[168:171], v5, s[32:35], s53 offen sc1
    s_waitcnt vmcnt(4)
    s_barrier
    ds_read_b64_tr_b16 v[192:193], v31 offset:0
    ds_read_b64_tr_b16 v[194:195], v31 offset:512
    ds_read_b64_tr_b16 v[196:197], v31 offset:2048
    ds_read_b64_tr_b16 v[198:199], v31 offset:2560
    ds_read_b64_tr_b16 v[200:201], v31 offset:4096
    ds_read_b64_tr_b16 v[202:203], v31 offset:4608
    ds_read_b64_tr_b16 v[204:205], v31 offset:6144
    ds_read_b64_tr_b16 v[206:207], v31 offset:6656
    v_mov_b32 v6, v30
    ds_read_b64_tr_b16 v[208:209], v31 offset:8192
    ds_read_b64_tr_b16 v[210:211], v31 offset:8704
    s_waitcnt lgkmcnt(6)
    v_mfma_f32_32x32x16_bf16 v[176:191], v[192:195], v[32:35], 0
    s_lshl_b32 s3, s44, 5
    s_add_u32 s3, s3, s45
    s_lshl_b32 s3, s3, 7
    v_mov_b32 v10, 32768
    ds_read_b64_tr_b16 v[212:213], v31 offset:10240
    ds_read_b64_tr_b16 v[214:215], v31 offset:10752
    v_mfma_f32_32x32x16_bf16 v[176:191], v[196:199], v[36:39], v[176:191]
    s_add_u32 m0, s58, 57344
    s_nop 0
    buffer_load_dwordx4 v6, s[12:15], s43 offen lds
    ds_read_b64_tr_b16 v[216:217], v31 offset:12288
    ds_read_b64_tr_b16 v[218:219], v31 offset:12800
    s_waitcnt lgkmcnt(6)
    v_mfma_f32_32x32x16_bf16 v[176:191], v[200:203], v[40:43], v[176:191]
    v_mov_b32 v11, s47
    s_and_b32 s36, s45, 15
    s_lshr_b32 s37, s45, 4
    s_mul_i32 s38, s36, 7
    ds_read_b64_tr_b16 v[220:221], v31 offset:14336
    ds_read_b64_tr_b16 v[222:223], v31 offset:14848
    v_mfma_f32_32x32x16_bf16 v[176:191], v[204:207], v[44:47], v[176:191]
    s_lshr_b32 s38, s38, 1
    s_bitcmp1_b32 s36, 0
    s_cselect_b32 s100, 15, 0xf0000000
    s_mov_b32 s101, s100
    s_lshl_b32 s41, s46, 12
    ds_read_b64_tr_b16 v[192:193], v31 offset:16384
    ds_read_b64_tr_b16 v[194:195], v31 offset:16896
    s_waitcnt lgkmcnt(6)
    v_mfma_f32_32x32x16_bf16 v[176:191], v[208:211], v[48:51], v[176:191]
    s_add_u32 s41, s41, 114688
    v_add_u32 v12, s41, v1
    v_bfe_u32 v24, v1, 4, 5
    v_lshrrev_b32 v25, 9, v1
    ds_read_b64_tr_b16 v[196:197], v31 offset:18432
    ds_read_b64_tr_b16 v[198:199], v31 offset:18944
    v_mfma_f32_32x32x16_bf16 v[176:191], v[212:215], v[52:55], v[176:191]
    s_add_u32 m0, s58, 61440
    s_add_u32 s60, s43, 28672
    buffer_load_dwordx4 v6, s[12:15], s60 offen lds
    ds_read_b64_tr_b16 v[200:201], v31 offset:20480
    ds_read_b64_tr_b16 v[202:203], v31 offset:20992
    s_waitcnt lgkmcnt(6)
    v_mfma_f32_32x32x16_bf16 v[176:191], v[216:219], v[56:59], v[176:191]
    v_lshlrev_b32 v26, 2, v25
    v_sub_u32 v26, v24, v26
    v_cmp_le_i32 s[64:65], 0, v26
    v_cmp_le_i32 s[66:67], 1, v26
    ds_read_b64_tr_b16 v[204:205], v31 offset:22528
    ds_read_b64_tr_b16 v[206:207], v31 offset:23040
    v_mfma_f32_32x32x16_bf16 v[176:191], v[220:223], v[60:63], v[176:191]
    v_cmp_le_i32 s[68:69], 2, v26
    v_cmp_le_i32 s[70:71], 3, v26
    v_cmp_le_i32 s[72:73], 8, v26
    v_cmp_le_i32 s[74:75], 9, v26
    ds_read_b64_tr_b16 v[208:209], v31 offset:24576
    ds_read_b64_tr_b16 v[210:211], v31 offset:25088
    s_waitcnt lgkmcnt(6)
    v_mfma_f32_32x32x16_bf16 v[176:191], v[192:195], v[64:67], v[176:191]
    v_cmp_le_i32 s[76:77], 10, v26
    v_cmp_le_i32 s[78:79], 11, v26
    v_cmp_le_i32 s[80:81], 16, v26
    v_cmp_le_i32 s[82:83], 17, v26
    ds_read_b64_tr_b16 v[212:213], v31 offset:26624
    ds_read_b64_tr_b16 v[214:215], v31 offset:27136
    v_mfma_f32_32x32x16_bf16 v[176:191], v[196:199], v[68:71], v[176:191]
    s_add_u32 m0, s58, 65536
    s_add_u32 s60, s43, 57344
    buffer_load_dwordx4 v6, s[12:15], s60 offen lds
    ds_read_b64_tr_b16 v[216:217], v31 offset:28672
    ds_read_b64_tr_b16 v[218:219], v31 offset:29184
    s_waitcnt lgkmcnt(6)
    v_mfma_f32_32x32x16_bf16 v[176:191], v[200:203], v[72:75], v[176:191]
    v_cmp_le_i32 s[84:85], 18, v26
    v_cmp_le_i32 s[86:87], 19, v26
    v_cmp_le_i32 s[88:89], 24, v26
    v_cmp_le_i32 s[90:91], 25, v26
    ds_read_b64_tr_b16 v[220:221], v31 offset:30720
    ds_read_b64_tr_b16 v[222:223], v31 offset:31232
    v_mfma_f32_32x32x16_bf16 v[176:191], v[204:207], v[76:79], v[176:191]
    v_cmp_le_i32 s[92:93], 26, v26
    v_cmp_le_i32 s[94:95], 27, v26
    v_mov_b32 v27, 0
    v_mov_b32 v28, 0xffff
    ds_read_b64_tr_b16 v[192:193], v31 offset:32768
    ds_read_b64_tr_b16 v[194:195], v31 offset:33280
    s_waitcnt lgkmcnt(6)
    v_mfma_f32_32x32x16_bf16 v[176:191], v[208:211], v[80:83], v[176:191]
    v_mov_b32 v29, 0xffff0000
    v_cndmask_b32 v16, v27, v28, s[64:65]
    v_cndmask_b32 v30, v27, v29, s[66:67]
    v_or_b32 v16, v16, v30
    ds_read_b64_tr_b16 v[196:197], v31 offset:34816
    ds_read_b64_tr_b16 v[198:199], v31 offset:35328
    v_mfma_f32_32x32x16_bf16 v[176:191], v[212:215], v[84:87], v[176:191]
    s_add_u32 m0, s58, 69632
    s_add_u32 s60, s43, 86016
    buffer_load_dwordx4 v6, s[12:15], s60 offen lds
    ds_read_b64_tr_b16 v[200:201], v31 offset:36864
    ds_read_b64_tr_b16 v[202:203], v31 offset:37376
    s_waitcnt lgkmcnt(6)
    v_mfma_f32_32x32x16_bf16 v[176:191], v[216:219], v[88:91], v[176:191]
    v_cndmask_b32 v17, v27, v28, s[68:69]
    v_cndmask_b32 v30, v27, v29, s[70:71]
    v_or_b32 v17, v17, v30
    v_cndmask_b32 v18, v27, v28, s[72:73]
    ds_read_b64_tr_b16 v[204:205], v31 offset:38912
    ds_read_b64_tr_b16 v[206:207], v31 offset:39424
    v_mfma_f32_32x32x16_bf16 v[176:191], v[220:223], v[92:95], v[176:191]
    v_cndmask_b32 v30, v27, v29, s[74:75]
    v_or_b32 v18, v18, v30
    v_cndmask_b32 v19, v27, v28, s[76:77]
    v_cndmask_b32 v30, v27, v29, s[78:79]
    ds_read_b64_tr_b16 v[208:209], v31 offset:40960
    ds_read_b64_tr_b16 v[210:211], v31 offset:41472
    s_waitcnt lgkmcnt(6)
    v_mfma_f32_32x32x16_bf16 v[176:191], v[192:195], v[96:99], v[176:191]
    v_or_b32 v19, v19, v30
    v_cndmask_b32 v20, v27, v28, s[80:81]
    v_cndmask_b32 v30, v27, v29, s[82:83]
    v_or_b32 v20, v20, v30
    ds_read_b64_tr_b16 v[212:213], v31 offset:43008
    ds_read_b64_tr_b16 v[214:215], v31 offset:43520
    v_mfma_f32_32x32x16_bf16 v[176:191], v[196:199], v[100:103], v[176:191]
    s_add_u32 m0, s58, 73728
    s_add_u32 s60, s43, 114688
    buffer_load_dwordx4 v6, s[12:15], s60 offen lds
    ds_read_b64_tr_b16 v[216:217], v31 offset:45056
    ds_read_b64_tr_b16 v[218:219], v31 offset:45568
    s_waitcnt lgkmcnt(6)
    v_mfma_f32_32x32x16_bf16 v[176:191], v[200:203], v[104:107], v[176:191]
    v_cndmask_b32 v21, v27, v28, s[84:85]
    v_cndmask_b32 v30, v27, v29, s[86:87]
    v_or_b32 v21, v21, v30
    v_cndmask_b32 v22, v27, v28, s[88:89]
    ds_read_b64_tr_b16 v[220:221], v31 offset:47104
    ds_read_b64_tr_b16 v[222:223], v31 offset:47616
    v_mfma_f32_32x32x16_bf16 v[176:191], v[204:207], v[108:111], v[176:191]
    v_cndmask_b32 v30, v27, v29, s[90:91]
    v_or_b32 v22, v22, v30
    v_cndmask_b32 v23, v27, v28, s[92:93]
    v_cndmask_b32 v30, v27, v29, s[94:95]
    ds_read_b64_tr_b16 v[192:193], v31 offset:49152
    ds_read_b64_tr_b16 v[194:195], v31 offset:49664
    s_waitcnt lgkmcnt(6)
    v_mfma_f32_32x32x16_bf16 v[176:191], v[208:211], v[112:115], v[176:191]
    v_or_b32 v23, v23, v30
    v_and_b32 v26, 0x13, v24
    v_and_b32 v27, 4, v24
    v_lshl_or_b32 v26, v27, 1, v26
    ds_read_b64_tr_b16 v[196:197], v31 offset:51200
    ds_read_b64_tr_b16 v[198:199], v31 offset:51712
    v_mfma_f32_32x32x16_bf16 v[176:191], v[212:215], v[116:119], v[176:191]
    v_and_b32 v27, 8, v24
    v_lshrrev_b32 v27, 1, v27
    v_or_b32 v26, v26, v27
    v_lshlrev_b32 v26, 4, v26
    ds_read_b64_tr_b16 v[200:201], v31 offset:53248
    ds_read_b64_tr_b16 v[202:203], v31 offset:53760
    s_waitcnt lgkmcnt(6)
    v_mfma_f32_32x32x16_bf16 v[176:191], v[216:219], v[120:123], v[176:191]
    v_mul_u32_u24 v13, 7168, v25
    v_add_u32 v13, v13, v26
    s_lshl_b32 s53, s37, 2
    s_add_u32 s53, s53, s46
    ds_read_b64_tr_b16 v[204:205], v31 offset:55296
    ds_read_b64_tr_b16 v[206:207], v31 offset:55808
    v_mfma_f32_32x32x16_bf16 v[176:191], v[220:223], v[124:127], v[176:191]
    s_sub_u32 s39, 8, s53
    s_cmp_eq_u32 s44, 0
    s_cselect_b32 s39, s39, 0
    s_mul_i32 s40, s53, 28672
    s_add_u32 s40, s40, s48
    s_waitcnt vmcnt(5)
    s_barrier
    s_cmp_eq_u32 s46, 0
    s_cselect_b64 exec, 1, 0
    buffer_store_dword v11, v10, s[32:35], s3 offen sc1
    s_mov_b64 exec, -1
    s_waitcnt lgkmcnt(4)
    v_mfma_f32_32x32x16_bf16 v[176:191], v[192:195], v[128:131], v[176:191]
    s_lshr_b32 s53, s38, 3
    s_add_u32 s54, s38, 3
    s_lshr_b32 s54, s54, 3
    s_sub_u32 s54, s54, s53
    v_mfma_f32_32x32x16_bf16 v[176:191], v[196:199], v[132:135], v[176:191]
    s_add_u32 m0, s58, 77824
    s_add_u32 s60, s43, 143360
    buffer_load_dwordx4 v6, s[12:15], s60 offen lds
    s_waitcnt lgkmcnt(0)
    v_mfma_f32_32x32x16_bf16 v[176:191], v[200:203], v[136:139], v[176:191]
    s_add_u32 m0, s58, 81920
    s_add_u32 s60, s43, 172032
    buffer_load_dwordx4 v6, s[12:15], s60 offen lds
    v_mfma_f32_32x32x16_bf16 v[176:191], v[204:207], v[140:143], v[176:191]
    s_add_u32 m0, s58, 86016
    s_add_u32 s60, s43, 200704
    buffer_load_dwordx4 v6, s[12:15], s60 offen lds
    s_mov_b32 s56, 0x3e8b97f6
    v_bfe_u32 v25, v24, 3, 1
    v_mul_u32_u24 v25, s54, v25
    v_add_u32 v25, s53, v25
    v_and_b32 v26, 7, v24
    v_min_u32 v26, 5, v26
    s_lshl3_add_u32 s53, s44, 0
    s_lshr_b32 s53, s53, 1
    s_lshl1_add_u32 s53, s37, s53
    v_mul_f32 v176, s56, v176
    v_mul_f32 v177, s56, v177
    v_mul_f32 v178, s56, v178
    v_mul_f32 v179, s56, v179
    v_mul_f32 v180, s56, v180
    v_mul_f32 v181, s56, v181
    v_mul_f32 v182, s56, v182
    v_mul_f32 v183, s56, v183
    v_mul_f32 v184, s56, v184
    v_mul_f32 v185, s56, v185
    v_mul_f32 v186, s56, v186
    v_mul_f32 v187, s56, v187
    v_mul_f32 v188, s56, v188
    v_mul_f32 v189, s56, v189
    v_mul_f32 v190, s56, v190
    v_mul_f32 v191, s56, v191
    v_cvt_pk_bf16_f32 v176, v176, v177
    v_cvt_pk_bf16_f32 v177, v178, v179
    v_cvt_pk_bf16_f32 v178, v180, v181
    v_cvt_pk_bf16_f32 v179, v182, v183
    buffer_store_dwordx4 v[176:179], v1, s[32:35], s55 offen offset:0 sc1
    v_cvt_pk_bf16_f32 v184, v184, v185
    v_cvt_pk_bf16_f32 v185, v186, v187
    v_cvt_pk_bf16_f32 v186, v188, v189
    v_cvt_pk_bf16_f32 v187, v190, v191
    buffer_store_dwordx4 v[184:187], v1, s[32:35], s55 offen offset:1024 sc1
    s_add_u32 m0, s58, 90112
    s_add_u32 s60, s43, 229376
    buffer_load_dwordx4 v6, s[12:15], s60 offen lds
    s_add_u32 m0, s58, 94208
    s_add_u32 s60, s43, 258048
    buffer_load_dwordx4 v6, s[12:15], s60 offen lds
    s_add_u32 m0, s58, 98304
    s_add_u32 s60, s43, 286720
    buffer_load_dwordx4 v6, s[12:15], s60 offen lds
    s_add_u32 m0, s58, 102400
    s_add_u32 s60, s43, 315392
    buffer_load_dwordx4 v6, s[12:15], s60 offen lds
    s_add_u32 m0, s58, 106496
    s_add_u32 s60, s43, 344064
    buffer_load_dwordx4 v6, s[12:15], s60 offen lds
    s_add_u32 m0, s58, 110592
    s_add_u32 s60, s43, 372736
    buffer_load_dwordx4 v6, s[12:15], s60 offen lds
    v_add_u32 v26, s53, v26
    v_subrev_u32 v26, 4, v26
    v_max_i32 v26, 0, v26
    v_lshrrev_b32 v27, 2, v26
    v_and_b32 v26, 3, v26
    v_mul_u32_u24 v26, 7, v26
    v_lshl_add_u32 v26, v27, 5, v26
    v_add_u32 v26, v26, v25
    v_lshlrev_b32 v26, 7, v26
    v_add_u32 v14, 32768, v26
    v_bfe_u32 v26, v24, 1, 1
    s_lshl_b32 s53, s37, 1
    v_add_u32 v26, s53, v26
    v_mul_u32_u24 v26, 7, v26
    v_add_u32 v26, v26, v25
    v_and_b32 v27, 1, v24
    v_lshlrev_b32 v27, 3, v27
    v_lshl_add_u32 v26, v26, 4, v27
    v_add_u32 v243, 946176, v26
    v_lshrrev_b32 v24, 7, v1
    v_mul_u32_u24 v15, 3584, v24
    v_and_b32 v24, 2, v24
    v_lshlrev_b32 v24, 5, v24
    v_and_b32 v25, 0x70, v1
    v_xor_b32 v24, v24, v25
    v_add_u32 v15, v15, v24
    s_sub_u32 s53, s45, 28
    s_lshl3_add_u32 s53, s53, s44
    s_cmp_lt_u32 s45, 28
    s_cselect_b32 s53, s45, s53
    s_min_u32 s53, s53, 27
    s_lshl_b32 s53, s53, 7
    s_mul_i32 s54, s46, 28672
    s_add_u32 s42, s53, s54
    v_bfe_u32 v3, v1, 4, 5
    v_mul_u32_u24 v3, 896, v3
    v_lshrrev_b32 v4, 9, v1
    v_lshl_add_u32 v3, v4, 4, v3
    s_lshl3_add_u32 s59, s44, s63
    s_mul_i32 s59, s59, 28672
    s_lshl1_add_u32 s51, s50, s62
    s_lshl_b32 s51, s51, 6
    s_add_u32 s51, s51, s59
    v_min_u32 v240, 223, v0
    v_lshlrev_b32 v240, 3, v240
    v_add_u32 v241, 7680, v240
    v_add_u32 v242, 11264, v240
    v_mov_b32 v24, 0x3f803f80
    v_mov_b32 v25, 0x3f803f80
    v_mov_b32 v26, 0x3f803f80
    v_mov_b32 v27, 0x3f803f80
    s_mov_b64 exec, s[100:101]
    ds_write_b128 v12, v[24:27] offset:2048
    ds_write_b128 v12, v[24:27] offset:3072
    ds_write_b128 v12, v[24:27] offset:18432
    ds_write_b128 v12, v[24:27] offset:19456
    ds_write_b128 v12, v[24:27] offset:34816
    ds_write_b128 v12, v[24:27] offset:35840
    s_mov_b64 exec, -1
    v_lshrrev_b32 v8, 4, v1
    v_bfe_u32 v9, v8, 2, 2
    v_lshrrev_b32 v10, 5, v8
    v_lshl_add_u32 v10, v10, 3, v9
    v_lshlrev_b32 v2, 7, v10
    v_lshrrev_b32 v9, 1, v9
    v_lshlrev_b32 v9, 6, v9
    v_and_b32 v10, 1, v8
    v_lshlrev_b32 v10, 4, v10
    v_xor_b32 v9, v9, v10
    v_and_b32 v10, 2, v8
    v_lshlrev_b32 v10, 2, v10
    v_xor_b32 v9, v9, v10
    v_and_b32 v10, 16, v8
    v_lshlrev_b32 v10, 1, v10
    v_xor_b32 v9, v9, v10
    s_lshl_b32 s53, s62, 6
    v_xor_b32 v9, s53, v9
    v_add_u32 v2, v2, v9
    s_mul_i32 s53, s62, 28672
    s_add_u32 s53, s53, 57344
    v_add_u32 v2, s53, v2
    v_xor_b32 v6, 32, v15
    s_lshl_b32 s58, s46, 10
    s_lshl_b32 s54, s38, 9
    s_add_u32 s55, s40, s54
    s_mov_b32 s3, s55
    s_lshl_b32 s53, s38, 7
    s_add_u32 s59, s40, s53
    s_add_u32 s59, s59, 458752
    s_add_u32 s55, s55, 229376
    s_cmp_eq_u32 s44, 0
    s_cselect_b32 s60, 2130706432, 0
    s_sub_u32 s60, s60, 1867776
    s_add_u32 s53, s55, s60
    s_sub_u32 s53, s53, 229376
    s_add_u32 s56, s59, s60
    s_sub_u32 s56, s56, 229376
    s_cmp_eq_u32 s37, 0
    s_cselect_b32 s60, s60, 0
    s_add_u32 s54, s55, s60
    s_sub_u32 s54, s54, 114688
    s_add_u32 s57, s59, s60
    s_sub_u32 s57, s57, 114688
    s_lshl2_add_u32 s98, s45, s46
    s_lshl2_add_u32 s98, s98, 946176
    v_mov_b32 v8, s98
    v_mov_b32 v9, s47
    s_waitcnt vmcnt(6)
    s_mov_b64 exec, 1
    buffer_store_dword v9, v8, s[32:35], s48 offen sc1
    s_mov_b64 exec, -1
L_p2_slow:
    s_mov_b32 s52, 0
    buffer_load_dword v8, v14, s[32:35], 0 offen sc1
    buffer_load_dwordx2 v[10:11], v243, s[32:35], s48 offen sc1
L_poll_24:
    s_waitcnt vmcnt(0)
    v_xor_b32 v255, s47, v8
    v_bitop3_b32 v255, v255, v10, s47 bitop3:0xf6
    v_bitop3_b32 v255, v255, v11, s47 bitop3:0xf6
    v_cmp_ne_u32 vcc, 0, v255
    s_cbranch_vccnz L_poll_24_again
    s_add_u32 m0, s41, 0
    s_nop 0
    buffer_load_dwordx4 v1, s[32:35], s53 offen sc1 lds
    s_add_u32 m0, s41, 0
    s_nop 0
    buffer_load_dwordx4 v1, s[32:35], s53 offen offset:1024 sc1 lds
    s_add_u32 m0, s41, 16384
    s_nop 0
    buffer_load_dwordx4 v1, s[32:35], s54 offen sc1 lds
    s_add_u32 m0, s41, 16384
    s_nop 0
    buffer_load_dwordx4 v1, s[32:35], s54 offen offset:1024 sc1 lds
    s_add_u32 m0, s41, 32768
    s_nop 0
    buffer_load_dwordx4 v1, s[32:35], s55 offen sc1 lds
    s_add_u32 m0, s41, 32768
    s_nop 0
    buffer_load_dwordx4 v1, s[32:35], s55 offen offset:1024 sc1 lds
    buffer_load_dwordx4 v[24:27], v1, s[32:35], s3 offen offset:0 sc1
    buffer_load_dwordx4 v[28:31], v1, s[32:35], s3 offen offset:1024 sc1
    s_andn2_b64 exec, -1, s[100:101]
    s_add_u32 m0, s41, 2048
    s_nop 0
    buffer_load_dwordx4 v13, s[32:35], s56 offen sc1 lds
    s_add_u32 m0, s41, 3072
    s_add_u32 s60, s56, 14336
    buffer_load_dwordx4 v13, s[32:35], s60 offen sc1 lds
    s_add_u32 m0, s41, 18432
    s_nop 0
    buffer_load_dwordx4 v13, s[32:35], s57 offen sc1 lds
    s_add_u32 m0, s41, 19456
    s_add_u32 s60, s57, 14336
    buffer_load_dwordx4 v13, s[32:35], s60 offen sc1 lds
    s_add_u32 m0, s41, 34816
    s_nop 0
    buffer_load_dwordx4 v13, s[32:35], s59 offen sc1 lds
    s_add_u32 m0, s41, 35840
    s_add_u32 s60, s59, 14336
    buffer_load_dwordx4 v13, s[32:35], s60 offen sc1 lds
    s_mov_b64 exec, -1
    s_barrier
    v_xor_b32 v5, 64, v2
    ds_read_b64_tr_b16 a[128:129], v2 offset:0
    ds_read_b64_tr_b16 a[130:131], v2 offset:512
    ds_read_b64_tr_b16 a[132:133], v5 offset:0
    ds_read_b64_tr_b16 a[134:135], v5 offset:512
    ds_read_b64_tr_b16 a[136:137], v2 offset:2048
    ds_read_b64_tr_b16 a[138:139], v2 offset:2560
    ds_read_b64_tr_b16 a[140:141], v5 offset:2048
    ds_read_b64_tr_b16 a[142:143], v5 offset:2560
    ds_read_b64_tr_b16 a[144:145], v2 offset:4096
    ds_read_b64_tr_b16 a[146:147], v2 offset:4608
    ds_read_b64_tr_b16 a[148:149], v5 offset:4096
    ds_read_b64_tr_b16 a[150:151], v5 offset:4608
    ds_read_b64_tr_b16 a[152:153], v2 offset:6144
    ds_read_b64_tr_b16 a[154:155], v2 offset:6656
    ds_read_b64_tr_b16 a[156:157], v5 offset:6144
    ds_read_b64_tr_b16 a[158:159], v5 offset:6656
    ds_read_b64_tr_b16 a[160:161], v2 offset:8192
    ds_read_b64_tr_b16 a[162:163], v2 offset:8704
    ds_read_b64_tr_b16 a[164:165], v5 offset:8192
    ds_read_b64_tr_b16 a[166:167], v5 offset:8704
    ds_read_b64_tr_b16 a[168:169], v2 offset:10240
    ds_read_b64_tr_b16 a[170:171], v2 offset:10752
    ds_read_b64_tr_b16 a[172:173], v5 offset:10240
    ds_read_b64_tr_b16 a[174:175], v5 offset:10752
    ds_read_b64_tr_b16 a[176:177], v2 offset:12288
    ds_read_b64_tr_b16 a[178:179], v2 offset:12800
    ds_read_b64_tr_b16 a[180:181], v5 offset:12288
    ds_read_b64_tr_b16 a[182:183], v5 offset:12800
    ds_read_b64_tr_b16 a[184:185], v2 offset:14336
    ds_read_b64_tr_b16 a[186:187], v2 offset:14848
    ds_read_b64_tr_b16 a[188:189], v5 offset:14336
    ds_read_b64_tr_b16 a[190:191], v5 offset:14848
    ds_read_b64_tr_b16 a[192:193], v2 offset:16384
    ds_read_b64_tr_b16 a[194:195], v2 offset:16896
    ds_read_b64_tr_b16 a[196:197], v5 offset:16384
    ds_read_b64_tr_b16 a[198:199], v5 offset:16896
    ds_read_b64_tr_b16 a[200:201], v2 offset:18432
    ds_read_b64_tr_b16 a[202:203], v2 offset:18944
    ds_read_b64_tr_b16 a[204:205], v5 offset:18432
    ds_read_b64_tr_b16 a[206:207], v5 offset:18944
    ds_read_b64_tr_b16 a[208:209], v2 offset:20480
    ds_read_b64_tr_b16 a[210:211], v2 offset:20992
    ds_read_b64_tr_b16 a[212:213], v5 offset:20480
    ds_read_b64_tr_b16 a[214:215], v5 offset:20992
    ds_read_b64_tr_b16 a[216:217], v2 offset:22528
    ds_read_b64_tr_b16 a[218:219], v2 offset:23040
    ds_read_b64_tr_b16 a[220:221], v5 offset:22528
    ds_read_b64_tr_b16 a[222:223], v5 offset:23040
    ds_read_b64_tr_b16 a[224:225], v2 offset:24576
    ds_read_b64_tr_b16 a[226:227], v2 offset:25088
    ds_read_b64_tr_b16 a[228:229], v5 offset:24576
    ds_read_b64_tr_b16 a[230:231], v5 offset:25088
    ds_read_b64_tr_b16 a[232:233], v2 offset:26624
    ds_read_b64_tr_b16 a[234:235], v2 offset:27136
    ds_read_b64_tr_b16 a[236:237], v5 offset:26624
    ds_read_b64_tr_b16 a[238:239], v5 offset:27136
    s_bitcmp1_b32 s36, 0
    s_cselect_b32 s98, -1, 0
    s_mov_b32 s99, 0
    s_waitcnt vmcnt(6)
    s_waitcnt lgkmcnt(0)
    s_barrier
    s_mov_b64 exec, s[98:99]
    v_mov_b32 v24, 0
    v_mov_b32 v25, 0
    s_not_b32 exec_hi, s98
    s_mov_b32 exec_lo, 0
    v_mov_b32 v30, 0
    v_mov_b32 v31, 0
    s_mov_b64 exec, -1
    ds_read_b128 a[0:3], v12 offset:0
    ds_read_b128 a[4:7], v12 offset:1024
    ds_read_b128 a[8:11], v12 offset:32768
    ds_read_b128 a[12:15], v12 offset:33792
    ds_read_b128 a[16:19], v12 offset:4096
    ds_read_b128 a[20:23], v12 offset:5120
    ds_read_b128 a[24:27], v12 offset:8192
    ds_read_b128 a[28:31], v12 offset:9216
    ds_read_b128 a[32:35], v12 offset:12288
    ds_read_b128 a[36:39], v12 offset:13312
    s_waitcnt lgkmcnt(8)
    v_mfma_f32_32x32x16_bf16 v[32:47], a[0:3], v[24:27], 0
    v_mfma_f32_32x32x16_bf16 v[32:47], a[4:7], v[28:31], v[32:47]
    s_add_u32 m0, s58, 0
    s_nop 0
    buffer_load_dwordx4 v15, s[16:19], s42 offen lds
    ds_read_b128 a[40:43], v12 offset:16384
    ds_read_b128 a[44:47], v12 offset:17408
    s_waitcnt lgkmcnt(8)
    v_mfma_f32_32x32x16_bf16 v[160:175], a[8:11], v[24:27], 0
    v_mfma_f32_32x32x16_bf16 v[160:175], a[12:15], v[28:31], v[160:175]
    s_add_u32 m0, s58, 57344
    s_nop 0
    buffer_load_dwordx4 v6, s[20:23], s42 offen lds
    ds_read_b128 a[48:51], v12 offset:20480
    ds_read_b128 a[52:55], v12 offset:21504
    s_waitcnt lgkmcnt(8)
    v_mfma_f32_32x32x16_bf16 v[48:63], a[16:19], v[24:27], 0
    v_mfma_f32_32x32x16_bf16 v[48:63], a[20:23], v[28:31], v[48:63]
    s_cmp_gt_i32 s39, 0
    s_cbranch_scc1 L_miss_25
L_miss_25_back:
    buffer_load_dwordx4 v[224:227], v3, s[4:7], s51 offen offset:0
    ds_read_b128 a[56:59], v12 offset:24576
    ds_read_b128 a[60:63], v12 offset:25600
    s_waitcnt lgkmcnt(8)
    v_mfma_f32_32x32x16_bf16 v[64:79], a[24:27], v[24:27], 0
    v_cndmask_b32 v160, v32, v160, s[64:65]
    v_cndmask_b32 v161, v33, v161, s[66:67]
    v_cndmask_b32 v162, v34, v162, s[68:69]
    v_cndmask_b32 v163, v35, v163, s[70:71]
    v_cndmask_b32 v164, v36, v164, s[72:73]
    v_mfma_f32_32x32x16_bf16 v[64:79], a[28:31], v[28:31], v[64:79]
    v_cndmask_b32 v165, v37, v165, s[74:75]
    v_cndmask_b32 v166, v38, v166, s[76:77]
    v_cndmask_b32 v167, v39, v167, s[78:79]
    v_cndmask_b32 v168, v40, v168, s[80:81]
    v_cndmask_b32 v169, v41, v169, s[82:83]
    s_cmp_gt_i32 s39, 1
    s_cbranch_scc1 L_miss_26
L_miss_26_back:
    s_add_u32 m0, s58, 4096
    s_add_u32 s60, s42, 114688
    buffer_load_dwordx4 v15, s[16:19], s60 offen lds
    ds_read_b128 a[64:67], v12 offset:28672
    ds_read_b128 a[68:71], v12 offset:29696
    s_waitcnt lgkmcnt(8)
    v_mfma_f32_32x32x16_bf16 v[80:95], a[32:35], v[24:27], 0
    v_cndmask_b32 v170, v42, v170, s[84:85]
    v_cndmask_b32 v171, v43, v171, s[86:87]
    v_cndmask_b32 v172, v44, v172, s[88:89]
    v_cndmask_b32 v173, v45, v173, s[90:91]
    v_cndmask_b32 v174, v46, v174, s[92:93]
    v_mfma_f32_32x32x16_bf16 v[80:95], a[36:39], v[28:31], v[80:95]
    v_cndmask_b32 v175, v47, v175, s[94:95]
    v_max3_f32 v8, v160, v161, v162
    v_max3_f32 v9, v163, v164, v165
    v_max3_f32 v8, v8, v166, v167
    v_max3_f32 v9, v9, v168, v169
    s_cmp_gt_i32 s39, 2
    s_cbranch_scc1 L_miss_27
L_miss_27_back:
    s_mul_i32 s53, s63, 28672
    s_add_u32 s53, s53, s48
    s_lshl_b32 s54, s50, 1
    s_add_u32 s54, s54, s62
    s_lshl_b32 s54, s54, 11
    s_add_u32 s53, s53, s54
    s_add_u32 s53, s53, 688128
    v_lshlrev_b32 v5, 3, v1
    s_mov_b64 exec, 0xffff
    buffer_load_dword a255, v5, s[32:35], s53 offen
    s_mov_b64 exec, -1
    s_waitcnt lgkmcnt(6)
    v_mfma_f32_32x32x16_bf16 v[96:111], a[40:43], v[24:27], 0
    v_max3_f32 v8, v8, v170, v171
    v_max3_f32 v9, v9, v172, v173
    v_max3_f32 v8, v8, v174, v175
    v_max3_f32 v8, v8, v48, v49
    v_max3_f32 v9, v9, v50, v51
    v_mfma_f32_32x32x16_bf16 v[96:111], a[44:47], v[28:31], v[96:111]
    v_max3_f32 v8, v8, v52, v53
    v_max3_f32 v9, v9, v54, v55
    v_max3_f32 v8, v8, v56, v57
    v_max3_f32 v9, v9, v58, v59
    v_max3_f32 v8, v8, v60, v61
    s_cmp_gt_i32 s39, 3
    s_cbranch_scc1 L_miss_28
L_miss_28_back:
    buffer_load_dwordx4 v[228:231], v3, s[4:7], s51 offen offset:32
    s_waitcnt lgkmcnt(4)
    v_mfma_f32_32x32x16_bf16 v[112:127], a[48:51], v[24:27], 0
    v_max3_f32 v9, v9, v62, v63
    v_max3_f32 v8, v8, v64, v65
    v_max3_f32 v9, v9, v66, v67
    v_max3_f32 v8, v8, v68, v69
    v_max3_f32 v9, v9, v70, v71
    v_mfma_f32_32x32x16_bf16 v[112:127], a[52:55], v[28:31], v[112:127]
    v_max3_f32 v8, v8, v72, v73
    v_max3_f32 v9, v9, v74, v75
    v_max3_f32 v8, v8, v76, v77
    v_max3_f32 v9, v9, v78, v79
    v_max3_f32 v8, v8, v80, v81
    s_cmp_gt_i32 s39, 4
    s_cbranch_scc1 L_miss_29
L_miss_29_back:
    s_add_u32 m0, s58, 61440
    s_add_u32 s60, s42, 114688
    buffer_load_dwordx4 v6, s[20:23], s60 offen lds
    s_waitcnt lgkmcnt(2)
    v_mfma_f32_32x32x16_bf16 v[128:143], a[56:59], v[24:27], 0
    v_max3_f32 v9, v9, v82, v83
    v_max3_f32 v8, v8, v84, v85
    v_max3_f32 v9, v9, v86, v87
    v_max3_f32 v8, v8, v88, v89
    v_max3_f32 v9, v9, v90, v91
    v_mfma_f32_32x32x16_bf16 v[128:143], a[60:63], v[28:31], v[128:143]
    v_max3_f32 v8, v8, v92, v93
    v_max3_f32 v9, v9, v94, v95
    v_max3_f32 v8, v8, v96, v97
    v_max3_f32 v9, v9, v98, v99
    v_max3_f32 v8, v8, v100, v101
    s_cmp_gt_i32 s39, 5
    s_cbranch_scc1 L_miss_30
L_miss_30_back:
    buffer_load_dwordx2 v[232:233], v241, s[32:35], 0 offen offset:0 sc1
    s_waitcnt lgkmcnt(0)
    v_mfma_f32_32x32x16_bf16 v[144:159], a[64:67], v[24:27], 0
    v_max3_f32 v9, v9, v102, v103
    v_max3_f32 v8, v8, v104, v105
    v_max3_f32 v9, v9, v106, v107
    v_max3_f32 v8, v8, v108, v109
    v_max3_f32 v9, v9, v110, v111
    v_mfma_f32_32x32x16_bf16 v[144:159], a[68:71], v[28:31], v[144:159]
    v_max3_f32 v8, v8, v112, v113
    v_max3_f32 v9, v9, v114, v115
    v_max3_f32 v8, v8, v116, v117
    v_max3_f32 v9, v9, v118, v119
    v_max3_f32 v8, v8, v120, v121
    s_cmp_gt_i32 s39, 6
    s_cbranch_scc1 L_miss_31
L_miss_31_back:
    s_add_u32 m0, s58, 8192
    s_add_u32 s60, s42, 229376
    buffer_load_dwordx4 v15, s[16:19], s60 offen lds
    v_max3_f32 v9, v9, v122, v123
    v_max3_f32 v8, v8, v124, v125
    v_max3_f32 v9, v9, v126, v127
    v_max3_f32 v8, v8, v128, v129
    v_max3_f32 v9, v9, v130, v131
    v_max3_f32 v8, v8, v132, v133
    v_max3_f32 v9, v9, v134, v135
    v_max3_f32 v8, v8, v136, v137
    v_max3_f32 v9, v9, v138, v139
    v_max3_f32 v8, v8, v140, v141
    v_max3_f32 v9, v9, v142, v143
    s_cmp_gt_i32 s39, 7
    s_cbranch_scc1 L_miss_32
L_miss_32_back:
    v_max3_f32 v8, v8, v144, v145
    v_max3_f32 v9, v9, v146, v147
    v_max3_f32 v8, v8, v148, v149
    v_max3_f32 v9, v9, v150, v151
    v_max3_f32 v8, v8, v152, v153
    v_max3_f32 v9, v9, v154, v155
    v_max3_f32 v8, v8, v156, v157
    v_max3_f32 v9, v9, v158, v159
    v_max_f32 v8, v8, v9
    v_mov_b32 v9, v8
    s_nop 1
    v_permlane32_swap_b32 v9, v8
    v_max_f32 v8, v8, v9
    v_sub_f32 v10, 0, v8
    s_waitcnt vmcnt(9)
    s_barrier
    ds_read_b128 a[72:75], v12 offset:6144
    ds_read_b128 a[76:79], v12 offset:7168
    ds_read_b128 a[80:83], v12 offset:10240
    ds_read_b128 a[84:87], v12 offset:11264
    ds_read_b128 a[88:91], v12 offset:14336
    ds_read_b128 a[92:95], v12 offset:15360
    ds_read_b128 a[96:99], v12 offset:18432
    ds_read_b128 a[100:103], v12 offset:19456
    ds_read_b128 a[104:107], v12 offset:22528
    ds_read_b128 a[108:111], v12 offset:23552
    v_pk_add_f32 v[48:49], v[48:49], v[10:11] op_sel_hi:[1,0]
    v_pk_add_f32 v[50:51], v[50:51], v[10:11] op_sel_hi:[1,0]
    v_pk_add_f32 v[52:53], v[52:53], v[10:11] op_sel_hi:[1,0]
    v_pk_add_f32 v[54:55], v[54:55], v[10:11] op_sel_hi:[1,0]
    v_pk_add_f32 v[56:57], v[56:57], v[10:11] op_sel_hi:[1,0]
    v_pk_add_f32 v[58:59], v[58:59], v[10:11] op_sel_hi:[1,0]
    v_pk_add_f32 v[60:61], v[60:61], v[10:11] op_sel_hi:[1,0]
    v_pk_add_f32 v[62:63], v[62:63], v[10:11] op_sel_hi:[1,0]
    v_exp_f32 v48, v48
    v_exp_f32 v49, v49
    v_exp_f32 v50, v50
    v_exp_f32 v51, v51
    v_cvt_pk_bf16_f32 v32, v48, v49
    v_exp_f32 v52, v52
    v_exp_f32 v53, v53
    v_cvt_pk_bf16_f32 v33, v50, v51
    v_exp_f32 v54, v54
    v_exp_f32 v55, v55
    v_cvt_pk_bf16_f32 v34, v52, v53
    buffer_load_dwordx2 v[234:235], v241, s[32:35], 0 offen offset:1792 sc1
    v_cvt_pk_bf16_f32 v35, v54, v55
    v_exp_f32 v56, v56
    v_exp_f32 v57, v57
    v_exp_f32 v58, v58
    v_exp_f32 v59, v59
    v_cvt_pk_bf16_f32 v36, v56, v57
    v_exp_f32 v60, v60
    v_exp_f32 v61, v61
    v_cvt_pk_bf16_f32 v37, v58, v59
    v_exp_f32 v62, v62
    v_exp_f32 v63, v63
    v_cvt_pk_bf16_f32 v38, v60, v61
    s_add_u32 m0, s58, 65536
    s_add_u32 s60, s42, 229376
    buffer_load_dwordx4 v6, s[20:23], s60 offen lds
    v_cvt_pk_bf16_f32 v39, v62, v63
    ds_read_b128 a[112:115], v12 offset:26624
    ds_read_b128 a[116:119], v12 offset:27648
    v_pk_add_f32 v[64:65], v[64:65], v[10:11] op_sel_hi:[1,0]
    v_pk_add_f32 v[66:67], v[66:67], v[10:11] op_sel_hi:[1,0]
    v_pk_add_f32 v[68:69], v[68:69], v[10:11] op_sel_hi:[1,0]
    v_pk_add_f32 v[70:71], v[70:71], v[10:11] op_sel_hi:[1,0]
    v_pk_add_f32 v[72:73], v[72:73], v[10:11] op_sel_hi:[1,0]
    v_pk_add_f32 v[74:75], v[74:75], v[10:11] op_sel_hi:[1,0]
    v_pk_add_f32 v[76:77], v[76:77], v[10:11] op_sel_hi:[1,0]
    v_pk_add_f32 v[78:79], v[78:79], v[10:11] op_sel_hi:[1,0]
    s_waitcnt lgkmcnt(10)
    v_mfma_f32_32x32x16_bf16 v[192:207], a[72:75], v[32:35], 0
    v_exp_f32 v64, v64
    v_exp_f32 v65, v65
    v_exp_f32 v66, v66
    v_exp_f32 v67, v67
    v_cvt_pk_bf16_f32 v40, v64, v65
    v_exp_f32 v68, v68
    v_exp_f32 v69, v69
    v_cvt_pk_bf16_f32 v41, v66, v67
    v_exp_f32 v70, v70
    v_exp_f32 v71, v71
    v_cvt_pk_bf16_f32 v42, v68, v69
    buffer_load_dwordx2 v[236:237], v242, s[32:35], 0 offen offset:0 sc1
    v_cvt_pk_bf16_f32 v43, v70, v71
    v_mfma_f32_32x32x16_bf16 v[192:207], a[76:79], v[36:39], v[192:207]
    v_exp_f32 v72, v72
    v_exp_f32 v73, v73
    v_exp_f32 v74, v74
    v_exp_f32 v75, v75
    v_cvt_pk_bf16_f32 v44, v72, v73
    v_exp_f32 v76, v76
    v_exp_f32 v77, v77
    v_cvt_pk_bf16_f32 v45, v74, v75
    v_exp_f32 v78, v78
    v_exp_f32 v79, v79
    v_cvt_pk_bf16_f32 v46, v76, v77
    s_add_u32 m0, s58, 12288
    s_add_u32 s60, s42, 344064
    buffer_load_dwordx4 v15, s[16:19], s60 offen lds
    v_cvt_pk_bf16_f32 v47, v78, v79
    ds_read_b128 a[120:123], v12 offset:30720
    ds_read_b128 a[124:127], v12 offset:31744
    v_pk_add_f32 v[80:81], v[80:81], v[10:11] op_sel_hi:[1,0]
    v_pk_add_f32 v[82:83], v[82:83], v[10:11] op_sel_hi:[1,0]
    v_pk_add_f32 v[84:85], v[84:85], v[10:11] op_sel_hi:[1,0]
    v_pk_add_f32 v[86:87], v[86:87], v[10:11] op_sel_hi:[1,0]
    v_pk_add_f32 v[88:89], v[88:89], v[10:11] op_sel_hi:[1,0]
    v_pk_add_f32 v[90:91], v[90:91], v[10:11] op_sel_hi:[1,0]
    v_pk_add_f32 v[92:93], v[92:93], v[10:11] op_sel_hi:[1,0]
    v_pk_add_f32 v[94:95], v[94:95], v[10:11] op_sel_hi:[1,0]
    s_waitcnt lgkmcnt(10)
    v_mfma_f32_32x32x16_bf16 v[192:207], a[80:83], v[40:43], v[192:207]
    v_exp_f32 v80, v80
    v_exp_f32 v81, v81
    v_exp_f32 v82, v82
    v_exp_f32 v83, v83
    v_cvt_pk_bf16_f32 v32, v80, v81
    v_exp_f32 v84, v84
    v_exp_f32 v85, v85
    v_cvt_pk_bf16_f32 v33, v82, v83
    v_exp_f32 v86, v86
    v_exp_f32 v87, v87
    v_cvt_pk_bf16_f32 v34, v84, v85
    buffer_load_dwordx2 v[238:239], v242, s[32:35], 0 offen offset:1792 sc1
    v_cvt_pk_bf16_f32 v35, v86, v87
    v_mfma_f32_32x32x16_bf16 v[192:207], a[84:87], v[44:47], v[192:207]
    v_exp_f32 v88, v88
    v_exp_f32 v89, v89
    v_exp_f32 v90, v90
    v_exp_f32 v91, v91
    v_cvt_pk_bf16_f32 v36, v88, v89
    v_exp_f32 v92, v92
    v_exp_f32 v93, v93
    v_cvt_pk_bf16_f32 v37, v90, v91
    v_exp_f32 v94, v94
    v_exp_f32 v95, v95
    v_cvt_pk_bf16_f32 v38, v92, v93
    s_add_u32 m0, s58, 69632
    s_add_u32 s60, s42, 344064
    buffer_load_dwordx4 v6, s[20:23], s60 offen lds
    v_cvt_pk_bf16_f32 v39, v94, v95
    ds_read_b128 a[0:3], v12 offset:34816
    ds_read_b128 a[4:7], v12 offset:35840
    v_pk_add_f32 v[96:97], v[96:97], v[10:11] op_sel_hi:[1,0]
    v_pk_add_f32 v[98:99], v[98:99], v[10:11] op_sel_hi:[1,0]
    v_pk_add_f32 v[100:101], v[100:101], v[10:11] op_sel_hi:[1,0]
    v_pk_add_f32 v[102:103], v[102:103], v[10:11] op_sel_hi:[1,0]
    v_pk_add_f32 v[104:105], v[104:105], v[10:11] op_sel_hi:[1,0]
    v_pk_add_f32 v[106:107], v[106:107], v[10:11] op_sel_hi:[1,0]
    v_pk_add_f32 v[108:109], v[108:109], v[10:11] op_sel_hi:[1,0]
    v_pk_add_f32 v[110:111], v[110:111], v[10:11] op_sel_hi:[1,0]
    s_waitcnt lgkmcnt(10)
    v_mfma_f32_32x32x16_bf16 v[192:207], a[88:91], v[32:35], v[192:207]
    v_exp_f32 v96, v96
    v_exp_f32 v97, v97
    v_exp_f32 v98, v98
    v_exp_f32 v99, v99
    v_cvt_pk_bf16_f32 v40, v96, v97
    v_exp_f32 v100, v100
    v_exp_f32 v101, v101
    v_cvt_pk_bf16_f32 v41, v98, v99
    v_exp_f32 v102, v102
    v_exp_f32 v103, v103
    v_cvt_pk_bf16_f32 v42, v100, v101
    s_add_u32 m0, s58, 16384
    s_add_u32 s60, s42, 458752
    buffer_load_dwordx4 v15, s[16:19], s60 offen lds
    v_cvt_pk_bf16_f32 v43, v102, v103
    v_mfma_f32_32x32x16_bf16 v[192:207], a[92:95], v[36:39], v[192:207]
    v_exp_f32 v104, v104
    v_exp_f32 v105, v105
    v_exp_f32 v106, v106
    v_exp_f32 v107, v107
    v_cvt_pk_bf16_f32 v44, v104, v105
    v_exp_f32 v108, v108
    v_exp_f32 v109, v109
    v_cvt_pk_bf16_f32 v45, v106, v107
    v_exp_f32 v110, v110
    v_exp_f32 v111, v111
    v_cvt_pk_bf16_f32 v46, v108, v109
    s_add_u32 m0, s58, 73728
    s_add_u32 s60, s42, 458752
    buffer_load_dwordx4 v6, s[20:23], s60 offen lds
    v_cvt_pk_bf16_f32 v47, v110, v111
    ds_read_b128 a[8:11], v12 offset:2048
    ds_read_b128 a[12:15], v12 offset:3072
    v_pk_add_f32 v[112:113], v[112:113], v[10:11] op_sel_hi:[1,0]
    v_pk_add_f32 v[114:115], v[114:115], v[10:11] op_sel_hi:[1,0]
    v_pk_add_f32 v[116:117], v[116:117], v[10:11] op_sel_hi:[1,0]
    v_pk_add_f32 v[118:119], v[118:119], v[10:11] op_sel_hi:[1,0]
    v_pk_add_f32 v[120:121], v[120:121], v[10:11] op_sel_hi:[1,0]
    v_pk_add_f32 v[122:123], v[122:123], v[10:11] op_sel_hi:[1,0]
    v_pk_add_f32 v[124:125], v[124:125], v[10:11] op_sel_hi:[1,0]
    v_pk_add_f32 v[126:127], v[126:127], v[10:11] op_sel_hi:[1,0]
    s_waitcnt lgkmcnt(10)
    v_mfma_f32_32x32x16_bf16 v[192:207], a[96:99], v[40:43], v[192:207]
    v_exp_f32 v112, v112
    v_exp_f32 v113, v113
    v_exp_f32 v114, v114
    v_exp_f32 v115, v115
    v_cvt_pk_bf16_f32 v32, v112, v113
    v_exp_f32 v116, v116
    v_exp_f32 v117, v117
    v_cvt_pk_bf16_f32 v33, v114, v115
    v_exp_f32 v118, v118
    v_exp_f32 v119, v119
    v_cvt_pk_bf16_f32 v34, v116, v117
    s_add_u32 m0, s58, 20480
    s_add_u32 s60, s42, 573440
    buffer_load_dwordx4 v15, s[16:19], s60 offen lds
    v_cvt_pk_bf16_f32 v35, v118, v119
    v_mfma_f32_32x32x16_bf16 v[192:207], a[100:103], v[44:47], v[192:207]
    v_exp_f32 v120, v120
    v_exp_f32 v121, v121
    v_exp_f32 v122, v122
    v_exp_f32 v123, v123
    v_cvt_pk_bf16_f32 v36, v120, v121
    v_exp_f32 v124, v124
    v_exp_f32 v125, v125
    v_cvt_pk_bf16_f32 v37, v122, v123
    v_exp_f32 v126, v126
    v_exp_f32 v127, v127
    v_cvt_pk_bf16_f32 v38, v124, v125
    s_add_u32 m0, s58, 77824
    s_add_u32 s60, s42, 573440
    buffer_load_dwordx4 v6, s[20:23], s60 offen lds
    v_cvt_pk_bf16_f32 v39, v126, v127
    v_pk_add_f32 v[128:129], v[128:129], v[10:11] op_sel_hi:[1,0]
    v_pk_add_f32 v[130:131], v[130:131], v[10:11] op_sel_hi:[1,0]
    v_pk_add_f32 v[132:133], v[132:133], v[10:11] op_sel_hi:[1,0]
    v_pk_add_f32 v[134:135], v[134:135], v[10:11] op_sel_hi:[1,0]
    v_pk_add_f32 v[136:137], v[136:137], v[10:11] op_sel_hi:[1,0]
    v_pk_add_f32 v[138:139], v[138:139], v[10:11] op_sel_hi:[1,0]
    v_pk_add_f32 v[140:141], v[140:141], v[10:11] op_sel_hi:[1,0]
    v_pk_add_f32 v[142:143], v[142:143], v[10:11] op_sel_hi:[1,0]
    s_waitcnt lgkmcnt(8)
    v_mfma_f32_32x32x16_bf16 v[192:207], a[104:107], v[32:35], v[192:207]
    v_exp_f32 v128, v128
    v_exp_f32 v129, v129
    v_exp_f32 v130, v130
    v_exp_f32 v131, v131
    v_cvt_pk_bf16_f32 v40, v128, v129
    v_exp_f32 v132, v132
    v_exp_f32 v133, v133
    v_cvt_pk_bf16_f32 v41, v130, v131
    v_exp_f32 v134, v134
    v_exp_f32 v135, v135
    v_cvt_pk_bf16_f32 v42, v132, v133
    s_add_u32 m0, s58, 24576
    s_add_u32 s60, s42, 688128
    buffer_load_dwordx4 v15, s[16:19], s60 offen lds
    v_cvt_pk_bf16_f32 v43, v134, v135
    v_mfma_f32_32x32x16_bf16 v[192:207], a[108:111], v[36:39], v[192:207]
    v_exp_f32 v136, v136
    v_exp_f32 v137, v137
    v_exp_f32 v138, v138
    v_exp_f32 v139, v139
    v_cvt_pk_bf16_f32 v44, v136, v137
    v_exp_f32 v140, v140
    v_exp_f32 v141, v141
    v_cvt_pk_bf16_f32 v45, v138, v139
    v_exp_f32 v142, v142
    v_exp_f32 v143, v143
    v_cvt_pk_bf16_f32 v46, v140, v141
    s_add_u32 m0, s58, 81920
    s_add_u32 s60, s42, 688128
    buffer_load_dwordx4 v6, s[20:23], s60 offen lds
    v_cvt_pk_bf16_f32 v47, v142, v143
    v_pk_add_f32 v[144:145], v[144:145], v[10:11] op_sel_hi:[1,0]
    v_pk_add_f32 v[146:147], v[146:147], v[10:11] op_sel_hi:[1,0]
    v_pk_add_f32 v[148:149], v[148:149], v[10:11] op_sel_hi:[1,0]
    v_pk_add_f32 v[150:151], v[150:151], v[10:11] op_sel_hi:[1,0]
    v_pk_add_f32 v[152:153], v[152:153], v[10:11] op_sel_hi:[1,0]
    v_pk_add_f32 v[154:155], v[154:155], v[10:11] op_sel_hi:[1,0]
    v_pk_add_f32 v[156:157], v[156:157], v[10:11] op_sel_hi:[1,0]
    v_pk_add_f32 v[158:159], v[158:159], v[10:11] op_sel_hi:[1,0]
    s_waitcnt lgkmcnt(6)
    v_mfma_f32_32x32x16_bf16 v[192:207], a[112:115], v[40:43], v[192:207]
    v_exp_f32 v144, v144
    v_exp_f32 v145, v145
    v_exp_f32 v146, v146
    v_exp_f32 v147, v147
    v_cvt_pk_bf16_f32 v32, v144, v145
    v_exp_f32 v148, v148
    v_exp_f32 v149, v149
    v_cvt_pk_bf16_f32 v33, v146, v147
    v_exp_f32 v150, v150
    v_exp_f32 v151, v151
    v_cvt_pk_bf16_f32 v34, v148, v149
    v_cvt_pk_bf16_f32 v35, v150, v151
    v_mfma_f32_32x32x16_bf16 v[192:207], a[116:119], v[44:47], v[192:207]
    v_exp_f32 v152, v152
    v_exp_f32 v153, v153
    v_exp_f32 v154, v154
    v_exp_f32 v155, v155
    v_cvt_pk_bf16_f32 v36, v152, v153
    v_exp_f32 v156, v156
    v_exp_f32 v157, v157
    v_cvt_pk_bf16_f32 v37, v154, v155
    v_exp_f32 v158, v158
    v_exp_f32 v159, v159
    v_cvt_pk_bf16_f32 v38, v156, v157
    v_cvt_pk_bf16_f32 v39, v158, v159
    v_pk_add_f32 v[160:161], v[160:161], v[10:11] op_sel_hi:[1,0]
    v_pk_add_f32 v[162:163], v[162:163], v[10:11] op_sel_hi:[1,0]
    v_pk_add_f32 v[164:165], v[164:165], v[10:11] op_sel_hi:[1,0]
    v_pk_add_f32 v[166:167], v[166:167], v[10:11] op_sel_hi:[1,0]
    v_pk_add_f32 v[168:169], v[168:169], v[10:11] op_sel_hi:[1,0]
    v_pk_add_f32 v[170:171], v[170:171], v[10:11] op_sel_hi:[1,0]
    v_pk_add_f32 v[172:173], v[172:173], v[10:11] op_sel_hi:[1,0]
    v_pk_add_f32 v[174:175], v[174:175], v[10:11] op_sel_hi:[1,0]
    s_waitcnt lgkmcnt(4)
    v_mfma_f32_32x32x16_bf16 v[192:207], a[120:123], v[32:35], v[192:207]
    v_exp_f32 v160, v160
    v_exp_f32 v161, v161
    v_exp_f32 v162, v162
    v_exp_f32 v163, v163
    v_cvt_pk_bf16_f32 v40, v160, v161
    v_exp_f32 v164, v164
    v_exp_f32 v165, v165
    v_cvt_pk_bf16_f32 v41, v162, v163
    v_exp_f32 v166, v166
    v_exp_f32 v167, v167
    v_cvt_pk_bf16_f32 v42, v164, v165
    v_cvt_pk_bf16_f32 v43, v166, v167
    v_mfma_f32_32x32x16_bf16 v[192:207], a[124:127], v[36:39], v[192:207]
    v_exp_f32 v168, v168
    v_exp_f32 v169, v169
    v_exp_f32 v170, v170
    v_exp_f32 v171, v171
    v_cvt_pk_bf16_f32 v44, v168, v169
    v_exp_f32 v172, v172
    v_exp_f32 v173, v173
    v_cvt_pk_bf16_f32 v45, v170, v171
    v_exp_f32 v174, v174
    v_exp_f32 v175, v175
    v_cvt_pk_bf16_f32 v46, v172, v173
    v_cvt_pk_bf16_f32 v47, v174, v175
    v_and_b32 v176, v40, v16
    v_xor_b32 v184, v40, v176
    v_and_b32 v177, v41, v17
    v_xor_b32 v185, v41, v177
    v_and_b32 v178, v42, v18
    v_xor_b32 v186, v42, v178
    v_and_b32 v179, v43, v19
    v_xor_b32 v187, v43, v179
    s_waitcnt lgkmcnt(2)
    v_mfma_f32_32x32x16_bf16 v[192:207], a[0:3], v[176:179], v[192:207]
    v_and_b32 v180, v44, v20
    v_xor_b32 v188, v44, v180
    v_and_b32 v181, v45, v21
    v_xor_b32 v189, v45, v181
    v_and_b32 v182, v46, v22
    v_xor_b32 v190, v46, v182
    v_and_b32 v183, v47, v23
    v_xor_b32 v191, v47, v183
    s_waitcnt lgkmcnt(0)
    v_mfma_f32_32x32x16_bf16 v[192:207], a[8:11], v[184:187], v[192:207]
    v_mfma_f32_32x32x16_bf16 v[192:207], a[4:7], v[180:183], v[192:207]
    v_mfma_f32_32x32x16_bf16 v[192:207], a[12:15], v[188:191], v[192:207]
    s_lshl_b32 s54, s38, 9
    s_add_u32 s54, s54, s40
    s_add_u32 s54, s54, 0
    s_bitcmp1_b32 s36, 0
    s_cselect_b64 s[98:99], -1, 0
    s_nop 6
    v_cndmask_b32 v8, v204, v192, s[98:99]
    v_mov_b32 v9, v8
    s_nop 1
    v_permlane32_swap_b32 v9, v8
    v_cndmask_b32 v8, v8, v9, s[98:99]
    v_rcp_f32 v8, v8
    s_nop 0
    v_mul_f32 v192, v8, v192
    v_mul_f32 v193, v8, v193
    v_mul_f32 v194, v8, v194
    v_mul_f32 v195, v8, v195
    v_mul_f32 v196, v8, v196
    v_mul_f32 v197, v8, v197
    v_mul_f32 v198, v8, v198
    v_mul_f32 v199, v8, v199
    v_mul_f32 v200, v8, v200
    v_mul_f32 v201, v8, v201
    v_mul_f32 v202, v8, v202
    v_mul_f32 v203, v8, v203
    v_mul_f32 v204, v8, v204
    v_mul_f32 v205, v8, v205
    v_mul_f32 v206, v8, v206
    v_mul_f32 v207, v8, v207
    v_cvt_pk_bf16_f32 v176, v192, v193
    v_cvt_pk_bf16_f32 v177, v194, v195
    v_cvt_pk_bf16_f32 v178, v196, v197
    v_cvt_pk_bf16_f32 v179, v198, v199
    v_cvt_pk_bf16_f32 v180, v200, v201
    v_cvt_pk_bf16_f32 v181, v202, v203
    v_cvt_pk_bf16_f32 v182, v204, v205
    v_cvt_pk_bf16_f32 v183, v206, v207
    s_cbranch_scc1 L_odd_33
    buffer_store_dwordx4 v[176:179], v1, s[32:35], s54 offen sc1
    s_mov_b32 exec_hi, 0
    buffer_store_dwordx4 v[180:183], v1, s[32:35], s54 offen offset:1024 sc1
    s_not_b64 exec, exec
    buffer_store_dwordx2 v[180:181], v1, s[32:35], s54 offen offset:1024 sc1
    s_branch L_ost_34
L_odd_33:
    buffer_store_dwordx4 v[180:183], v1, s[32:35], s54 offen offset:1024 sc1
    s_mov_b32 exec_lo, 0
    buffer_store_dwordx4 v[176:179], v1, s[32:35], s54 offen sc1
    s_not_b64 exec, exec
    buffer_store_dwordx2 v[178:179], v1, s[32:35], s54 offen offset:8 sc1
L_ost_34:
    s_mov_b64 exec, -1
    s_cmp_lt_u32 s45, 28
    s_cbranch_scc1 L_comp_35
    s_lshl2_add_u32 s53, s45, s46
    s_lshl2_add_u32 s53, s53, 946688
    v_mov_b32 v8, s53
    v_mov_b32 v9, s47
    s_waitcnt vmcnt(0)
    s_mov_b64 exec, 1
    buffer_store_dword v9, v8, s[32:35], s48 offen sc1
    s_mov_b64 exec, -1
    s_branch L_helper_tail
L_comp_35:
    v_mov_b32 v5, v15
    s_lshl2_add_u32 s53, s45, s46
    s_lshl2_add_u32 s53, s53, 946688
    v_mov_b32 v8, s53
    v_mov_b32 v9, s47
    s_waitcnt vmcnt(0)
    s_mov_b64 exec, 1
    buffer_store_dword v9, v8, s[32:35], s48 offen sc1
    s_mov_b64 exec, -1
    v_xor_b32 v255, s47, v233
    v_bitop3_b32 v255, v255, v235, s47 bitop3:0xf6
    v_bitop3_b32 v255, v255, v237, s47 bitop3:0xf6
    v_bitop3_b32 v255, v255, v239, s47 bitop3:0xf6
    v_cmp_ne_u32 vcc, 0, v255
    s_cbranch_vccnz L_chk_36
L_chk_36_back:
    v_lshlrev_b32 v18, 16, v236
    v_and_b32 v19, 0xffff0000, v236
    v_add_f32 v18, 1.0, v18
    v_add_f32 v19, 1.0, v19
    v_cvt_pk_bf16_f32 v236, v18, v19
    v_lshrrev_b32 v10, 1, v240
    v_add_u32 v10, 159744, v10
    s_barrier
    ds_write_b32 v10, v232 offset:0
    ds_write_b32 v10, v234 offset:896
    ds_write_b32 v10, v236 offset:1792
    ds_write_b32 v10, v238 offset:2688
    s_lshl_b32 s54, s50, 1
    s_add_u32 s54, s54, s62
    s_lshl_b32 s54, s54, 6
    s_mul_i32 s55, s63, 28672
    s_add_u32 s55, s55, s48
    s_mul_i32 s56, s62, 14336
    s_add_u32 s56, s56, s55
    s_add_u32 s56, s56, 0
    v_and_b32 v8, 0xf0, v1
    s_lshr_b32 s53, s63, 2
    s_lshl_b32 s53, s53, 6
    s_and_b32 s59, s63, 3
    s_add_u32 s53, s53, s59
    s_lshl2_add_u32 s53, s53, s48
    s_add_u32 s53, s53, 946688
    s_mov_b32 s52, 0
    buffer_load_dword v10, v8, s[32:35], s53 offen sc1
L_poll_37:
    s_waitcnt vmcnt(0)
    v_cmp_ne_u32 vcc, s47, v10
    s_cbranch_vccnz L_poll_37_again
    buffer_load_dwordx4 a[0:3], v1, s[32:35], s56 offen offset:0 sc1
    buffer_load_dwordx4 a[4:7], v1, s[32:35], s56 offen offset:1024 sc1
    buffer_load_dwordx4 a[8:11], v1, s[32:35], s56 offen offset:2048 sc1
    buffer_load_dwordx4 a[12:15], v1, s[32:35], s56 offen offset:3072 sc1
    s_add_u32 s56, s56, 4096
    buffer_load_dwordx4 a[16:19], v1, s[32:35], s56 offen offset:0 sc1
    buffer_load_dwordx4 a[20:23], v1, s[32:35], s56 offen offset:1024 sc1
    buffer_load_dwordx4 a[24:27], v1, s[32:35], s56 offen offset:2048 sc1
    buffer_load_dwordx4 a[28:31], v1, s[32:35], s56 offen offset:3072 sc1
    s_waitcnt lgkmcnt(0)
    s_barrier
    v_lshl_add_u32 v8, v4, 4, s54
    v_add_u32 v8, 159744, v8
    ds_read_b128 v[12:15], v8 offset:0
    ds_read_b128 v[20:23], v8 offset:1792
    ds_read_b128 v[16:19], v8 offset:32
    ds_read_b128 v[24:27], v8 offset:1824
    s_lshl_b32 s53, s61, 5
    v_add_u32 v8, s53, v8
    ds_read_b128 v[248:251], v8 offset:2688
    s_waitcnt vmcnt(7)
    v_mfma_f32_32x32x16_bf16 v[32:47], a[128:131], a[0:3], 0
    s_add_u32 s56, s56, 4096
    buffer_load_dwordx4 a[32:35], v1, s[32:35], s56 offen offset:0 sc1
    v_lshlrev_b32 v104, 16, v224
    v_and_b32 v105, 0xffff0000, v224
    v_lshlrev_b32 v106, 16, v225
    v_mfma_f32_32x32x16_bf16 v[48:63], a[132:135], a[0:3], 0
    v_and_b32 v107, 0xffff0000, v225
    v_lshlrev_b32 v108, 16, v226
    v_and_b32 v109, 0xffff0000, v226
    s_waitcnt vmcnt(7)
    v_mfma_f32_32x32x16_bf16 v[32:47], a[136:139], a[4:7], v[32:47]
    buffer_load_dwordx4 a[36:39], v1, s[32:35], s56 offen offset:1024 sc1
    v_lshlrev_b32 v110, 16, v227
    v_and_b32 v111, 0xffff0000, v227
    v_lshlrev_b32 v112, 16, v228
    v_mfma_f32_32x32x16_bf16 v[48:63], a[140:143], a[4:7], v[48:63]
    v_and_b32 v113, 0xffff0000, v228
    v_lshlrev_b32 v114, 16, v229
    v_and_b32 v115, 0xffff0000, v229
    s_waitcnt vmcnt(7)
    v_mfma_f32_32x32x16_bf16 v[32:47], a[144:147], a[8:11], v[32:47]
    buffer_load_dwordx4 a[40:43], v1, s[32:35], s56 offen offset:2048 sc1
    v_lshlrev_b32 v116, 16, v230
    v_and_b32 v117, 0xffff0000, v230
    v_lshlrev_b32 v118, 16, v231
    v_mfma_f32_32x32x16_bf16 v[48:63], a[148:151], a[8:11], v[48:63]
    v_and_b32 v119, 0xffff0000, v231
    s_waitcnt lgkmcnt(0)
    v_lshlrev_b32 v64, 16, v12
    s_waitcnt vmcnt(7)
    v_mfma_f32_32x32x16_bf16 v[32:47], a[152:155], a[12:15], v[32:47]
    buffer_load_dwordx4 a[44:47], v1, s[32:35], s56 offen offset:3072 sc1
    v_and_b32 v65, 0xffff0000, v12
    v_lshlrev_b32 v66, 16, v13
    v_and_b32 v67, 0xffff0000, v13
    v_mfma_f32_32x32x16_bf16 v[48:63], a[156:159], a[12:15], v[48:63]
    v_lshlrev_b32 v68, 16, v14
    v_and_b32 v69, 0xffff0000, v14
    v_lshlrev_b32 v70, 16, v15
    s_waitcnt vmcnt(7)
    v_mfma_f32_32x32x16_bf16 v[32:47], a[160:163], a[16:19], v[32:47]
    s_add_u32 s56, s56, 4096
    buffer_load_dwordx4 a[48:51], v1, s[32:35], s56 offen offset:0 sc1
    v_and_b32 v71, 0xffff0000, v15
    v_lshlrev_b32 v72, 16, v16
    v_and_b32 v73, 0xffff0000, v16
    v_mfma_f32_32x32x16_bf16 v[48:63], a[164:167], a[16:19], v[48:63]
    v_lshlrev_b32 v74, 16, v17
    v_and_b32 v75, 0xffff0000, v17
    v_lshlrev_b32 v76, 16, v18
    s_waitcnt vmcnt(7)
    v_mfma_f32_32x32x16_bf16 v[32:47], a[168:171], a[20:23], v[32:47]
    buffer_load_dwordx4 a[52:55], v1, s[32:35], s56 offen offset:1024 sc1
    v_and_b32 v77, 0xffff0000, v18
    v_lshlrev_b32 v78, 16, v19
    v_and_b32 v79, 0xffff0000, v19
    v_mfma_f32_32x32x16_bf16 v[48:63], a[172:175], a[20:23], v[48:63]
    v_lshlrev_b32 v80, 16, v20
    v_and_b32 v81, 0xffff0000, v20
    v_lshlrev_b32 v82, 16, v21
    s_waitcnt vmcnt(7)
    v_mfma_f32_32x32x16_bf16 v[32:47], a[176:179], a[24:27], v[32:47]
    s_add_u32 m0, s58, 28672
    s_add_u32 s60, s42, 802816
    buffer_load_dwordx4 v5, s[16:19], s60 offen lds
    v_and_b32 v83, 0xffff0000, v21
    v_lshlrev_b32 v84, 16, v22
    v_and_b32 v85, 0xffff0000, v22
    v_mfma_f32_32x32x16_bf16 v[48:63], a[180:183], a[24:27], v[48:63]
    s_add_u32 m0, s58, 86016
    s_add_u32 s60, s42, 802816
    buffer_load_dwordx4 v6, s[20:23], s60 offen lds
    v_lshlrev_b32 v86, 16, v23
    v_and_b32 v87, 0xffff0000, v23
    v_lshlrev_b32 v88, 16, v24
    s_waitcnt vmcnt(8)
    v_mfma_f32_32x32x16_bf16 v[32:47], a[184:187], a[28:31], v[32:47]
    s_add_u32 m0, s58, 32768
    s_add_u32 s60, s42, 917504
    buffer_load_dwordx4 v5, s[16:19], s60 offen lds
    v_and_b32 v89, 0xffff0000, v24
    v_lshlrev_b32 v90, 16, v25
    v_and_b32 v91, 0xffff0000, v25
    v_mfma_f32_32x32x16_bf16 v[48:63], a[188:191], a[28:31], v[48:63]
    s_add_u32 m0, s58, 90112
    s_add_u32 s60, s42, 917504
    buffer_load_dwordx4 v6, s[20:23], s60 offen lds
    v_lshlrev_b32 v92, 16, v26
    v_and_b32 v93, 0xffff0000, v26
    v_lshlrev_b32 v94, 16, v27
    s_waitcnt vmcnt(9)
    v_mfma_f32_32x32x16_bf16 v[32:47], a[192:195], a[32:35], v[32:47]
    v_and_b32 v95, 0xffff0000, v27
    s_lshl_b32 s53, s46, 12
    s_add_u32 s53, s53, 114688
    v_mfma_f32_32x32x16_bf16 v[48:63], a[196:199], a[32:35], v[48:63]
    v_add_u32 v26, s53, v1
    v_xor_b32 v27, 4096, v26
    s_lshl_b32 s53, s46, 11
    s_waitcnt vmcnt(8)
    v_mfma_f32_32x32x16_bf16 v[32:47], a[200:203], a[36:39], v[32:47]
    s_add_u32 s53, s53, 131072
    v_add_u32 v29, s53, v1
    s_lshl_b32 s53, s54, 5
    v_mfma_f32_32x32x16_bf16 v[48:63], a[204:207], a[36:39], v[48:63]
    s_add_u32 s57, s53, s55
    s_add_u32 s57, s57, 688128
    s_lshl_b32 s59, s63, 8
    s_waitcnt vmcnt(7)
    v_mfma_f32_32x32x16_bf16 v[32:47], a[208:211], a[40:43], v[32:47]
    s_add_u32 s59, s59, s53
    s_add_u32 s59, s59, s48
    s_add_u32 s59, s59, 917504
    v_mfma_f32_32x32x16_bf16 v[48:63], a[212:215], a[40:43], v[48:63]
    v_bfe_u32 v28, v1, 1, 8
    v_lshl_add_u32 v28, v4, 2, v28
    s_waitcnt vmcnt(6)
    v_mfma_f32_32x32x16_bf16 v[32:47], a[216:219], a[44:47], v[32:47]
    v_mfma_f32_32x32x16_bf16 v[48:63], a[220:223], a[44:47], v[48:63]
    s_waitcnt vmcnt(5)
    v_mfma_f32_32x32x16_bf16 v[32:47], a[224:227], a[48:51], v[32:47]
    v_mfma_f32_32x32x16_bf16 v[48:63], a[228:231], a[48:51], v[48:63]
    s_waitcnt vmcnt(4)
    v_mfma_f32_32x32x16_bf16 v[32:47], a[232:235], a[52:55], v[32:47]
    v_mfma_f32_32x32x16_bf16 v[48:63], a[236:239], a[52:55], v[48:63]
    s_nop 11
    ds_write_b128 v26, v[48:51] offset:0
    ds_write_b128 v26, v[52:55] offset:1024
    ds_write_b128 v26, v[56:59] offset:2048
    ds_write_b128 v26, v[60:63] offset:3072
    s_waitcnt lgkmcnt(0)
    s_barrier
    ds_read_b128 v[48:51], v27 offset:0
    ds_read_b128 v[52:55], v27 offset:1024
    ds_read_b128 v[56:59], v27 offset:2048
    ds_read_b128 v[60:63], v27 offset:3072
    s_waitcnt lgkmcnt(3)
    v_pk_add_f32 v[32:33], v[32:33], v[48:49]
    v_pk_add_f32 v[34:35], v[34:35], v[50:51]
    s_waitcnt lgkmcnt(2)
    v_pk_add_f32 v[36:37], v[36:37], v[52:53]
    v_pk_add_f32 v[38:39], v[38:39], v[54:55]
    s_waitcnt lgkmcnt(1)
    v_pk_add_f32 v[40:41], v[40:41], v[56:57]
    v_pk_add_f32 v[42:43], v[42:43], v[58:59]
    s_waitcnt lgkmcnt(0)
    v_pk_add_f32 v[44:45], v[44:45], v[60:61]
    v_pk_add_f32 v[46:47], v[46:47], v[62:63]
    v_pk_fma_f32 v[32:33], v[32:33], v[64:65], v[104:105]
    v_pk_fma_f32 v[34:35], v[34:35], v[66:67], v[106:107]
    v_pk_fma_f32 v[36:37], v[36:37], v[68:69], v[108:109]
    v_pk_fma_f32 v[38:39], v[38:39], v[70:71], v[110:111]
    v_pk_fma_f32 v[40:41], v[40:41], v[72:73], v[112:113]
    v_pk_fma_f32 v[42:43], v[42:43], v[74:75], v[114:115]
    v_pk_fma_f32 v[44:45], v[44:45], v[76:77], v[116:117]
    v_pk_fma_f32 v[46:47], v[46:47], v[78:79], v[118:119]
    v_pk_mul_f32 v[48:49], v[32:33], v[80:81]
    v_pk_mul_f32 v[50:51], v[34:35], v[82:83]
    v_pk_mul_f32 v[52:53], v[36:37], v[84:85]
    v_pk_mul_f32 v[54:55], v[38:39], v[86:87]
    v_pk_mul_f32 v[56:57], v[40:41], v[88:89]
    v_pk_mul_f32 v[58:59], v[42:43], v[90:91]
    v_pk_mul_f32 v[60:61], v[44:45], v[92:93]
    v_pk_mul_f32 v[62:63], v[46:47], v[94:95]
    v_cvt_pk_bf16_f32 v12, v48, v49
    v_cvt_pk_bf16_f32 v13, v50, v51
    v_cvt_pk_bf16_f32 v14, v52, v53
    v_cvt_pk_bf16_f32 v15, v54, v55
    buffer_store_dwordx4 v[12:15], v1, s[32:35], s57 offen offset:0 sc1
    v_cvt_pk_bf16_f32 v16, v56, v57
    v_cvt_pk_bf16_f32 v17, v58, v59
    v_cvt_pk_bf16_f32 v18, v60, v61
    v_cvt_pk_bf16_f32 v19, v62, v63
    buffer_store_dwordx4 v[16:19], v1, s[32:35], s57 offen offset:1024 sc1
    v_pk_mul_f32 v[22:23], v[32:33], v[32:33]
    v_pk_add_f32 v[20:21], v[32:33], v[34:35]
    v_pk_fma_f32 v[22:23], v[34:35], v[34:35], v[22:23]
    v_pk_add_f32 v[20:21], v[20:21], v[36:37]
    v_pk_fma_f32 v[22:23], v[36:37], v[36:37], v[22:23]
    v_pk_add_f32 v[20:21], v[20:21], v[38:39]
    v_pk_fma_f32 v[22:23], v[38:39], v[38:39], v[22:23]
    v_pk_add_f32 v[20:21], v[20:21], v[40:41]
    v_pk_fma_f32 v[22:23], v[40:41], v[40:41], v[22:23]
    v_pk_add_f32 v[20:21], v[20:21], v[42:43]
    v_pk_fma_f32 v[22:23], v[42:43], v[42:43], v[22:23]
    v_pk_add_f32 v[20:21], v[20:21], v[44:45]
    v_pk_fma_f32 v[22:23], v[44:45], v[44:45], v[22:23]
    v_pk_add_f32 v[20:21], v[20:21], v[46:47]
    v_pk_fma_f32 v[22:23], v[46:47], v[46:47], v[22:23]
    v_add_f32 v20, v20, v21
    v_add_f32 v21, v22, v23
    s_nop 1
    v_permlane32_swap_b32 v20, v21
    v_add_f32 v20, v20, v21
    buffer_store_dword v20, v28, s[32:35], s59 offen sc1
    v_cvt_pk_bf16_f32 v240, v32, v33
    v_cvt_pk_bf16_f32 v241, v34, v35
    v_cvt_pk_bf16_f32 v242, v36, v37
    v_cvt_pk_bf16_f32 v243, v38, v39
    v_cvt_pk_bf16_f32 v244, v40, v41
    v_cvt_pk_bf16_f32 v245, v42, v43
    v_cvt_pk_bf16_f32 v246, v44, v45
    v_cvt_pk_bf16_f32 v247, v46, v47
    ds_write_b128 v29, v[240:243] offset:0
    ds_write_b128 v29, v[244:247] offset:1024
    s_lshl2_add_u32 s53, s45, s46
    s_lshl2_add_u32 s53, s53, 947200
    v_mov_b32 v8, s53
    v_mov_b32 v9, s47
    s_waitcnt vmcnt(0)
    s_mov_b64 exec, 1
    buffer_store_dword v9, v8, s[32:35], s48 offen sc1
    s_mov_b64 exec, -1
    v_lshrrev_b32 v8, 4, v1
    v_bfe_u32 v9, v8, 2, 2
    v_lshrrev_b32 v10, 5, v8
    v_lshl_add_u32 v10, v10, 3, v9
    v_lshlrev_b32 v12, 7, v10
    v_lshrrev_b32 v9, 1, v9
    v_lshlrev_b32 v9, 6, v9
    v_and_b32 v10, 1, v8
    v_lshlrev_b32 v10, 4, v10
    v_xor_b32 v9, v9, v10
    v_and_b32 v10, 2, v8
    v_lshlrev_b32 v10, 2, v10
    v_xor_b32 v9, v9, v10
    v_and_b32 v10, 16, v8
    v_lshlrev_b32 v10, 1, v10
    v_xor_b32 v9, v9, v10
    v_add_u32 v12, v12, v9
    v_bfe_u32 v8, v1, 8, 1
    v_mul_u32_u24 v8, 57344, v8
    s_mul_i32 s53, s46, 10240
    s_add_u32 s37, s53, 114688
    s_lshl_b32 s53, s62, 6
    s_lshl_b32 s54, s61, 5
    s_add_u32 s53, s53, s54
    v_xor_b32 v28, s53, v12
    v_add_u32 v28, s37, v28
    v_xor_b32 v29, 64, v28
    v_add_u32 v12, v12, v8
    v_xor_b32 v13, 32, v12
    v_xor_b32 v14, 64, v12
    v_xor_b32 v15, 96, v12
    s_lshl_b32 s53, s62, 11
    s_lshl_b32 s54, s61, 10
    s_add_u32 s53, s53, s54
    s_add_u32 s53, s53, 131072
    v_add_u32 v8, s53, v1
    s_waitcnt lgkmcnt(0)
    s_barrier
    ds_read_b128 v[240:243], v8 offset:0
    ds_read_b128 v[244:247], v8 offset:4096
    v_lshrrev_b32 v8, 7, v1
    v_mul_u32_u24 v2, 896, v8
    v_and_b32 v8, 2, v8
    v_lshlrev_b32 v8, 5, v8
    v_and_b32 v9, 0x70, v1
    v_xor_b32 v8, v8, v9
    v_add_u32 v2, v2, v8
    s_lshl_b32 s53, s50, 7
    s_mul_i32 s54, s46, 401408
    s_add_u32 s57, s53, s54
    s_sub_u32 s57, s57, 14336
    v_add_u32 v0, 6144, v2
    s_mul_i32 s40, s46, 57344
    s_add_u32 s40, s40, s48
    s_add_u32 s40, s40, 688128
    v_and_b32 v30, 0x1f0, v1
    v_lshrrev_b32 v30, 1, v30
    v_mul_u32_u24 v8, 14336, v4
    v_add_u32 v30, v30, v8
    s_lshl_b32 s54, s46, 9
    s_add_u32 s54, s54, s48
    s_add_u32 s41, s54, 917504
    s_mov_b32 s100, 0x01000100
    s_mov_b32 s101, 0x07060302
    s_lshl_b32 s36, s45, 12
    s_add_u32 s36, s36, 131072
    s_mov_b32 s55, 0xffff
    s_mul_i32 s56, s46, 229376
    s_add_u32 s56, s56, s48
    s_lshl_b32 s54, s45, 12
    s_add_u32 s56, s56, s54
    s_add_u32 s56, s56, 1048576
    s_mul_i32 s59, s49, 229376
    s_mul_i32 s54, s46, 28672
    s_add_u32 s59, s59, s54
    s_add_u32 s59, s59, s48
    s_add_u32 s59, s59, 1048576
    v_min_u32 v31, 96, v1
    s_mul_i32 s53, s46, 112
    s_lshl_b32 s54, s49, 2
    s_add_u32 s53, s53, s54
    s_add_u32 s53, s53, 947712
    v_add_u32 v31, s53, v31
    s_mul_i32 s53, s61, 28640
    s_sub_u32 s51, s51, s53
    s_waitcnt lgkmcnt(0)
    s_barrier
    v_lshrrev_b32 v8, 2, v1
    v_min_u32 v8, 108, v8
    s_mul_i32 s53, s46, 112
    s_add_u32 s53, s53, s48
    s_add_u32 s53, s53, 947200
    s_mov_b32 s52, 0
    buffer_load_dword v10, v8, s[32:35], s53 offen sc1
L_poll_38:
    s_waitcnt vmcnt(0)
    v_cmp_ne_u32 vcc, s47, v10
    s_cbranch_vccnz L_poll_38_again
    s_lshl_b32 s53, s45, 4
    s_lshl_b32 s54, s46, 2
    s_add_u32 s53, s53, s54
    s_add_u32 s53, s53, 947712
    v_mov_b32 v10, s53
    v_mov_b32 v11, s47
    buffer_load_dwordx4 a[252:255], v1, s[32:35], s40 offen offset:0 sc1
    buffer_load_dwordx4 a[248:251], v1, s[32:35], s40 offen offset:1024 sc1
    buffer_load_dwordx4 a[244:247], v1, s[32:35], s40 offen offset:2048 sc1
    buffer_load_dwordx4 a[240:243], v1, s[32:35], s40 offen offset:3072 sc1
    s_add_u32 s40, s40, 4096
    buffer_load_dwordx4 a[236:239], v1, s[32:35], s40 offen offset:0 sc1
    ds_read_b64_tr_b16 v[160:161], v12 offset:0
    ds_read_b64_tr_b16 v[162:163], v12 offset:512
    ds_read_b64_tr_b16 v[164:165], v13 offset:0
    ds_read_b64_tr_b16 v[166:167], v13 offset:512
    ds_read_b64_tr_b16 v[168:169], v14 offset:0
    ds_read_b64_tr_b16 v[170:171], v14 offset:512
    ds_read_b64_tr_b16 v[172:173], v15 offset:0
    ds_read_b64_tr_b16 v[174:175], v15 offset:512
    ds_read_b64_tr_b16 v[176:177], v12 offset:2048
    ds_read_b64_tr_b16 v[178:179], v12 offset:2560
    ds_read_b64_tr_b16 v[180:181], v13 offset:2048
    ds_read_b64_tr_b16 v[182:183], v13 offset:2560
    s_waitcnt vmcnt(4) lgkmcnt(8)
    v_mfma_f32_32x32x16_bf16 v[32:47], v[160:163], a[252:255], 0
    buffer_load_dwordx4 a[232:235], v1, s[32:35], s40 offen offset:1024 sc1
    ds_read_b64_tr_b16 v[184:185], v14 offset:2048
    ds_read_b64_tr_b16 v[186:187], v14 offset:2560
    v_mfma_f32_32x32x16_bf16 v[48:63], v[164:167], a[252:255], 0
    buffer_load_dwordx4 a[228:231], v1, s[32:35], s40 offen offset:2048 sc1
    ds_read_b64_tr_b16 v[188:189], v15 offset:2048
    ds_read_b64_tr_b16 v[190:191], v15 offset:2560
    s_waitcnt lgkmcnt(8)
    v_mfma_f32_32x32x16_bf16 v[64:79], v[168:171], a[252:255], 0
    s_add_u32 m0, s58, 36864
    s_add_u32 s60, s42, 1032192
    ds_read_b64_tr_b16 v[192:193], v12 offset:4096
    ds_read_b64_tr_b16 v[194:195], v12 offset:4608
    buffer_load_dwordx4 v5, s[16:19], s60 offen lds
    s_add_u32 m0, s58, 94208
    s_nop 0
    v_mfma_f32_32x32x16_bf16 v[80:95], v[172:175], a[252:255], 0
    buffer_load_dwordx4 v6, s[20:23], s60 offen lds
    s_add_u32 m0, s58, 40960
    ds_read_b64_tr_b16 v[196:197], v13 offset:4096
    ds_read_b64_tr_b16 v[198:199], v13 offset:4608
    s_add_u32 s60, s42, 1146880
    s_waitcnt vmcnt(7) lgkmcnt(8)
    v_mfma_f32_32x32x16_bf16 v[32:47], v[176:179], a[248:251], v[32:47]
    buffer_load_dwordx4 v5, s[16:19], s60 offen lds
    s_add_u32 m0, s58, 98304
    s_nop 0
    ds_read_b64_tr_b16 v[200:201], v14 offset:4096
    ds_read_b64_tr_b16 v[202:203], v14 offset:4608
    buffer_load_dwordx4 v6, s[20:23], s60 offen lds
    v_mfma_f32_32x32x16_bf16 v[48:63], v[180:183], a[248:251], v[48:63]
    buffer_load_dwordx4 a[252:255], v1, s[32:35], s40 offen offset:3072 sc1
    ds_read_b64_tr_b16 v[204:205], v15 offset:4096
    ds_read_b64_tr_b16 v[206:207], v15 offset:4608
    s_waitcnt lgkmcnt(8)
    v_mfma_f32_32x32x16_bf16 v[64:79], v[184:187], a[248:251], v[64:79]
    s_add_u32 m0, s58, 45056
    s_add_u32 s60, s42, 1261568
    ds_read_b64_tr_b16 v[160:161], v12 offset:6144
    ds_read_b64_tr_b16 v[162:163], v12 offset:6656
    buffer_load_dwordx4 v5, s[16:19], s60 offen lds
    s_add_u32 m0, s58, 102400
    s_nop 0
    v_mfma_f32_32x32x16_bf16 v[80:95], v[188:191], a[248:251], v[80:95]
    buffer_load_dwordx4 v6, s[20:23], s60 offen lds
    ds_read_b64_tr_b16 v[164:165], v13 offset:6144
    ds_read_b64_tr_b16 v[166:167], v13 offset:6656
    s_waitcnt vmcnt(11) lgkmcnt(8)
    v_mfma_f32_32x32x16_bf16 v[32:47], v[192:195], a[244:247], v[32:47]
    ds_read_b64_tr_b16 v[168:169], v14 offset:6144
    ds_read_b64_tr_b16 v[170:171], v14 offset:6656
    v_mfma_f32_32x32x16_bf16 v[48:63], v[196:199], a[244:247], v[48:63]
    s_add_u32 s40, s40, 4096
    buffer_load_dwordx4 a[248:251], v1, s[32:35], s40 offen offset:0 sc1
    ds_read_b64_tr_b16 v[172:173], v15 offset:6144
    ds_read_b64_tr_b16 v[174:175], v15 offset:6656
    s_waitcnt lgkmcnt(8)
    v_mfma_f32_32x32x16_bf16 v[64:79], v[200:203], a[244:247], v[64:79]
    ds_read_b64_tr_b16 v[176:177], v12 offset:8192
    ds_read_b64_tr_b16 v[178:179], v12 offset:8704
    v_mfma_f32_32x32x16_bf16 v[80:95], v[204:207], a[244:247], v[80:95]
    ds_read_b64_tr_b16 v[180:181], v13 offset:8192
    ds_read_b64_tr_b16 v[182:183], v13 offset:8704
    s_waitcnt vmcnt(11) lgkmcnt(8)
    v_mfma_f32_32x32x16_bf16 v[32:47], v[160:163], a[240:243], v[32:47]
    ds_read_b64_tr_b16 v[184:185], v14 offset:8192
    ds_read_b64_tr_b16 v[186:187], v14 offset:8704
    v_mfma_f32_32x32x16_bf16 v[48:63], v[164:167], a[240:243], v[48:63]
    ds_read_b64_tr_b16 v[188:189], v15 offset:8192
    ds_read_b64_tr_b16 v[190:191], v15 offset:8704
    s_waitcnt lgkmcnt(8)
    v_mfma_f32_32x32x16_bf16 v[64:79], v[168:171], a[240:243], v[64:79]
    buffer_load_dwordx4 a[244:247], v1, s[32:35], s40 offen offset:1024 sc1
    ds_read_b64_tr_b16 v[192:193], v12 offset:10240
    ds_read_b64_tr_b16 v[194:195], v12 offset:10752
    v_mfma_f32_32x32x16_bf16 v[80:95], v[172:175], a[240:243], v[80:95]
    s_add_u32 m0, s58, 49152
    s_add_u32 s60, s42, 1376256
    ds_read_b64_tr_b16 v[196:197], v13 offset:10240
    ds_read_b64_tr_b16 v[198:199], v13 offset:10752
    buffer_load_dwordx4 v5, s[16:19], s60 offen lds
    s_waitcnt vmcnt(12) lgkmcnt(8)
    v_mfma_f32_32x32x16_bf16 v[32:47], v[176:179], a[236:239], v[32:47]
    s_add_u32 m0, s58, 106496
    s_nop 0
    ds_read_b64_tr_b16 v[200:201], v14 offset:10240
    ds_read_b64_tr_b16 v[202:203], v14 offset:10752
    buffer_load_dwordx4 v6, s[20:23], s60 offen lds
    v_mfma_f32_32x32x16_bf16 v[48:63], v[180:183], a[236:239], v[48:63]
    ds_read_b64_tr_b16 v[204:205], v15 offset:10240
    ds_read_b64_tr_b16 v[206:207], v15 offset:10752
    s_waitcnt lgkmcnt(8)
    v_mfma_f32_32x32x16_bf16 v[64:79], v[184:187], a[236:239], v[64:79]
    ds_read_b64_tr_b16 v[160:161], v12 offset:12288
    ds_read_b64_tr_b16 v[162:163], v12 offset:12800
    v_mfma_f32_32x32x16_bf16 v[80:95], v[188:191], a[236:239], v[80:95]
    buffer_load_dwordx4 a[240:243], v1, s[32:35], s40 offen offset:2048 sc1
    ds_read_b64_tr_b16 v[164:165], v13 offset:12288
    ds_read_b64_tr_b16 v[166:167], v13 offset:12800
    s_waitcnt vmcnt(13) lgkmcnt(8)
    v_mfma_f32_32x32x16_bf16 v[32:47], v[192:195], a[232:235], v[32:47]
    ds_read_b64_tr_b16 v[168:169], v14 offset:12288
    ds_read_b64_tr_b16 v[170:171], v14 offset:12800
    v_mfma_f32_32x32x16_bf16 v[48:63], v[196:199], a[232:235], v[48:63]
    buffer_load_dwordx4 a[236:239], v1, s[32:35], s40 offen offset:3072 sc1
    ds_read_b64_tr_b16 v[172:173], v15 offset:12288
    ds_read_b64_tr_b16 v[174:175], v15 offset:12800
    s_waitcnt lgkmcnt(8)
    v_mfma_f32_32x32x16_bf16 v[64:79], v[200:203], a[232:235], v[64:79]
    ds_read_b64_tr_b16 v[176:177], v12 offset:14336
    ds_read_b64_tr_b16 v[178:179], v12 offset:14848
    v_mfma_f32_32x32x16_bf16 v[80:95], v[204:207], a[232:235], v[80:95]
    s_add_u32 m0, s58, 53248
    s_add_u32 s60, s42, 1490944
    ds_read_b64_tr_b16 v[180:181], v13 offset:14336
    ds_read_b64_tr_b16 v[182:183], v13 offset:14848
    buffer_load_dwordx4 v5, s[16:19], s60 offen lds
    s_waitcnt vmcnt(14) lgkmcnt(8)
    v_mfma_f32_32x32x16_bf16 v[32:47], v[160:163], a[228:231], v[32:47]
    s_add_u32 m0, s58, 110592
    s_nop 0
    ds_read_b64_tr_b16 v[184:185], v14 offset:14336
    ds_read_b64_tr_b16 v[186:187], v14 offset:14848
    buffer_load_dwordx4 v6, s[20:23], s60 offen lds
    v_mfma_f32_32x32x16_bf16 v[48:63], v[164:167], a[228:231], v[48:63]
    ds_read_b64_tr_b16 v[188:189], v15 offset:14336
    ds_read_b64_tr_b16 v[190:191], v15 offset:14848
    s_waitcnt lgkmcnt(8)
    v_mfma_f32_32x32x16_bf16 v[64:79], v[168:171], a[228:231], v[64:79]
    s_add_u32 s40, s40, 4096
    buffer_load_dwordx4 a[232:235], v1, s[32:35], s40 offen offset:0 sc1
    ds_read_b64_tr_b16 v[192:193], v12 offset:16384
    ds_read_b64_tr_b16 v[194:195], v12 offset:16896
    v_mfma_f32_32x32x16_bf16 v[80:95], v[172:175], a[228:231], v[80:95]
    ds_read_b64_tr_b16 v[196:197], v13 offset:16384
    ds_read_b64_tr_b16 v[198:199], v13 offset:16896
    s_waitcnt vmcnt(11) lgkmcnt(8)
    v_mfma_f32_32x32x16_bf16 v[32:47], v[176:179], a[252:255], v[32:47]
    buffer_load_dwordx4 a[228:231], v1, s[32:35], s40 offen offset:1024 sc1
    ds_read_b64_tr_b16 v[200:201], v14 offset:16384
    ds_read_b64_tr_b16 v[202:203], v14 offset:16896
    v_mfma_f32_32x32x16_bf16 v[48:63], v[180:183], a[252:255], v[48:63]
    ds_read_b64_tr_b16 v[204:205], v15 offset:16384
    ds_read_b64_tr_b16 v[206:207], v15 offset:16896
    s_waitcnt lgkmcnt(8)
    v_mfma_f32_32x32x16_bf16 v[64:79], v[184:187], a[252:255], v[64:79]
    buffer_load_dwordx2 v[96:97], v30, s[32:35], s41 offen offset:0 sc1
    buffer_load_dwordx2 v[110:111], v30, s[32:35], s41 offen offset:256 sc1
    ds_read_b64_tr_b16 v[160:161], v12 offset:18432
    ds_read_b64_tr_b16 v[162:163], v12 offset:18944
    v_mfma_f32_32x32x16_bf16 v[80:95], v[188:191], a[252:255], v[80:95]
    ds_read_b64_tr_b16 v[164:165], v13 offset:18432
    ds_read_b64_tr_b16 v[166:167], v13 offset:18944
    s_waitcnt vmcnt(11) lgkmcnt(8)
    v_mfma_f32_32x32x16_bf16 v[32:47], v[192:195], a[248:251], v[32:47]
    ds_read_b64_tr_b16 v[168:169], v14 offset:18432
    ds_read_b64_tr_b16 v[170:171], v14 offset:18944
    v_mfma_f32_32x32x16_bf16 v[48:63], v[196:199], a[248:251], v[48:63]
    buffer_load_dwordx4 a[252:255], v1, s[32:35], s40 offen offset:2048 sc1
    ds_read_b64_tr_b16 v[172:173], v15 offset:18432
    ds_read_b64_tr_b16 v[174:175], v15 offset:18944
    s_waitcnt lgkmcnt(8)
    v_mfma_f32_32x32x16_bf16 v[64:79], v[200:203], a[248:251], v[64:79]
    ds_read_b64_tr_b16 v[176:177], v12 offset:20480
    ds_read_b64_tr_b16 v[178:179], v12 offset:20992
    v_mfma_f32_32x32x16_bf16 v[80:95], v[204:207], a[248:251], v[80:95]
    buffer_load_dwordx2 v[98:99], v30, s[32:35], s41 offen offset:2048 sc1
    buffer_load_dwordx2 v[112:113], v30, s[32:35], s41 offen offset:2304 sc1
    ds_read_b64_tr_b16 v[180:181], v13 offset:20480
    ds_read_b64_tr_b16 v[182:183], v13 offset:20992
    s_add_u32 s41, s41, 4096
    s_waitcnt vmcnt(13) lgkmcnt(8)
    v_mfma_f32_32x32x16_bf16 v[32:47], v[160:163], a[244:247], v[32:47]
    ds_read_b64_tr_b16 v[184:185], v14 offset:20480
    ds_read_b64_tr_b16 v[186:187], v14 offset:20992
    v_mfma_f32_32x32x16_bf16 v[48:63], v[164:167], a[244:247], v[48:63]
    ds_read_b64_tr_b16 v[188:189], v15 offset:20480
    ds_read_b64_tr_b16 v[190:191], v15 offset:20992
    s_waitcnt lgkmcnt(8)
    v_mfma_f32_32x32x16_bf16 v[64:79], v[168:171], a[244:247], v[64:79]
    ds_read_b64_tr_b16 v[192:193], v12 offset:22528
    ds_read_b64_tr_b16 v[194:195], v12 offset:23040
    v_mfma_f32_32x32x16_bf16 v[80:95], v[172:175], a[244:247], v[80:95]
    buffer_load_dwordx4 a[248:251], v1, s[32:35], s40 offen offset:3072 sc1
    ds_read_b64_tr_b16 v[196:197], v13 offset:22528
    ds_read_b64_tr_b16 v[198:199], v13 offset:23040
    s_waitcnt vmcnt(11) lgkmcnt(8)
    v_mfma_f32_32x32x16_bf16 v[32:47], v[176:179], a[240:243], v[32:47]
    ds_read_b64_tr_b16 v[200:201], v14 offset:22528
    ds_read_b64_tr_b16 v[202:203], v14 offset:23040
    v_mfma_f32_32x32x16_bf16 v[48:63], v[180:183], a[240:243], v[48:63]
    s_add_u32 s40, s40, 4096
    buffer_load_dwordx4 a[244:247], v1, s[32:35], s40 offen offset:0 sc1
    ds_read_b64_tr_b16 v[204:205], v15 offset:22528
    ds_read_b64_tr_b16 v[206:207], v15 offset:23040
    s_waitcnt lgkmcnt(8)
    v_mfma_f32_32x32x16_bf16 v[64:79], v[184:187], a[240:243], v[64:79]
    buffer_load_dwordx2 v[100:101], v30, s[32:35], s41 offen offset:0 sc1
    buffer_load_dwordx2 v[114:115], v30, s[32:35], s41 offen offset:256 sc1
    ds_read_b64_tr_b16 v[160:161], v12 offset:24576
    ds_read_b64_tr_b16 v[162:163], v12 offset:25088
    v_mfma_f32_32x32x16_bf16 v[80:95], v[188:191], a[240:243], v[80:95]
    ds_read_b64_tr_b16 v[164:165], v13 offset:24576
    ds_read_b64_tr_b16 v[166:167], v13 offset:25088
    s_waitcnt vmcnt(13) lgkmcnt(8)
    v_mfma_f32_32x32x16_bf16 v[32:47], v[192:195], a[236:239], v[32:47]
    ds_read_b64_tr_b16 v[168:169], v14 offset:24576
    ds_read_b64_tr_b16 v[170:171], v14 offset:25088
    v_mfma_f32_32x32x16_bf16 v[48:63], v[196:199], a[236:239], v[48:63]
    ds_read_b64_tr_b16 v[172:173], v15 offset:24576
    ds_read_b64_tr_b16 v[174:175], v15 offset:25088
    s_waitcnt lgkmcnt(8)
    v_mfma_f32_32x32x16_bf16 v[64:79], v[200:203], a[236:239], v[64:79]
    buffer_load_dwordx2 v[102:103], v30, s[32:35], s41 offen offset:2048 sc1
    buffer_load_dwordx2 v[116:117], v30, s[32:35], s41 offen offset:2304 sc1
    ds_read_b64_tr_b16 v[176:177], v12 offset:26624
    ds_read_b64_tr_b16 v[178:179], v12 offset:27136
    s_add_u32 s41, s41, 4096
    v_mfma_f32_32x32x16_bf16 v[80:95], v[204:207], a[236:239], v[80:95]
    ds_read_b64_tr_b16 v[180:181], v13 offset:26624
    ds_read_b64_tr_b16 v[182:183], v13 offset:27136
    s_waitcnt vmcnt(12) lgkmcnt(8)
    v_mfma_f32_32x32x16_bf16 v[32:47], v[160:163], a[232:235], v[32:47]
    buffer_load_dwordx2 v[104:105], v30, s[32:35], s41 offen offset:0 sc1
    buffer_load_dwordx2 v[118:119], v30, s[32:35], s41 offen offset:256 sc1
    ds_read_b64_tr_b16 v[184:185], v14 offset:26624
    ds_read_b64_tr_b16 v[186:187], v14 offset:27136
    v_mfma_f32_32x32x16_bf16 v[48:63], v[164:167], a[232:235], v[48:63]
    ds_read_b64_tr_b16 v[188:189], v15 offset:26624
    ds_read_b64_tr_b16 v[190:191], v15 offset:27136
    s_waitcnt lgkmcnt(8)
    v_mfma_f32_32x32x16_bf16 v[64:79], v[168:171], a[232:235], v[64:79]
    buffer_load_dwordx2 v[106:107], v30, s[32:35], s41 offen offset:2048 sc1
    buffer_load_dwordx2 v[120:121], v30, s[32:35], s41 offen offset:2304 sc1
    ds_read_b64_tr_b16 v[192:193], v12 offset:28672
    ds_read_b64_tr_b16 v[194:195], v12 offset:29184
    s_add_u32 s41, s41, 4096
    v_mfma_f32_32x32x16_bf16 v[80:95], v[172:175], a[232:235], v[80:95]
    ds_read_b64_tr_b16 v[196:197], v13 offset:28672
    ds_read_b64_tr_b16 v[198:199], v13 offset:29184
    s_waitcnt vmcnt(15) lgkmcnt(8)
    v_mfma_f32_32x32x16_bf16 v[32:47], v[176:179], a[228:231], v[32:47]
    ds_read_b64_tr_b16 v[200:201], v14 offset:28672
    ds_read_b64_tr_b16 v[202:203], v14 offset:29184
    v_mfma_f32_32x32x16_bf16 v[48:63], v[180:183], a[228:231], v[48:63]
    buffer_load_dwordx2 v[108:109], v30, s[32:35], s41 offen offset:0 sc1
    buffer_load_dwordx2 v[122:123], v30, s[32:35], s41 offen offset:256 sc1
    ds_read_b64_tr_b16 v[204:205], v15 offset:28672
    ds_read_b64_tr_b16 v[206:207], v15 offset:29184
    s_waitcnt lgkmcnt(8)
    v_mfma_f32_32x32x16_bf16 v[64:79], v[184:187], a[228:231], v[64:79]
    ds_read_b64_tr_b16 v[160:161], v12 offset:30720
    ds_read_b64_tr_b16 v[162:163], v12 offset:31232
    v_mfma_f32_32x32x16_bf16 v[80:95], v[188:191], a[228:231], v[80:95]
    ds_read_b64_tr_b16 v[164:165], v13 offset:30720
    ds_read_b64_tr_b16 v[166:167], v13 offset:31232
    s_waitcnt vmcnt(14) lgkmcnt(8)
    v_mfma_f32_32x32x16_bf16 v[32:47], v[192:195], a[252:255], v[32:47]
    buffer_load_dwordx4 a[240:243], v1, s[32:35], s40 offen offset:1024 sc1
    ds_read_b64_tr_b16 v[168:169], v14 offset:30720
    ds_read_b64_tr_b16 v[170:171], v14 offset:31232
    v_mfma_f32_32x32x16_bf16 v[48:63], v[196:199], a[252:255], v[48:63]
    buffer_load_dwordx4 a[236:239], v1, s[32:35], s40 offen offset:2048 sc1
    ds_read_b64_tr_b16 v[172:173], v15 offset:30720
    ds_read_b64_tr_b16 v[174:175], v15 offset:31232
    s_waitcnt lgkmcnt(8)
    v_mfma_f32_32x32x16_bf16 v[64:79], v[200:203], a[252:255], v[64:79]
    ds_read_b64_tr_b16 v[176:177], v12 offset:32768
    ds_read_b64_tr_b16 v[178:179], v12 offset:33280
    v_mfma_f32_32x32x16_bf16 v[80:95], v[204:207], a[252:255], v[80:95]
    buffer_load_dwordx4 a[252:255], v1, s[32:35], s40 offen offset:3072 sc1
    ds_read_b64_tr_b16 v[180:181], v13 offset:32768
    ds_read_b64_tr_b16 v[182:183], v13 offset:33280
    s_waitcnt vmcnt(14) lgkmcnt(8)
    v_mfma_f32_32x32x16_bf16 v[32:47], v[160:163], a[248:251], v[32:47]
    s_add_u32 s40, s40, 4096
    buffer_load_dwordx4 a[232:235], v1, s[32:35], s40 offen offset:0 sc1
    ds_read_b64_tr_b16 v[184:185], v14 offset:32768
    ds_read_b64_tr_b16 v[186:187], v14 offset:33280
    v_mfma_f32_32x32x16_bf16 v[48:63], v[164:167], a[248:251], v[48:63]
    buffer_load_dwordx4 a[228:231], v1, s[32:35], s40 offen offset:1024 sc1
    ds_read_b64_tr_b16 v[188:189], v15 offset:32768
    ds_read_b64_tr_b16 v[190:191], v15 offset:33280
    s_waitcnt lgkmcnt(8)
    v_mfma_f32_32x32x16_bf16 v[64:79], v[168:171], a[248:251], v[64:79]
    s_add_u32 m0, s37, 0
    s_add_u32 s57, s57, 14336
    ds_read_b64_tr_b16 v[192:193], v12 offset:34816
    ds_read_b64_tr_b16 v[194:195], v12 offset:35328
    buffer_load_dwordx4 v2, s[24:27], s57 offen lds
    buffer_load_dwordx4 v0, s[24:27], s57 offen offset:1024 lds
    v_mfma_f32_32x32x16_bf16 v[80:95], v[172:175], a[248:251], v[80:95]
    ds_read_b64_tr_b16 v[196:197], v13 offset:34816
    ds_read_b64_tr_b16 v[198:199], v13 offset:35328
    s_barrier
    s_waitcnt vmcnt(17) lgkmcnt(8)
    v_mfma_f32_32x32x16_bf16 v[32:47], v[176:179], a[244:247], v[32:47]
    s_lshl4_add_u32 s53, s45, 16384
    v_bfe_u32 v8, v1, 2, 4
    ds_read_b64_tr_b16 v[200:201], v14 offset:34816
    ds_read_b64_tr_b16 v[202:203], v14 offset:35328
    buffer_load_dword v9, v8, s[32:35], s53 offen sc1
    v_mfma_f32_32x32x16_bf16 v[48:63], v[180:183], a[244:247], v[48:63]
    ds_read_b64_tr_b16 v[204:205], v15 offset:34816
    ds_read_b64_tr_b16 v[206:207], v15 offset:35328
    s_waitcnt lgkmcnt(8)
    v_mfma_f32_32x32x16_bf16 v[64:79], v[184:187], a[244:247], v[64:79]
    buffer_load_dwordx4 a[248:251], v1, s[32:35], s40 offen offset:2048 sc1
    ds_read_b64_tr_b16 v[160:161], v12 offset:36864
    ds_read_b64_tr_b16 v[162:163], v12 offset:37376
    v_mfma_f32_32x32x16_bf16 v[80:95], v[188:191], a[244:247], v[80:95]
    s_add_u32 m0, s37, 2048
    s_add_u32 s57, s57, 14336
    ds_read_b64_tr_b16 v[164:165], v13 offset:36864
    ds_read_b64_tr_b16 v[166:167], v13 offset:37376
    buffer_load_dwordx4 v2, s[24:27], s57 offen lds
    s_waitcnt vmcnt(10)
    s_waitcnt vmcnt(9) lgkmcnt(8)
    v_mfma_f32_32x32x16_bf16 v[32:47], v[192:195], a[240:243], v[32:47]
    v_add_f32 v96, v96, v98
    v_add_f32 v97, v97, v99
    buffer_load_dwordx4 v0, s[24:27], s57 offen offset:1024 lds
    v_add_f32 v96, v96, v100
    v_add_f32 v97, v97, v101
    v_add_f32 v96, v96, v102
    v_mfma_f32_32x32x16_bf16 v[48:63], v[196:199], a[240:243], v[48:63]
    v_add_f32 v97, v97, v103
    v_add_f32 v96, v96, v104
    buffer_load_dwordx4 a[244:247], v1, s[32:35], s40 offen offset:3072 sc1
    v_add_f32 v97, v97, v105
    v_add_f32 v96, v96, v106
    s_waitcnt lgkmcnt(4)
    v_mfma_f32_32x32x16_bf16 v[64:79], v[200:203], a[240:243], v[64:79]
    v_add_f32 v97, v97, v107
    v_add_f32 v96, v96, v108
    v_add_f32 v97, v97, v109
    v_mov_b32 v98, v96
    v_mov_b32 v99, v97
    s_nop 0
    v_permlane32_swap_b32 v98, v96
    v_mfma_f32_32x32x16_bf16 v[80:95], v[204:207], a[240:243], v[80:95]
    ds_read_b64_tr_b16 v[168:169], v14 offset:36864
    ds_read_b64_tr_b16 v[170:171], v14 offset:37376
    v_permlane32_swap_b32 v99, v97
    v_add_f32 v96, v96, v98
    s_add_u32 m0, s37, 4096
    s_waitcnt vmcnt(10) lgkmcnt(2)
    v_mfma_f32_32x32x16_bf16 v[32:47], v[160:163], a[236:239], v[32:47]
    ds_read_b64_tr_b16 v[172:173], v15 offset:36864
    ds_read_b64_tr_b16 v[174:175], v15 offset:37376
    v_add_f32 v97, v97, v99
    v_mul_f32 v96, 0xbb124925, v96
    s_add_u32 s57, s57, 14336
    buffer_load_dwordx4 v2, s[24:27], s57 offen lds
    v_mfma_f32_32x32x16_bf16 v[48:63], v[164:167], a[236:239], v[48:63]
    ds_read_b64_tr_b16 v[176:177], v12 offset:38912
    ds_read_b64_tr_b16 v[178:179], v12 offset:39424
    v_mul_f32 v97, 0x3b124925, v97
    v_fma_f32 v97, -v96, v96, v97
    buffer_load_dwordx4 v0, s[24:27], s57 offen offset:1024 lds
    s_waitcnt lgkmcnt(2)
    v_mfma_f32_32x32x16_bf16 v[64:79], v[168:171], a[236:239], v[64:79]
    ds_read_b64_tr_b16 v[180:181], v13 offset:38912
    ds_read_b64_tr_b16 v[182:183], v13 offset:39424
    v_max_f32 v97, 0, v97
    v_add_f32 v97, 0x3727c5ac, v97
    v_rcp_f32 v24, v97
    v_sqrt_f32 v97, v97
    v_mfma_f32_32x32x16_bf16 v[80:95], v[172:175], a[236:239], v[80:95]
    ds_read_b64_tr_b16 v[184:185], v14 offset:38912
    ds_read_b64_tr_b16 v[186:187], v14 offset:39424
    v_cvt_pk_bf16_f32 v98, v96, v97
    v_lshlrev_b32 v99, 16, v98
    s_add_u32 s40, s40, 4096
    s_waitcnt vmcnt(11) lgkmcnt(2)
    v_mfma_f32_32x32x16_bf16 v[32:47], v[176:179], a[252:255], v[32:47]
    ds_read_b64_tr_b16 v[188:189], v15 offset:38912
    ds_read_b64_tr_b16 v[190:191], v15 offset:39424
    v_and_b32 v100, 0xffff0000, v98
    v_sub_f32 v99, v96, v99
    buffer_load_dwordx4 a[240:243], v1, s[32:35], s40 offen offset:0 sc1
    buffer_load_dwordx4 a[236:239], v1, s[32:35], s40 offen offset:1024 sc1
    v_mfma_f32_32x32x16_bf16 v[48:63], v[180:183], a[252:255], v[48:63]
    ds_read_b64_tr_b16 v[192:193], v12 offset:40960
    ds_read_b64_tr_b16 v[194:195], v12 offset:41472
    v_sub_f32 v100, v97, v100
    v_cvt_pk_bf16_f32 v99, v99, v100
    v_perm_b32 v16, v98, v98, s100
    s_waitcnt lgkmcnt(2)
    v_mfma_f32_32x32x16_bf16 v[64:79], v[184:187], a[252:255], v[64:79]
    ds_read_b64_tr_b16 v[196:197], v13 offset:40960
    ds_read_b64_tr_b16 v[198:199], v13 offset:41472
    v_bfi_b32 v17, s55, v99, v98
    v_perm_b32 v18, v99, v98, s101
    s_add_u32 m0, s37, 6144
    s_waitcnt vmcnt(9)
    v_mfma_f32_32x32x16_bf16 v[80:95], v[188:191], a[252:255], v[80:95]
    ds_read_b64_tr_b16 v[200:201], v14 offset:40960
    ds_read_b64_tr_b16 v[202:203], v14 offset:41472
    v_mov_b32 v19, 0
    v_add_f32 v110, v110, v112
    s_add_u32 s57, s57, 14336
    s_barrier
    s_waitcnt lgkmcnt(2)
    v_mfma_f32_32x32x16_bf16 v[32:47], v[192:195], a[232:235], v[32:47]
    ds_read_b64_tr_b16 v[204:205], v15 offset:40960
    ds_read_b64_tr_b16 v[206:207], v15 offset:41472
    v_add_f32 v111, v111, v113
    v_add_f32 v110, v110, v114
    buffer_load_dwordx4 v2, s[24:27], s57 offen lds
    buffer_load_dwordx4 v0, s[24:27], s57 offen offset:1024 lds
    v_mfma_f32_32x32x16_bf16 v[48:63], v[196:199], a[232:235], v[48:63]
    ds_read_b64_tr_b16 v[160:161], v12 offset:43008
    ds_read_b64_tr_b16 v[162:163], v12 offset:43520
    v_add_f32 v111, v111, v115
    v_add_f32 v110, v110, v116
    buffer_load_dwordx4 a[252:255], v1, s[32:35], s40 offen offset:2048 sc1
    s_waitcnt lgkmcnt(2)
    v_mfma_f32_32x32x16_bf16 v[64:79], v[200:203], a[232:235], v[64:79]
    ds_read_b64_tr_b16 v[164:165], v13 offset:43008
    ds_read_b64_tr_b16 v[166:167], v13 offset:43520
    v_add_f32 v111, v111, v117
    v_add_f32 v110, v110, v118
    s_add_u32 m0, s37, 8192
    s_add_u32 s57, s57, 14336
    v_mfma_f32_32x32x16_bf16 v[80:95], v[204:207], a[232:235], v[80:95]
    ds_read_b64_tr_b16 v[168:169], v14 offset:43008
    ds_read_b64_tr_b16 v[170:171], v14 offset:43520
    v_add_f32 v111, v111, v119
    v_add_f32 v110, v110, v120
    buffer_load_dwordx4 v2, s[24:27], s57 offen lds
    s_waitcnt vmcnt(12)
    v_cmp_ne_u32 vcc, s47, v9
    s_cbranch_vccnz L_hw_39
L_hw_39_back:
    s_waitcnt lgkmcnt(2)
    v_mfma_f32_32x32x16_bf16 v[32:47], v[160:163], a[228:231], v[32:47]
    ds_read_b64_tr_b16 v[172:173], v15 offset:43008
    ds_read_b64_tr_b16 v[174:175], v15 offset:43520
    v_add_f32 v111, v111, v121
    v_add_f32 v110, v110, v122
    buffer_load_dwordx4 v0, s[24:27], s57 offen offset:1024 lds
    s_waitcnt vmcnt(10)
    v_mfma_f32_32x32x16_bf16 v[48:63], v[164:167], a[228:231], v[48:63]
    ds_read_b64_tr_b16 v[176:177], v12 offset:45056
    ds_read_b64_tr_b16 v[178:179], v12 offset:45568
    v_add_f32 v111, v111, v123
    v_mov_b32 v112, v110
    buffer_load_dwordx4 v[208:211], v1, s[32:35], s36 offen offset:0 sc1
    s_waitcnt lgkmcnt(2)
    v_mfma_f32_32x32x16_bf16 v[64:79], v[168:171], a[228:231], v[64:79]
    ds_read_b64_tr_b16 v[180:181], v13 offset:45056
    ds_read_b64_tr_b16 v[182:183], v13 offset:45568
    v_mov_b32 v113, v111
    v_permlane32_swap_b32 v112, v110
    buffer_load_dwordx4 v[212:215], v1, s[32:35], s36 offen offset:1024 sc1
    buffer_load_dwordx4 v[216:219], v1, s[32:35], s36 offen offset:2048 sc1
    v_mfma_f32_32x32x16_bf16 v[80:95], v[172:175], a[228:231], v[80:95]
    ds_read_b64_tr_b16 v[184:185], v14 offset:45056
    ds_read_b64_tr_b16 v[186:187], v14 offset:45568
    v_permlane32_swap_b32 v113, v111
    v_add_f32 v110, v110, v112
    buffer_load_dwordx4 v[220:223], v1, s[32:35], s36 offen offset:3072 sc1
    s_waitcnt lgkmcnt(2)
    v_mfma_f32_32x32x16_bf16 v[32:47], v[176:179], a[248:251], v[32:47]
    ds_read_b64_tr_b16 v[188:189], v15 offset:45056
    ds_read_b64_tr_b16 v[190:191], v15 offset:45568
    v_add_f32 v111, v111, v113
    v_mul_f32 v110, 0xbb124925, v110
    ds_read_b64_tr_b16 a[0:1], v28 offset:0
    ds_read_b64_tr_b16 a[2:3], v28 offset:512
    v_mfma_f32_32x32x16_bf16 v[48:63], v[180:183], a[248:251], v[48:63]
    ds_read_b64_tr_b16 v[192:193], v12 offset:47104
    ds_read_b64_tr_b16 v[194:195], v12 offset:47616
    v_mul_f32 v111, 0x3b124925, v111
    v_fma_f32 v111, -v110, v110, v111
    ds_read_b64_tr_b16 a[4:5], v29 offset:0
    s_waitcnt lgkmcnt(5)
    v_mfma_f32_32x32x16_bf16 v[64:79], v[184:187], a[248:251], v[64:79]
    ds_read_b64_tr_b16 v[196:197], v13 offset:47104
    ds_read_b64_tr_b16 v[198:199], v13 offset:47616
    v_max_f32 v111, 0, v111
    v_add_f32 v111, 0x3727c5ac, v111
    ds_read_b64_tr_b16 a[6:7], v29 offset:512
    s_waitcnt vmcnt(11)
    v_mfma_f32_32x32x16_bf16 v[80:95], v[188:191], a[248:251], v[80:95]
    ds_read_b64_tr_b16 v[200:201], v14 offset:47104
    ds_read_b64_tr_b16 v[202:203], v14 offset:47616
    v_rcp_f32 v25, v111
    v_sqrt_f32 v111, v111
    ds_read_b64_tr_b16 a[8:9], v28 offset:2048
    s_waitcnt lgkmcnt(4)
    v_mfma_f32_32x32x16_bf16 v[32:47], v[192:195], a[244:247], v[32:47]
    ds_read_b64_tr_b16 v[204:205], v15 offset:47104
    ds_read_b64_tr_b16 v[206:207], v15 offset:47616
    v_cvt_pk_bf16_f32 v112, v110, v111
    v_lshlrev_b32 v113, 16, v112
    ds_read_b64_tr_b16 a[10:11], v28 offset:2560
    ds_read_b64_tr_b16 a[12:13], v29 offset:2048
    v_mfma_f32_32x32x16_bf16 v[48:63], v[196:199], a[244:247], v[48:63]
    ds_read_b64_tr_b16 v[160:161], v12 offset:49152
    ds_read_b64_tr_b16 v[162:163], v12 offset:49664
    v_and_b32 v114, 0xffff0000, v112
    v_sub_f32 v113, v110, v113
    buffer_load_dwordx4 a[248:251], v1, s[32:35], s40 offen offset:3072 sc1
    s_waitcnt lgkmcnt(4)
    v_mfma_f32_32x32x16_bf16 v[64:79], v[200:203], a[244:247], v[64:79]
    ds_read_b64_tr_b16 v[164:165], v13 offset:49152
    ds_read_b64_tr_b16 v[166:167], v13 offset:49664
    v_sub_f32 v114, v111, v114
    v_cvt_pk_bf16_f32 v113, v113, v114
    ds_read_b64_tr_b16 a[14:15], v29 offset:2560
    ds_read_b64_tr_b16 a[16:17], v28 offset:4096
    v_mfma_f32_32x32x16_bf16 v[80:95], v[204:207], a[244:247], v[80:95]
    ds_read_b64_tr_b16 v[168:169], v14 offset:49152
    ds_read_b64_tr_b16 v[170:171], v14 offset:49664
    v_perm_b32 v20, v112, v112, s100
    v_bfi_b32 v21, s55, v113, v112
    s_add_u32 s40, s40, 4096
    s_barrier
    s_waitcnt vmcnt(11) lgkmcnt(4)
    v_mfma_f32_32x32x16_bf16 v[32:47], v[160:163], a[240:243], v[32:47]
    ds_read_b64_tr_b16 v[172:173], v15 offset:49152
    ds_read_b64_tr_b16 v[174:175], v15 offset:49664
    v_perm_b32 v22, v113, v112, s101
    v_mov_b32 v23, 0
    buffer_load_dwordx4 a[244:247], v1, s[32:35], s40 offen offset:0 sc1
    ds_read_b64_tr_b16 a[18:19], v28 offset:4608
    v_mfma_f32_32x32x16_bf16 v[48:63], v[164:167], a[240:243], v[48:63]
    ds_read_b64_tr_b16 v[176:177], v12 offset:51200
    ds_read_b64_tr_b16 v[178:179], v12 offset:51712
    buffer_load_dwordx4 a[232:235], v1, s[32:35], s40 offen offset:1024 sc1
    ds_read_b64_tr_b16 a[20:21], v29 offset:4096
    ds_read_b64_tr_b16 a[22:23], v29 offset:4608
    s_waitcnt vmcnt(10) lgkmcnt(5)
    v_mfma_f32_32x32x16_bf16 v[64:79], v[168:171], a[240:243], v[64:79]
    ds_read_b64_tr_b16 v[180:181], v13 offset:51200
    ds_read_b64_tr_b16 v[182:183], v13 offset:51712
    ds_read_b64_tr_b16 a[24:25], v28 offset:6144
    ds_read_b64_tr_b16 a[26:27], v28 offset:6656
    ds_read_b64_tr_b16 v[184:185], v14 offset:51200
    ds_read_b64_tr_b16 v[186:187], v14 offset:51712
    v_mfma_f32_32x32x16_bf16 v[80:95], v[172:175], a[240:243], v[80:95]
    buffer_load_dwordx4 a[240:243], v1, s[32:35], s40 offen offset:2048 sc1
    ds_read_b64_tr_b16 a[28:29], v29 offset:6144
    ds_read_b64_tr_b16 a[30:31], v29 offset:6656
    ds_read_b64_tr_b16 v[188:189], v15 offset:51200
    ds_read_b64_tr_b16 v[190:191], v15 offset:51712
    s_waitcnt lgkmcnt(8)
    v_mfma_f32_32x32x16_bf16 v[32:47], v[176:179], a[236:239], v[32:47]
    buffer_load_dwordx4 a[228:231], v1, s[32:35], s40 offen offset:3072 sc1
    ds_read_b64_tr_b16 v[192:193], v12 offset:53248
    ds_read_b64_tr_b16 v[194:195], v12 offset:53760
    ds_read_b64_tr_b16 v[196:197], v13 offset:53248
    ds_read_b64_tr_b16 v[198:199], v13 offset:53760
    ds_read_b64_tr_b16 v[200:201], v14 offset:53248
    v_mfma_f32_32x32x16_bf16 v[48:63], v[180:183], a[236:239], v[48:63]
    ds_read_b64_tr_b16 v[202:203], v14 offset:53760
    ds_read_b64_tr_b16 v[204:205], v15 offset:53248
    ds_read_b64_tr_b16 v[206:207], v15 offset:53760
    s_waitcnt lgkmcnt(8)
    v_mfma_f32_32x32x16_bf16 v[64:79], v[184:187], a[236:239], v[64:79]
    s_add_u32 m0, s37, 0
    s_add_u32 s57, s57, 14336
    ds_read_b64_tr_b16 v[160:161], v12 offset:55296
    ds_read_b64_tr_b16 v[162:163], v12 offset:55808
    buffer_load_dwordx4 v2, s[24:27], s57 offen lds
    s_waitcnt vmcnt(10)
    v_mfma_f32_32x32x16_bf16 v[80:95], v[188:191], a[236:239], v[80:95]
    buffer_load_dwordx4 v0, s[24:27], s57 offen offset:1024 lds
    ds_read_b64_tr_b16 a[32:33], v28 offset:8192
    ds_read_b64_tr_b16 a[34:35], v28 offset:8704
    ds_read_b64_tr_b16 v[164:165], v13 offset:55296
    ds_read_b64_tr_b16 v[166:167], v13 offset:55808
    s_waitcnt lgkmcnt(10)
    v_mfma_f32_32x32x16_bf16 v[32:47], v[192:195], a[252:255], v[32:47]
    ds_read_b64_tr_b16 a[36:37], v29 offset:8192
    ds_read_b64_tr_b16 a[38:39], v29 offset:8704
    ds_read_b64_tr_b16 v[168:169], v14 offset:55296
    ds_read_b64_tr_b16 v[170:171], v14 offset:55808
    v_mfma_f32_32x32x16_bf16 v[48:63], v[196:199], a[252:255], v[48:63]
    ds_read_b64_tr_b16 v[172:173], v15 offset:55296
    ds_read_b64_tr_b16 v[174:175], v15 offset:55808
    s_waitcnt lgkmcnt(12)
    v_mfma_f32_32x32x16_bf16 v[64:79], v[200:203], a[252:255], v[64:79]
    s_add_u32 s40, s40, 4096
    buffer_load_dwordx4 a[236:239], v1, s[32:35], s40 offen offset:0 sc1
    v_mfma_f32_32x32x16_bf16 v[80:95], v[204:207], a[252:255], v[80:95]
    s_waitcnt vmcnt(7) lgkmcnt(6)
    v_mfma_f32_32x32x16_bf16 v[32:47], v[160:163], a[248:251], v[32:47]
    buffer_load_dwordx4 a[252:255], v1, s[32:35], s40 offen offset:1024 sc1
    v_mfma_f32_32x32x16_bf16 v[48:63], v[164:167], a[248:251], v[48:63]
    s_add_u32 m0, s37, 2048
    s_add_u32 s57, s57, 14336
    buffer_load_dwordx4 v2, s[24:27], s57 offen lds
    buffer_load_dwordx4 v0, s[24:27], s57 offen offset:1024 lds
    s_waitcnt lgkmcnt(0)
    v_mfma_f32_32x32x16_bf16 v[64:79], v[168:171], a[248:251], v[64:79]
    s_add_u32 m0, s37, 4096
    s_add_u32 s57, s57, 14336
    ds_read_b64_tr_b16 v[176:177], v12 offset:0
    ds_read_b64_tr_b16 v[178:179], v12 offset:512
    buffer_load_dwordx4 v2, s[24:27], s57 offen lds
    buffer_load_dwordx4 v0, s[24:27], s57 offen offset:1024 lds
    v_mfma_f32_32x32x16_bf16 v[80:95], v[172:175], a[248:251], v[80:95]
    ds_read_b64_tr_b16 v[180:181], v13 offset:0
    ds_read_b64_tr_b16 v[182:183], v13 offset:512
    v_mfma_f32_32x32x16_bf16 v[32:47], v[208:211], v[16:19], v[32:47]
    ds_read_b64_tr_b16 v[184:185], v14 offset:0
    ds_read_b64_tr_b16 v[186:187], v14 offset:512
    v_mfma_f32_32x32x16_bf16 v[48:63], v[212:215], v[16:19], v[48:63]
    s_add_u32 m0, s37, 6144
    s_add_u32 s57, s57, 14336
    ds_read_b64_tr_b16 v[188:189], v15 offset:0
    ds_read_b64_tr_b16 v[190:191], v15 offset:512
    buffer_load_dwordx4 v2, s[24:27], s57 offen lds
    v_mfma_f32_32x32x16_bf16 v[64:79], v[216:219], v[16:19], v[64:79]
    buffer_load_dwordx4 v0, s[24:27], s57 offen offset:1024 lds
    ds_read_b64_tr_b16 v[192:193], v12 offset:2048
    ds_read_b64_tr_b16 v[194:195], v12 offset:2560
    v_mfma_f32_32x32x16_bf16 v[80:95], v[220:223], v[16:19], v[80:95]
    ds_read_b64_tr_b16 v[196:197], v13 offset:2048
    ds_read_b64_tr_b16 v[198:199], v13 offset:2560
    s_waitcnt vmcnt(13) lgkmcnt(8)
    v_mfma_f32_32x32x16_bf16 v[96:111], v[176:179], a[244:247], 0
    buffer_load_dwordx4 a[248:251], v1, s[32:35], s40 offen offset:2048 sc1
    ds_read_b64_tr_b16 v[200:201], v14 offset:2048
    ds_read_b64_tr_b16 v[202:203], v14 offset:2560
    v_mfma_f32_32x32x16_bf16 v[112:127], v[180:183], a[244:247], 0
    ds_read_b64_tr_b16 v[204:205], v15 offset:2048
    ds_read_b64_tr_b16 v[206:207], v15 offset:2560
    s_waitcnt lgkmcnt(8)
    v_mfma_f32_32x32x16_bf16 v[128:143], v[184:187], a[244:247], 0
    s_add_u32 m0, s37, 8192
    s_add_u32 s57, s57, 14336
    ds_read_b64_tr_b16 v[160:161], v12 offset:4096
    ds_read_b64_tr_b16 v[162:163], v12 offset:4608
    buffer_load_dwordx4 v2, s[24:27], s57 offen lds
    s_waitcnt vmcnt(10)
    v_mfma_f32_32x32x16_bf16 v[144:159], v[188:191], a[244:247], 0
    buffer_load_dwordx4 v0, s[24:27], s57 offen offset:1024 lds
    ds_read_b64_tr_b16 a[40:41], v28 offset:0
    ds_read_b64_tr_b16 a[42:43], v28 offset:512
    ds_read_b64_tr_b16 v[164:165], v13 offset:4096
    ds_read_b64_tr_b16 v[166:167], v13 offset:4608
    s_waitcnt lgkmcnt(10)
    v_mfma_f32_32x32x16_bf16 v[96:111], v[192:195], a[232:235], v[96:111]
    v_max_f32 v32, 0, v32
    v_mul_f32 v40, v24, v40
    ds_read_b64_tr_b16 a[44:45], v29 offset:0
    ds_read_b64_tr_b16 a[46:47], v29 offset:512
    v_max_f32 v33, 0, v33
    v_mul_f32 v41, v24, v41
    v_mfma_f32_32x32x16_bf16 v[112:127], v[196:199], a[232:235], v[112:127]
    v_max_f32 v34, 0, v34
    v_mul_f32 v42, v24, v42
    v_max_f32 v35, 0, v35
    v_mul_f32 v43, v24, v43
    v_max_f32 v36, 0, v36
    s_waitcnt lgkmcnt(8)
    v_mfma_f32_32x32x16_bf16 v[128:143], v[200:203], a[232:235], v[128:143]
    v_mul_f32 v44, v24, v44
    v_max_f32 v37, 0, v37
    buffer_load_dwordx4 a[244:247], v1, s[32:35], s40 offen offset:3072 sc1
    v_mul_f32 v45, v24, v45
    v_max_f32 v38, 0, v38
    v_mul_f32 v46, v24, v46
    v_mfma_f32_32x32x16_bf16 v[144:159], v[204:207], a[232:235], v[144:159]
    ds_read_b64_tr_b16 v[168:169], v14 offset:4096
    ds_read_b64_tr_b16 v[170:171], v14 offset:4608
    v_max_f32 v39, 0, v39
    v_mul_f32 v47, v24, v47
    v_mul_f32 v32, v32, v40
    s_waitcnt lgkmcnt(4)
    v_mfma_f32_32x32x16_bf16 v[96:111], v[160:163], a[240:243], v[96:111]
    ds_read_b64_tr_b16 v[172:173], v15 offset:4096
    ds_read_b64_tr_b16 v[174:175], v15 offset:4608
    v_mul_f32 v33, v33, v41
    v_mul_f32 v34, v34, v42
    s_add_u32 s40, s40, 4096
    buffer_load_dwordx4 a[232:235], v1, s[32:35], s40 offen offset:0 sc1
    v_mfma_f32_32x32x16_bf16 v[112:127], v[164:167], a[240:243], v[112:127]
    ds_read_b64_tr_b16 v[176:177], v12 offset:6144
    ds_read_b64_tr_b16 v[178:179], v12 offset:6656
    v_mul_f32 v35, v35, v43
    v_mul_f32 v36, v36, v44
    v_mul_f32 v37, v37, v45
    s_waitcnt vmcnt(9) lgkmcnt(2)
    v_mfma_f32_32x32x16_bf16 v[128:143], v[168:171], a[240:243], v[128:143]
    ds_read_b64_tr_b16 v[180:181], v13 offset:6144
    ds_read_b64_tr_b16 v[182:183], v13 offset:6656
    v_mul_f32 v38, v38, v46
    v_mul_f32 v39, v39, v47
    s_add_u32 m0, s37, 0
    s_add_u32 s57, s57, 14336
    v_mfma_f32_32x32x16_bf16 v[144:159], v[172:175], a[240:243], v[144:159]
    ds_read_b64_tr_b16 v[184:185], v14 offset:6144
    ds_read_b64_tr_b16 v[186:187], v14 offset:6656
    v_cvt_pk_bf16_f32 v224, v32, v33
    v_cvt_pk_bf16_f32 v225, v34, v35
    buffer_load_dwordx4 v2, s[24:27], s57 offen lds
    s_waitcnt lgkmcnt(2)
    v_mfma_f32_32x32x16_bf16 v[96:111], v[176:179], a[228:231], v[96:111]
    ds_read_b64_tr_b16 v[188:189], v15 offset:6144
    ds_read_b64_tr_b16 v[190:191], v15 offset:6656
    v_cvt_pk_bf16_f32 v226, v36, v37
    v_cvt_pk_bf16_f32 v227, v38, v39
    buffer_load_dwordx4 v0, s[24:27], s57 offen offset:1024 lds
    ds_read_b64_tr_b16 a[48:49], v28 offset:2048
    v_mfma_f32_32x32x16_bf16 v[112:127], v[180:183], a[228:231], v[112:127]
    ds_read_b64_tr_b16 v[192:193], v12 offset:8192
    ds_read_b64_tr_b16 v[194:195], v12 offset:8704
    v_max_f32 v48, 0, v48
    v_mul_f32 v56, v24, v56
    buffer_load_dwordx4 a[240:243], v1, s[32:35], s40 offen offset:1024 sc1
    s_waitcnt vmcnt(10) lgkmcnt(3)
    v_mfma_f32_32x32x16_bf16 v[128:143], v[184:187], a[228:231], v[128:143]
    ds_read_b64_tr_b16 v[196:197], v13 offset:8192
    ds_read_b64_tr_b16 v[198:199], v13 offset:8704
    v_max_f32 v49, 0, v49
    v_mul_f32 v57, v24, v57
    buffer_store_dwordx4 v[224:227], v1, s[32:35], s56 offen offset:0 sc1
    ds_read_b64_tr_b16 a[50:51], v28 offset:2560
    v_mfma_f32_32x32x16_bf16 v[144:159], v[188:191], a[228:231], v[144:159]
    ds_read_b64_tr_b16 v[200:201], v14 offset:8192
    ds_read_b64_tr_b16 v[202:203], v14 offset:8704
    v_max_f32 v50, 0, v50
    v_mul_f32 v58, v24, v58
    ds_read_b64_tr_b16 a[52:53], v29 offset:2048
    s_waitcnt lgkmcnt(4)
    v_mfma_f32_32x32x16_bf16 v[96:111], v[192:195], a[236:239], v[96:111]
    ds_read_b64_tr_b16 v[204:205], v15 offset:8192
    ds_read_b64_tr_b16 v[206:207], v15 offset:8704
    v_max_f32 v51, 0, v51
    v_mul_f32 v59, v24, v59
    ds_read_b64_tr_b16 a[54:55], v29 offset:2560
    ds_read_b64_tr_b16 a[56:57], v28 offset:4096
    v_mfma_f32_32x32x16_bf16 v[112:127], v[196:199], a[236:239], v[112:127]
    ds_read_b64_tr_b16 v[160:161], v12 offset:10240
    ds_read_b64_tr_b16 v[162:163], v12 offset:10752
    v_max_f32 v52, 0, v52
    v_mul_f32 v60, v24, v60
    buffer_load_dwordx4 a[228:231], v1, s[32:35], s40 offen offset:2048 sc1
    s_waitcnt vmcnt(10) lgkmcnt(4)
    v_mfma_f32_32x32x16_bf16 v[128:143], v[200:203], a[236:239], v[128:143]
    ds_read_b64_tr_b16 v[164:165], v13 offset:10240
    ds_read_b64_tr_b16 v[166:167], v13 offset:10752
    v_max_f32 v53, 0, v53
    v_mul_f32 v61, v24, v61
    ds_read_b64_tr_b16 a[58:59], v28 offset:4608
    ds_read_b64_tr_b16 a[60:61], v29 offset:4096
    v_mfma_f32_32x32x16_bf16 v[144:159], v[204:207], a[236:239], v[144:159]
    ds_read_b64_tr_b16 v[168:169], v14 offset:10240
    ds_read_b64_tr_b16 v[170:171], v14 offset:10752
    v_max_f32 v54, 0, v54
    v_mul_f32 v62, v24, v62
    ds_read_b64_tr_b16 a[62:63], v29 offset:4608
    s_waitcnt lgkmcnt(5)
    v_mfma_f32_32x32x16_bf16 v[96:111], v[160:163], a[252:255], v[96:111]
    ds_read_b64_tr_b16 v[172:173], v15 offset:10240
    ds_read_b64_tr_b16 v[174:175], v15 offset:10752
    v_max_f32 v55, 0, v55
    v_mul_f32 v63, v24, v63
    buffer_load_dwordx4 a[236:239], v1, s[32:35], s40 offen offset:3072 sc1
    ds_read_b64_tr_b16 a[64:65], v28 offset:6144
    v_mfma_f32_32x32x16_bf16 v[112:127], v[164:167], a[252:255], v[112:127]
    ds_read_b64_tr_b16 v[176:177], v12 offset:12288
    ds_read_b64_tr_b16 v[178:179], v12 offset:12800
    v_mul_f32 v48, v48, v56
    v_mul_f32 v49, v49, v57
    s_add_u32 m0, s37, 2048
    s_waitcnt lgkmcnt(3)
    v_mfma_f32_32x32x16_bf16 v[128:143], v[168:171], a[252:255], v[128:143]
    ds_read_b64_tr_b16 v[180:181], v13 offset:12288
    ds_read_b64_tr_b16 v[182:183], v13 offset:12800
    v_mul_f32 v50, v50, v58
    v_mul_f32 v51, v51, v59
    s_add_u32 s57, s57, 14336
    s_waitcnt vmcnt(8)
    v_mfma_f32_32x32x16_bf16 v[144:159], v[172:175], a[252:255], v[144:159]
    ds_read_b64_tr_b16 v[184:185], v14 offset:12288
    ds_read_b64_tr_b16 v[186:187], v14 offset:12800
    v_mul_f32 v52, v52, v60
    v_mul_f32 v53, v53, v61
    buffer_load_dwordx4 v2, s[24:27], s57 offen lds
    s_waitcnt lgkmcnt(2)
    v_mfma_f32_32x32x16_bf16 v[96:111], v[176:179], a[248:251], v[96:111]
    ds_read_b64_tr_b16 v[188:189], v15 offset:12288
    ds_read_b64_tr_b16 v[190:191], v15 offset:12800
    v_mul_f32 v54, v54, v62
    v_mul_f32 v55, v55, v63
    buffer_load_dwordx4 v0, s[24:27], s57 offen offset:1024 lds
    s_add_u32 s40, s40, 4096
    v_mfma_f32_32x32x16_bf16 v[112:127], v[180:183], a[248:251], v[112:127]
    ds_read_b64_tr_b16 v[192:193], v12 offset:14336
    ds_read_b64_tr_b16 v[194:195], v12 offset:14848
    v_cvt_pk_bf16_f32 v228, v48, v49
    v_cvt_pk_bf16_f32 v229, v50, v51
    buffer_load_dwordx4 a[252:255], v1, s[32:35], s40 offen offset:0 sc1
    s_waitcnt lgkmcnt(2)
    v_mfma_f32_32x32x16_bf16 v[128:143], v[184:187], a[248:251], v[128:143]
    ds_read_b64_tr_b16 v[196:197], v13 offset:14336
    ds_read_b64_tr_b16 v[198:199], v13 offset:14848
    v_cvt_pk_bf16_f32 v230, v52, v53
    v_cvt_pk_bf16_f32 v231, v54, v55
    s_add_u32 m0, s37, 4096
    s_add_u32 s57, s57, 14336
    v_mfma_f32_32x32x16_bf16 v[144:159], v[188:191], a[248:251], v[144:159]
    ds_read_b64_tr_b16 v[200:201], v14 offset:14336
    ds_read_b64_tr_b16 v[202:203], v14 offset:14848
    v_max_f32 v64, 0, v64
    v_mul_f32 v72, v24, v72
    buffer_load_dwordx4 v2, s[24:27], s57 offen lds
    s_waitcnt vmcnt(11) lgkmcnt(2)
    v_mfma_f32_32x32x16_bf16 v[96:111], v[192:195], a[244:247], v[96:111]
    ds_read_b64_tr_b16 v[204:205], v15 offset:14336
    ds_read_b64_tr_b16 v[206:207], v15 offset:14848
    v_max_f32 v65, 0, v65
    v_mul_f32 v73, v24, v73
    buffer_load_dwordx4 v0, s[24:27], s57 offen offset:1024 lds
    buffer_store_dwordx4 v[228:231], v1, s[32:35], s56 offen offset:1024 sc1
    v_mfma_f32_32x32x16_bf16 v[112:127], v[196:199], a[244:247], v[112:127]
    ds_read_b64_tr_b16 v[160:161], v12 offset:16384
    ds_read_b64_tr_b16 v[162:163], v12 offset:16896
    v_max_f32 v66, 0, v66
    v_mul_f32 v74, v24, v74
    ds_read_b64_tr_b16 a[66:67], v28 offset:6656
    s_waitcnt vmcnt(10) lgkmcnt(3)
    v_mfma_f32_32x32x16_bf16 v[128:143], v[200:203], a[244:247], v[128:143]
    ds_read_b64_tr_b16 v[164:165], v13 offset:16384
    ds_read_b64_tr_b16 v[166:167], v13 offset:16896
    v_max_f32 v67, 0, v67
    v_mul_f32 v75, v24, v75
    ds_read_b64_tr_b16 a[68:69], v29 offset:6144
    ds_read_b64_tr_b16 a[70:71], v29 offset:6656
    v_mfma_f32_32x32x16_bf16 v[144:159], v[204:207], a[244:247], v[144:159]
    ds_read_b64_tr_b16 v[168:169], v14 offset:16384
    ds_read_b64_tr_b16 v[170:171], v14 offset:16896
    v_max_f32 v68, 0, v68
    v_mul_f32 v76, v24, v76
    ds_read_b64_tr_b16 a[72:73], v28 offset:8192
    s_waitcnt lgkmcnt(5)
    v_mfma_f32_32x32x16_bf16 v[96:111], v[160:163], a[232:235], v[96:111]
    ds_read_b64_tr_b16 v[172:173], v15 offset:16384
    ds_read_b64_tr_b16 v[174:175], v15 offset:16896
    v_max_f32 v69, 0, v69
    v_mul_f32 v77, v24, v77
    buffer_load_dwordx4 a[248:251], v1, s[32:35], s40 offen offset:1024 sc1
    ds_read_b64_tr_b16 a[74:75], v28 offset:8704
    v_mfma_f32_32x32x16_bf16 v[112:127], v[164:167], a[232:235], v[112:127]
    ds_read_b64_tr_b16 v[176:177], v12 offset:18432
    ds_read_b64_tr_b16 v[178:179], v12 offset:18944
    v_max_f32 v70, 0, v70
    v_mul_f32 v78, v24, v78
    ds_read_b64_tr_b16 a[76:77], v29 offset:8192
    s_waitcnt lgkmcnt(4)
    v_mfma_f32_32x32x16_bf16 v[128:143], v[168:171], a[232:235], v[128:143]
    ds_read_b64_tr_b16 v[180:181], v13 offset:18432
    ds_read_b64_tr_b16 v[182:183], v13 offset:18944
    v_max_f32 v71, 0, v71
    v_mul_f32 v79, v24, v79
    ds_read_b64_tr_b16 a[78:79], v29 offset:8704
    ds_read_b64_tr_b16 a[80:81], v28 offset:0
    v_mfma_f32_32x32x16_bf16 v[144:159], v[172:175], a[232:235], v[144:159]
    ds_read_b64_tr_b16 v[184:185], v14 offset:18432
    ds_read_b64_tr_b16 v[186:187], v14 offset:18944
    v_mul_f32 v64, v64, v72
    v_mul_f32 v65, v65, v73
    buffer_load_dwordx4 a[244:247], v1, s[32:35], s40 offen offset:2048 sc1
    s_waitcnt vmcnt(11) lgkmcnt(4)
    v_mfma_f32_32x32x16_bf16 v[96:111], v[176:179], a[240:243], v[96:111]
    ds_read_b64_tr_b16 v[188:189], v15 offset:18432
    ds_read_b64_tr_b16 v[190:191], v15 offset:18944
    v_mul_f32 v66, v66, v74
    v_mul_f32 v67, v67, v75
    buffer_load_dwordx4 a[232:235], v1, s[32:35], s40 offen offset:3072 sc1
    ds_read_b64_tr_b16 a[82:83], v28 offset:512
    v_mfma_f32_32x32x16_bf16 v[112:127], v[180:183], a[240:243], v[112:127]
    ds_read_b64_tr_b16 v[192:193], v12 offset:20480
    ds_read_b64_tr_b16 v[194:195], v12 offset:20992
    v_mul_f32 v68, v68, v76
    v_mul_f32 v69, v69, v77
    ds_read_b64_tr_b16 a[84:85], v29 offset:0
    s_waitcnt lgkmcnt(4)
    v_mfma_f32_32x32x16_bf16 v[128:143], v[184:187], a[240:243], v[128:143]
    ds_read_b64_tr_b16 v[196:197], v13 offset:20480
    ds_read_b64_tr_b16 v[198:199], v13 offset:20992
    v_mul_f32 v70, v70, v78
    v_mul_f32 v71, v71, v79
    s_add_u32 m0, s37, 6144
    s_add_u32 s57, s57, 14336
    v_mfma_f32_32x32x16_bf16 v[144:159], v[188:191], a[240:243], v[144:159]
    ds_read_b64_tr_b16 v[200:201], v14 offset:20480
    ds_read_b64_tr_b16 v[202:203], v14 offset:20992
    v_cvt_pk_bf16_f32 v232, v64, v65
    v_cvt_pk_bf16_f32 v233, v66, v67
    buffer_load_dwordx4 v2, s[24:27], s57 offen lds
    s_waitcnt vmcnt(11) lgkmcnt(2)
    v_mfma_f32_32x32x16_bf16 v[96:111], v[192:195], a[228:231], v[96:111]
    ds_read_b64_tr_b16 v[204:205], v15 offset:20480
    ds_read_b64_tr_b16 v[206:207], v15 offset:20992
    v_cvt_pk_bf16_f32 v234, v68, v69
    v_cvt_pk_bf16_f32 v235, v70, v71
    buffer_load_dwordx4 v0, s[24:27], s57 offen offset:1024 lds
    ds_read_b64_tr_b16 a[86:87], v29 offset:512
    v_mfma_f32_32x32x16_bf16 v[112:127], v[196:199], a[228:231], v[112:127]
    ds_read_b64_tr_b16 v[160:161], v12 offset:22528
    ds_read_b64_tr_b16 v[162:163], v12 offset:23040
    v_max_f32 v80, 0, v80
    v_mul_f32 v88, v24, v88
    buffer_store_dwordx4 v[232:235], v1, s[32:35], s56 offen offset:2048 sc1
    s_waitcnt lgkmcnt(3)
    v_mfma_f32_32x32x16_bf16 v[128:143], v[200:203], a[228:231], v[128:143]
    ds_read_b64_tr_b16 v[164:165], v13 offset:22528
    ds_read_b64_tr_b16 v[166:167], v13 offset:23040
    v_max_f32 v81, 0, v81
    v_mul_f32 v89, v24, v89
    v_max_f32 v82, 0, v82
    s_waitcnt vmcnt(10)
    v_mfma_f32_32x32x16_bf16 v[144:159], v[204:207], a[228:231], v[144:159]
    ds_read_b64_tr_b16 v[168:169], v14 offset:22528
    ds_read_b64_tr_b16 v[170:171], v14 offset:23040
    v_mul_f32 v90, v24, v90
    v_max_f32 v83, 0, v83
    ds_read_b64_tr_b16 a[88:89], v28 offset:2048
    s_waitcnt lgkmcnt(3)
    v_mfma_f32_32x32x16_bf16 v[96:111], v[160:163], a[236:239], v[96:111]
    ds_read_b64_tr_b16 v[172:173], v15 offset:22528
    ds_read_b64_tr_b16 v[174:175], v15 offset:23040
    v_mul_f32 v91, v24, v91
    v_max_f32 v84, 0, v84
    ds_read_b64_tr_b16 a[90:91], v28 offset:2560
    ds_read_b64_tr_b16 a[92:93], v29 offset:2048
    v_mfma_f32_32x32x16_bf16 v[112:127], v[164:167], a[236:239], v[112:127]
    ds_read_b64_tr_b16 v[176:177], v12 offset:24576
    ds_read_b64_tr_b16 v[178:179], v12 offset:25088
    v_mul_f32 v92, v24, v92
    v_max_f32 v85, 0, v85
    s_add_u32 s40, s40, 4096
    s_waitcnt lgkmcnt(4)
    v_mfma_f32_32x32x16_bf16 v[128:143], v[168:171], a[236:239], v[128:143]
    ds_read_b64_tr_b16 v[180:181], v13 offset:24576
    ds_read_b64_tr_b16 v[182:183], v13 offset:25088
    v_mul_f32 v93, v24, v93
    v_max_f32 v86, 0, v86
    buffer_load_dwordx4 a[240:243], v1, s[32:35], s40 offen offset:0 sc1
    ds_read_b64_tr_b16 a[94:95], v29 offset:2560
    v_mfma_f32_32x32x16_bf16 v[144:159], v[172:175], a[236:239], v[144:159]
    ds_read_b64_tr_b16 v[184:185], v14 offset:24576
    ds_read_b64_tr_b16 v[186:187], v14 offset:25088
    v_mul_f32 v94, v24, v94
    v_max_f32 v87, 0, v87
    buffer_load_dwordx4 a[236:239], v1, s[32:35], s40 offen offset:1024 sc1
    s_waitcnt vmcnt(9) lgkmcnt(3)
    v_mfma_f32_32x32x16_bf16 v[96:111], v[176:179], a[252:255], v[96:111]
    ds_read_b64_tr_b16 v[188:189], v15 offset:24576
    ds_read_b64_tr_b16 v[190:191], v15 offset:25088
    v_mul_f32 v95, v24, v95
    v_mul_f32 v80, v80, v88
    buffer_load_dwordx4 a[228:231], v1, s[32:35], s40 offen offset:2048 sc1
    ds_read_b64_tr_b16 a[96:97], v28 offset:4096
    v_mfma_f32_32x32x16_bf16 v[112:127], v[180:183], a[252:255], v[112:127]
    ds_read_b64_tr_b16 v[192:193], v12 offset:26624
    ds_read_b64_tr_b16 v[194:195], v12 offset:27136
    v_mul_f32 v81, v81, v89
    v_mul_f32 v82, v82, v90
    ds_read_b64_tr_b16 a[98:99], v28 offset:4608
    s_waitcnt lgkmcnt(4)
    v_mfma_f32_32x32x16_bf16 v[128:143], v[184:187], a[252:255], v[128:143]
    ds_read_b64_tr_b16 v[196:197], v13 offset:26624
    ds_read_b64_tr_b16 v[198:199], v13 offset:27136
    v_mul_f32 v83, v83, v91
    v_mul_f32 v84, v84, v92
    ds_read_b64_tr_b16 a[100:101], v29 offset:4096
    ds_read_b64_tr_b16 a[102:103], v29 offset:4608
    v_mfma_f32_32x32x16_bf16 v[144:159], v[188:191], a[252:255], v[144:159]
    ds_read_b64_tr_b16 v[200:201], v14 offset:26624
    ds_read_b64_tr_b16 v[202:203], v14 offset:27136
    v_mul_f32 v85, v85, v93
    v_mul_f32 v86, v86, v94
    s_add_u32 m0, s37, 8192
    s_waitcnt vmcnt(8) lgkmcnt(4)
    v_mfma_f32_32x32x16_bf16 v[96:111], v[192:195], a[248:251], v[96:111]
    ds_read_b64_tr_b16 v[204:205], v15 offset:26624
    ds_read_b64_tr_b16 v[206:207], v15 offset:27136
    v_mul_f32 v87, v87, v95
    v_cvt_pk_bf16_f32 v236, v80, v81
    s_add_u32 s57, s57, 14336
    buffer_load_dwordx4 v2, s[24:27], s57 offen lds
    v_mfma_f32_32x32x16_bf16 v[112:127], v[196:199], a[248:251], v[112:127]
    ds_read_b64_tr_b16 v[160:161], v12 offset:28672
    ds_read_b64_tr_b16 v[162:163], v12 offset:29184
    v_cvt_pk_bf16_f32 v237, v82, v83
    v_cvt_pk_bf16_f32 v238, v84, v85
    buffer_load_dwordx4 v0, s[24:27], s57 offen offset:1024 lds
    s_waitcnt lgkmcnt(2)
    v_mfma_f32_32x32x16_bf16 v[128:143], v[200:203], a[248:251], v[128:143]
    ds_read_b64_tr_b16 v[164:165], v13 offset:28672
    ds_read_b64_tr_b16 v[166:167], v13 offset:29184
    v_cvt_pk_bf16_f32 v239, v86, v87
    buffer_load_dwordx4 a[252:255], v1, s[32:35], s40 offen offset:3072 sc1
    buffer_store_dwordx4 v[236:239], v1, s[32:35], s56 offen offset:3072 sc1
    ds_read_b64_tr_b16 v[168:169], v14 offset:28672
    v_mfma_f32_32x32x16_bf16 v[144:159], v[204:207], a[248:251], v[144:159]
    ds_read_b64_tr_b16 v[170:171], v14 offset:29184
    s_add_u32 s56, s56, 114688
    ds_read_b64_tr_b16 v[172:173], v15 offset:28672
    ds_read_b64_tr_b16 v[174:175], v15 offset:29184
    ds_read_b64_tr_b16 v[176:177], v12 offset:30720
    s_waitcnt vmcnt(11) lgkmcnt(5)
    v_mfma_f32_32x32x16_bf16 v[96:111], v[160:163], a[244:247], v[96:111]
    ds_read_b64_tr_b16 v[178:179], v12 offset:31232
    ds_read_b64_tr_b16 v[180:181], v13 offset:30720
    ds_read_b64_tr_b16 v[182:183], v13 offset:31232
    ds_read_b64_tr_b16 v[184:185], v14 offset:30720
    ds_read_b64_tr_b16 v[186:187], v14 offset:31232
    v_mfma_f32_32x32x16_bf16 v[112:127], v[164:167], a[244:247], v[112:127]
    ds_read_b64_tr_b16 v[188:189], v15 offset:30720
    ds_read_b64_tr_b16 v[190:191], v15 offset:31232
    s_waitcnt lgkmcnt(8)
    v_mfma_f32_32x32x16_bf16 v[128:143], v[168:171], a[244:247], v[128:143]
    s_add_u32 s40, s40, 4096
    buffer_load_dwordx4 a[248:251], v1, s[32:35], s40 offen offset:0 sc1
    ds_read_b64_tr_b16 v[192:193], v12 offset:32768
    ds_read_b64_tr_b16 v[194:195], v12 offset:33280
    v_mfma_f32_32x32x16_bf16 v[144:159], v[172:175], a[244:247], v[144:159]
    ds_read_b64_tr_b16 v[196:197], v13 offset:32768
    ds_read_b64_tr_b16 v[198:199], v13 offset:33280
    s_waitcnt vmcnt(9) lgkmcnt(8)
    v_mfma_f32_32x32x16_bf16 v[96:111], v[176:179], a[232:235], v[96:111]
    buffer_load_dwordx4 a[244:247], v1, s[32:35], s40 offen offset:1024 sc1
    ds_read_b64_tr_b16 a[104:105], v28 offset:6144
    ds_read_b64_tr_b16 a[106:107], v28 offset:6656
    ds_read_b64_tr_b16 v[200:201], v14 offset:32768
    ds_read_b64_tr_b16 v[202:203], v14 offset:33280
    v_mfma_f32_32x32x16_bf16 v[112:127], v[180:183], a[232:235], v[112:127]
    ds_read_b64_tr_b16 a[108:109], v29 offset:6144
    ds_read_b64_tr_b16 a[110:111], v29 offset:6656
    ds_read_b64_tr_b16 v[204:205], v15 offset:32768
    ds_read_b64_tr_b16 v[206:207], v15 offset:33280
    s_waitcnt lgkmcnt(12)
    v_mfma_f32_32x32x16_bf16 v[128:143], v[184:187], a[232:235], v[128:143]
    s_add_u32 m0, s37, 0
    s_add_u32 s57, s57, 14336
    ds_read_b64_tr_b16 v[160:161], v12 offset:34816
    ds_read_b64_tr_b16 v[162:163], v12 offset:35328
    buffer_load_dwordx4 v2, s[24:27], s57 offen lds
    buffer_load_dwordx4 v0, s[24:27], s57 offen offset:1024 lds
    v_mfma_f32_32x32x16_bf16 v[144:159], v[188:191], a[232:235], v[144:159]
    ds_read_b64_tr_b16 v[164:165], v13 offset:34816
    ds_read_b64_tr_b16 v[166:167], v13 offset:35328
    s_waitcnt vmcnt(10) lgkmcnt(12)
    v_mfma_f32_32x32x16_bf16 v[96:111], v[192:195], a[240:243], v[96:111]
    ds_read_b64_tr_b16 v[168:169], v14 offset:34816
    ds_read_b64_tr_b16 v[170:171], v14 offset:35328
    v_mfma_f32_32x32x16_bf16 v[112:127], v[196:199], a[240:243], v[112:127]
    buffer_load_dwordx4 a[232:235], v1, s[32:35], s40 offen offset:2048 sc1
    ds_read_b64_tr_b16 v[172:173], v15 offset:34816
    ds_read_b64_tr_b16 v[174:175], v15 offset:35328
    s_waitcnt lgkmcnt(8)
    v_mfma_f32_32x32x16_bf16 v[128:143], v[200:203], a[240:243], v[128:143]
    ds_read_b64_tr_b16 v[176:177], v12 offset:36864
    ds_read_b64_tr_b16 v[178:179], v12 offset:37376
    v_mfma_f32_32x32x16_bf16 v[144:159], v[204:207], a[240:243], v[144:159]
    s_add_u32 m0, s37, 2048
    s_add_u32 s57, s57, 14336
    ds_read_b64_tr_b16 v[180:181], v13 offset:36864
    ds_read_b64_tr_b16 v[182:183], v13 offset:37376
    buffer_load_dwordx4 v2, s[24:27], s57 offen lds
    s_waitcnt vmcnt(11) lgkmcnt(8)
    v_mfma_f32_32x32x16_bf16 v[96:111], v[160:163], a[236:239], v[96:111]
    buffer_load_dwordx4 v0, s[24:27], s57 offen offset:1024 lds
    ds_read_b64_tr_b16 v[184:185], v14 offset:36864
    ds_read_b64_tr_b16 v[186:187], v14 offset:37376
    v_mfma_f32_32x32x16_bf16 v[112:127], v[164:167], a[236:239], v[112:127]
    ds_read_b64_tr_b16 v[188:189], v15 offset:36864
    ds_read_b64_tr_b16 v[190:191], v15 offset:37376
    s_waitcnt lgkmcnt(8)
    v_mfma_f32_32x32x16_bf16 v[128:143], v[168:171], a[236:239], v[128:143]
    ds_read_b64_tr_b16 v[192:193], v12 offset:38912
    ds_read_b64_tr_b16 v[194:195], v12 offset:39424
    v_mfma_f32_32x32x16_bf16 v[144:159], v[172:175], a[236:239], v[144:159]
    buffer_load_dwordx4 a[240:243], v1, s[32:35], s40 offen offset:3072 sc1
    ds_read_b64_tr_b16 v[196:197], v13 offset:38912
    ds_read_b64_tr_b16 v[198:199], v13 offset:39424
    s_waitcnt vmcnt(10) lgkmcnt(8)
    v_mfma_f32_32x32x16_bf16 v[96:111], v[176:179], a[228:231], v[96:111]
    s_add_u32 s40, s40, 4096
    buffer_load_dwordx4 a[236:239], v1, s[32:35], s40 offen offset:0 sc1
    ds_read_b64_tr_b16 a[112:113], v28 offset:8192
    ds_read_b64_tr_b16 a[114:115], v28 offset:8704
    ds_read_b64_tr_b16 v[200:201], v14 offset:38912
    ds_read_b64_tr_b16 v[202:203], v14 offset:39424
    v_mfma_f32_32x32x16_bf16 v[112:127], v[180:183], a[228:231], v[112:127]
    ds_read_b64_tr_b16 a[116:117], v29 offset:8192
    ds_read_b64_tr_b16 a[118:119], v29 offset:8704
    ds_read_b64_tr_b16 v[204:205], v15 offset:38912
    ds_read_b64_tr_b16 v[206:207], v15 offset:39424
    s_waitcnt lgkmcnt(12)
    v_mfma_f32_32x32x16_bf16 v[128:143], v[184:187], a[228:231], v[128:143]
    ds_read_b64_tr_b16 v[160:161], v12 offset:40960
    ds_read_b64_tr_b16 v[162:163], v12 offset:41472
    v_mfma_f32_32x32x16_bf16 v[144:159], v[188:191], a[228:231], v[144:159]
    ds_read_b64_tr_b16 v[164:165], v13 offset:40960
    ds_read_b64_tr_b16 v[166:167], v13 offset:41472
    s_waitcnt vmcnt(10) lgkmcnt(12)
    v_mfma_f32_32x32x16_bf16 v[96:111], v[192:195], a[252:255], v[96:111]
    s_waitcnt vmcnt(9)
    s_mov_b64 exec, 1
    buffer_store_dword v11, v10, s[32:35], s48 offen offset:0 sc1
    s_mov_b64 exec, -1
    ds_read_b64_tr_b16 v[168:169], v14 offset:40960
    ds_read_b64_tr_b16 v[170:171], v14 offset:41472
    v_mfma_f32_32x32x16_bf16 v[112:127], v[196:199], a[252:255], v[112:127]
    ds_read_b64_tr_b16 v[172:173], v15 offset:40960
    ds_read_b64_tr_b16 v[174:175], v15 offset:41472
    s_waitcnt lgkmcnt(8)
    v_mfma_f32_32x32x16_bf16 v[128:143], v[200:203], a[252:255], v[128:143]
    buffer_load_dwordx4 a[228:231], v1, s[32:35], s40 offen offset:1024 sc1
    ds_read_b64_tr_b16 v[176:177], v12 offset:43008
    ds_read_b64_tr_b16 v[178:179], v12 offset:43520
    v_mfma_f32_32x32x16_bf16 v[144:159], v[204:207], a[252:255], v[144:159]
    ds_read_b64_tr_b16 v[180:181], v13 offset:43008
    ds_read_b64_tr_b16 v[182:183], v13 offset:43520
    s_waitcnt vmcnt(10) lgkmcnt(8)
    v_mfma_f32_32x32x16_bf16 v[96:111], v[160:163], a[248:251], v[96:111]
    buffer_load_dwordx4 a[252:255], v1, s[32:35], s40 offen offset:2048 sc1
    ds_read_b64_tr_b16 v[184:185], v14 offset:43008
    ds_read_b64_tr_b16 v[186:187], v14 offset:43520
    v_mfma_f32_32x32x16_bf16 v[112:127], v[164:167], a[248:251], v[112:127]
    s_add_u32 m0, s37, 4096
    s_add_u32 s57, s57, 14336
    ds_read_b64_tr_b16 v[188:189], v15 offset:43008
    ds_read_b64_tr_b16 v[190:191], v15 offset:43520
    buffer_load_dwordx4 v2, s[24:27], s57 offen lds
    s_waitcnt lgkmcnt(8)
    v_mfma_f32_32x32x16_bf16 v[128:143], v[168:171], a[248:251], v[128:143]
    buffer_load_dwordx4 v0, s[24:27], s57 offen offset:1024 lds
    ds_read_b64_tr_b16 v[192:193], v12 offset:45056
    ds_read_b64_tr_b16 v[194:195], v12 offset:45568
    v_mfma_f32_32x32x16_bf16 v[144:159], v[172:175], a[248:251], v[144:159]
    ds_read_b64_tr_b16 v[196:197], v13 offset:45056
    ds_read_b64_tr_b16 v[198:199], v13 offset:45568
    s_waitcnt vmcnt(10) lgkmcnt(8)
    v_mfma_f32_32x32x16_bf16 v[96:111], v[176:179], a[244:247], v[96:111]
    buffer_load_dword v9, v31, s[32:35], s48 offen offset:0 sc1
    ds_read_b64_tr_b16 a[120:121], v28 offset:0
    ds_read_b64_tr_b16 a[122:123], v28 offset:512
    ds_read_b64_tr_b16 v[200:201], v14 offset:45056
    ds_read_b64_tr_b16 v[202:203], v14 offset:45568
    v_mfma_f32_32x32x16_bf16 v[112:127], v[180:183], a[244:247], v[112:127]
    ds_read_b64_tr_b16 a[124:125], v29 offset:0
    ds_read_b64_tr_b16 a[126:127], v29 offset:512
    ds_read_b64_tr_b16 v[204:205], v15 offset:45056
    ds_read_b64_tr_b16 v[206:207], v15 offset:45568
    s_waitcnt lgkmcnt(12)
    v_mfma_f32_32x32x16_bf16 v[128:143], v[184:187], a[244:247], v[128:143]
    ds_read_b64_tr_b16 v[160:161], v12 offset:47104
    ds_read_b64_tr_b16 v[162:163], v12 offset:47616
    v_mfma_f32_32x32x16_bf16 v[144:159], v[188:191], a[244:247], v[144:159]
    buffer_load_dwordx4 a[248:251], v1, s[32:35], s40 offen offset:3072 sc1
    ds_read_b64_tr_b16 v[164:165], v13 offset:47104
    ds_read_b64_tr_b16 v[166:167], v13 offset:47616
    s_waitcnt vmcnt(11) lgkmcnt(12)
    v_mfma_f32_32x32x16_bf16 v[96:111], v[192:195], a[232:235], v[96:111]
    ds_read_b64_tr_b16 v[168:169], v14 offset:47104
    ds_read_b64_tr_b16 v[170:171], v14 offset:47616
    v_mfma_f32_32x32x16_bf16 v[112:127], v[196:199], a[232:235], v[112:127]
    s_add_u32 m0, s37, 6144
    s_add_u32 s57, s57, 14336
    ds_read_b64_tr_b16 v[172:173], v15 offset:47104
    ds_read_b64_tr_b16 v[174:175], v15 offset:47616
    buffer_load_dwordx4 v2, s[24:27], s57 offen lds
    s_waitcnt vmcnt(10) lgkmcnt(8)
    v_mfma_f32_32x32x16_bf16 v[128:143], v[200:203], a[232:235], v[128:143]
    buffer_load_dwordx4 v0, s[24:27], s57 offen offset:1024 lds
    ds_read_b64_tr_b16 a[128:129], v28 offset:2048
    ds_read_b64_tr_b16 a[130:131], v28 offset:2560
    ds_read_b64_tr_b16 v[176:177], v12 offset:49152
    ds_read_b64_tr_b16 v[178:179], v12 offset:49664
    v_mfma_f32_32x32x16_bf16 v[144:159], v[204:207], a[232:235], v[144:159]
    ds_read_b64_tr_b16 a[132:133], v29 offset:2048
    ds_read_b64_tr_b16 a[134:135], v29 offset:2560
    ds_read_b64_tr_b16 v[180:181], v13 offset:49152
    ds_read_b64_tr_b16 v[182:183], v13 offset:49664
    s_waitcnt vmcnt(10) lgkmcnt(12)
    v_mfma_f32_32x32x16_bf16 v[96:111], v[160:163], a[240:243], v[96:111]
    s_add_u32 m0, s37, 8192
    s_add_u32 s57, s57, 14336
    ds_read_b64_tr_b16 v[184:185], v14 offset:49152
    ds_read_b64_tr_b16 v[186:187], v14 offset:49664
    buffer_load_dwordx4 v2, s[24:27], s57 offen lds
    buffer_load_dwordx4 v0, s[24:27], s57 offen offset:1024 lds
    v_mfma_f32_32x32x16_bf16 v[112:127], v[164:167], a[240:243], v[112:127]
    ds_read_b64_tr_b16 v[188:189], v15 offset:49152
    ds_read_b64_tr_b16 v[190:191], v15 offset:49664
    s_waitcnt lgkmcnt(12)
    v_mfma_f32_32x32x16_bf16 v[128:143], v[168:171], a[240:243], v[128:143]
    ds_read_b64_tr_b16 v[192:193], v12 offset:51200
    ds_read_b64_tr_b16 v[194:195], v12 offset:51712
    v_mfma_f32_32x32x16_bf16 v[144:159], v[172:175], a[240:243], v[144:159]
    s_add_u32 m0, s37, 0
    s_add_u32 s57, s57, 14336
    ds_read_b64_tr_b16 v[196:197], v13 offset:51200
    ds_read_b64_tr_b16 v[198:199], v13 offset:51712
    buffer_load_dwordx4 v2, s[24:27], s57 offen lds
    s_waitcnt vmcnt(12) lgkmcnt(8)
    v_mfma_f32_32x32x16_bf16 v[96:111], v[176:179], a[236:239], v[96:111]
    buffer_load_dwordx4 v0, s[24:27], s57 offen offset:1024 lds
    ds_read_b64_tr_b16 v[200:201], v14 offset:51200
    ds_read_b64_tr_b16 v[202:203], v14 offset:51712
    v_mfma_f32_32x32x16_bf16 v[112:127], v[180:183], a[236:239], v[112:127]
    ds_read_b64_tr_b16 v[204:205], v15 offset:51200
    ds_read_b64_tr_b16 v[206:207], v15 offset:51712
    s_waitcnt lgkmcnt(8)
    v_mfma_f32_32x32x16_bf16 v[128:143], v[184:187], a[236:239], v[128:143]
    s_add_u32 m0, s37, 2048
    s_add_u32 s57, s57, 14336
    ds_read_b64_tr_b16 v[160:161], v12 offset:53248
    ds_read_b64_tr_b16 v[162:163], v12 offset:53760
    buffer_load_dwordx4 v2, s[24:27], s57 offen lds
    buffer_load_dwordx4 v0, s[24:27], s57 offen offset:1024 lds
    v_mfma_f32_32x32x16_bf16 v[144:159], v[188:191], a[236:239], v[144:159]
    ds_read_b64_tr_b16 v[164:165], v13 offset:53248
    ds_read_b64_tr_b16 v[166:167], v13 offset:53760
    s_waitcnt vmcnt(13) lgkmcnt(8)
    v_mfma_f32_32x32x16_bf16 v[96:111], v[192:195], a[228:231], v[96:111]
    s_waitcnt vmcnt(9)
    v_cmp_ne_u32 vcc, s47, v9
    s_cbranch_vccnz L_hw_40
L_hw_40_back:
    buffer_load_dwordx4 a[244:247], v1, s[32:35], s59 offen offset:0 sc1
    ds_read_b64_tr_b16 v[168:169], v14 offset:53248
    v_mfma_f32_32x32x16_bf16 v[112:127], v[196:199], a[228:231], v[112:127]
    ds_read_b64_tr_b16 a[136:137], v28 offset:4096
    ds_read_b64_tr_b16 a[138:139], v28 offset:4608
    ds_read_b64_tr_b16 v[170:171], v14 offset:53760
    ds_read_b64_tr_b16 v[172:173], v15 offset:53248
    ds_read_b64_tr_b16 v[174:175], v15 offset:53760
    s_waitcnt lgkmcnt(10)
    v_mfma_f32_32x32x16_bf16 v[128:143], v[200:203], a[228:231], v[128:143]
    buffer_load_dwordx4 a[240:243], v1, s[32:35], s59 offen offset:1024 sc1
    ds_read_b64_tr_b16 a[140:141], v29 offset:4096
    ds_read_b64_tr_b16 a[142:143], v29 offset:4608
    ds_read_b64_tr_b16 v[176:177], v12 offset:55296
    ds_read_b64_tr_b16 v[178:179], v12 offset:55808
    v_mfma_f32_32x32x16_bf16 v[144:159], v[204:207], a[228:231], v[144:159]
    ds_read_b64_tr_b16 v[180:181], v13 offset:55296
    ds_read_b64_tr_b16 v[182:183], v13 offset:55808
    s_waitcnt lgkmcnt(12)
    v_mfma_f32_32x32x16_bf16 v[96:111], v[160:163], a[252:255], v[96:111]
    buffer_load_dwordx4 a[236:239], v1, s[32:35], s59 offen offset:2048 sc1
    ds_read_b64_tr_b16 v[184:185], v14 offset:55296
    ds_read_b64_tr_b16 v[186:187], v14 offset:55808
    v_mfma_f32_32x32x16_bf16 v[112:127], v[164:167], a[252:255], v[112:127]
    ds_read_b64_tr_b16 v[188:189], v15 offset:55296
    ds_read_b64_tr_b16 v[190:191], v15 offset:55808
    s_waitcnt lgkmcnt(10)
    v_mfma_f32_32x32x16_bf16 v[128:143], v[168:171], a[252:255], v[128:143]
    buffer_load_dwordx4 a[232:235], v1, s[32:35], s59 offen offset:3072 sc1
    s_waitcnt vmcnt(10)
    v_mfma_f32_32x32x16_bf16 v[144:159], v[172:175], a[252:255], v[144:159]
    ds_read_b64_tr_b16 a[144:145], v28 offset:6144
    ds_read_b64_tr_b16 a[146:147], v28 offset:6656
    s_waitcnt lgkmcnt(6)
    v_mfma_f32_32x32x16_bf16 v[96:111], v[176:179], a[248:251], v[96:111]
    s_add_u32 s59, s59, 4096
    buffer_load_dwordx4 a[252:255], v1, s[32:35], s59 offen offset:0 sc1
    ds_read_b64_tr_b16 a[148:149], v29 offset:6144
    ds_read_b64_tr_b16 a[150:151], v29 offset:6656
    v_mfma_f32_32x32x16_bf16 v[112:127], v[180:183], a[248:251], v[112:127]
    buffer_load_dwordx4 a[228:231], v1, s[32:35], s59 offen offset:1024 sc1
    s_waitcnt vmcnt(10) lgkmcnt(4)
    v_mfma_f32_32x32x16_bf16 v[128:143], v[184:187], a[248:251], v[128:143]
    ds_read_b64_tr_b16 a[152:153], v28 offset:8192
    ds_read_b64_tr_b16 a[154:155], v28 offset:8704
    v_mfma_f32_32x32x16_bf16 v[144:159], v[188:191], a[248:251], v[144:159]
    buffer_load_dwordx4 a[248:251], v1, s[32:35], s59 offen offset:2048 sc1
    ds_read_b64_tr_b16 a[156:157], v29 offset:8192
    ds_read_b64_tr_b16 a[158:159], v29 offset:8704
    v_mfma_f32_32x32x16_bf16 v[96:111], v[208:211], v[20:23], v[96:111]
    v_mfma_f32_32x32x16_bf16 v[112:127], v[212:215], v[20:23], v[112:127]
    buffer_load_dwordx4 a[224:227], v1, s[32:35], s59 offen offset:3072 sc1
    s_waitcnt vmcnt(10)
    v_mfma_f32_32x32x16_bf16 v[128:143], v[216:219], v[20:23], v[128:143]
    ds_read_b64_tr_b16 a[160:161], v28 offset:0
    ds_read_b64_tr_b16 a[162:163], v28 offset:512
    v_mfma_f32_32x32x16_bf16 v[144:159], v[220:223], v[20:23], v[144:159]
    s_add_u32 s59, s59, 4096
    buffer_load_dwordx4 v[160:163], v1, s[32:35], s59 offen offset:0 sc1
    ds_read_b64_tr_b16 a[164:165], v29 offset:0
    ds_read_b64_tr_b16 a[166:167], v29 offset:512
    s_waitcnt vmcnt(8)
    v_mfma_f32_32x32x16_bf16 v[32:47], a[0:3], a[244:247], 0
    buffer_load_dwordx4 v[164:167], v1, s[32:35], s59 offen offset:1024 sc1
    v_mfma_f32_32x32x16_bf16 v[48:63], a[4:7], a[244:247], 0
    buffer_load_dwordx4 v[168:171], v1, s[32:35], s59 offen offset:2048 sc1
    ds_read_b64_tr_b16 a[168:169], v28 offset:2048
    ds_read_b64_tr_b16 a[170:171], v28 offset:2560
    s_waitcnt vmcnt(9)
    v_mfma_f32_32x32x16_bf16 v[32:47], a[8:11], a[240:243], v[32:47]
    v_max_f32 v96, 0, v96
    v_mul_f32 v104, v25, v104
    buffer_load_dwordx4 v[172:175], v1, s[32:35], s59 offen offset:3072 sc1
    ds_read_b64_tr_b16 a[172:173], v29 offset:2048
    ds_read_b64_tr_b16 a[174:175], v29 offset:2560
    v_max_f32 v97, 0, v97
    v_mfma_f32_32x32x16_bf16 v[48:63], a[12:15], a[240:243], v[48:63]
    v_mul_f32 v105, v25, v105
    v_max_f32 v98, 0, v98
    s_add_u32 s59, s59, 4096
    buffer_load_dwordx4 v[176:179], v1, s[32:35], s59 offen offset:0 sc1
    v_mul_f32 v106, v25, v106
    s_waitcnt vmcnt(10)
    v_mfma_f32_32x32x16_bf16 v[32:47], a[16:19], a[236:239], v[32:47]
    v_max_f32 v99, 0, v99
    v_mul_f32 v107, v25, v107
    v_max_f32 v100, 0, v100
    v_mul_f32 v108, v25, v108
    v_max_f32 v101, 0, v101
    v_mul_f32 v109, v25, v109
    v_mfma_f32_32x32x16_bf16 v[48:63], a[20:23], a[236:239], v[48:63]
    v_max_f32 v102, 0, v102
    v_mul_f32 v110, v25, v110
    buffer_load_dwordx4 v[180:183], v1, s[32:35], s59 offen offset:1024 sc1
    v_max_f32 v103, 0, v103
    v_mul_f32 v111, v25, v111
    s_waitcnt vmcnt(10)
    v_mfma_f32_32x32x16_bf16 v[32:47], a[24:27], a[232:235], v[32:47]
    v_mul_f32 v96, v96, v104
    v_mul_f32 v97, v97, v105
    v_mul_f32 v98, v98, v106
    v_mul_f32 v99, v99, v107
    v_mul_f32 v100, v100, v108
    v_mul_f32 v101, v101, v109
    v_mfma_f32_32x32x16_bf16 v[48:63], a[28:31], a[232:235], v[48:63]
    v_mul_f32 v102, v102, v110
    v_mul_f32 v103, v103, v111
    buffer_load_dwordx4 v[184:187], v1, s[32:35], s59 offen offset:2048 sc1
    v_cvt_pk_bf16_f32 v224, v96, v97
    v_cvt_pk_bf16_f32 v225, v98, v99
    s_waitcnt vmcnt(10)
    v_mfma_f32_32x32x16_bf16 v[32:47], a[32:35], a[252:255], v[32:47]
    v_cvt_pk_bf16_f32 v226, v100, v101
    v_cvt_pk_bf16_f32 v227, v102, v103
    v_max_f32 v112, 0, v112
    v_mul_f32 v120, v25, v120
    v_max_f32 v113, 0, v113
    v_mul_f32 v121, v25, v121
    v_mfma_f32_32x32x16_bf16 v[48:63], a[36:39], a[252:255], v[48:63]
    v_max_f32 v114, 0, v114
    v_mul_f32 v122, v25, v122
    buffer_store_dwordx4 v[224:227], v1, s[32:35], s56 offen offset:0 sc1
    v_max_f32 v115, 0, v115
    v_mul_f32 v123, v25, v123
    s_waitcnt vmcnt(10)
    v_mfma_f32_32x32x16_bf16 v[32:47], a[40:43], a[228:231], v[32:47]
    v_max_f32 v116, 0, v116
    v_mul_f32 v124, v25, v124
    v_max_f32 v117, 0, v117
    v_mul_f32 v125, v25, v125
    v_max_f32 v118, 0, v118
    v_mul_f32 v126, v25, v126
    v_mfma_f32_32x32x16_bf16 v[48:63], a[44:47], a[228:231], v[48:63]
    v_max_f32 v119, 0, v119
    v_mul_f32 v127, v25, v127
    buffer_load_dwordx4 v[188:191], v1, s[32:35], s59 offen offset:3072 sc1
    v_mul_f32 v112, v112, v120
    v_mul_f32 v113, v113, v121
    s_waitcnt vmcnt(10)
    v_mfma_f32_32x32x16_bf16 v[32:47], a[48:51], a[248:251], v[32:47]
    v_mul_f32 v114, v114, v122
    v_mul_f32 v115, v115, v123
    v_mul_f32 v116, v116, v124
    v_mul_f32 v117, v117, v125
    v_mul_f32 v118, v118, v126
    v_mul_f32 v119, v119, v127
    v_mfma_f32_32x32x16_bf16 v[48:63], a[52:55], a[248:251], v[48:63]
    v_cvt_pk_bf16_f32 v228, v112, v113
    v_cvt_pk_bf16_f32 v229, v114, v115
    s_add_u32 s59, s59, 4096
    buffer_load_dwordx4 v[192:195], v1, s[32:35], s59 offen offset:0 sc1
    v_cvt_pk_bf16_f32 v230, v116, v117
    s_waitcnt vmcnt(10)
    v_mfma_f32_32x32x16_bf16 v[32:47], a[56:59], a[224:227], v[32:47]
    v_cvt_pk_bf16_f32 v231, v118, v119
    v_max_f32 v128, 0, v128
    buffer_store_dwordx4 v[228:231], v1, s[32:35], s56 offen offset:1024 sc1
    v_mul_f32 v136, v25, v136
    v_max_f32 v129, 0, v129
    v_mul_f32 v137, v25, v137
    v_mfma_f32_32x32x16_bf16 v[48:63], a[60:63], a[224:227], v[48:63]
    v_max_f32 v130, 0, v130
    v_mul_f32 v138, v25, v138
    v_max_f32 v131, 0, v131
    v_mul_f32 v139, v25, v139
    v_max_f32 v132, 0, v132
    s_waitcnt vmcnt(10)
    v_mfma_f32_32x32x16_bf16 v[32:47], a[64:67], v[160:163], v[32:47]
    v_mul_f32 v140, v25, v140
    v_max_f32 v133, 0, v133
    v_mul_f32 v141, v25, v141
    v_max_f32 v134, 0, v134
    v_mul_f32 v142, v25, v142
    v_max_f32 v135, 0, v135
    v_mfma_f32_32x32x16_bf16 v[48:63], a[68:71], v[160:163], v[48:63]
    v_mul_f32 v143, v25, v143
    v_mul_f32 v128, v128, v136
    v_mul_f32 v129, v129, v137
    v_mul_f32 v130, v130, v138
    v_mul_f32 v131, v131, v139
    s_waitcnt vmcnt(9)
    v_mfma_f32_32x32x16_bf16 v[32:47], a[72:75], v[164:167], v[32:47]
    v_mul_f32 v132, v132, v140
    v_mul_f32 v133, v133, v141
    v_mul_f32 v134, v134, v142
    v_mul_f32 v135, v135, v143
    v_cvt_pk_bf16_f32 v232, v128, v129
    v_cvt_pk_bf16_f32 v233, v130, v131
    v_mfma_f32_32x32x16_bf16 v[48:63], a[76:79], v[164:167], v[48:63]
    v_cvt_pk_bf16_f32 v234, v132, v133
    v_cvt_pk_bf16_f32 v235, v134, v135
    buffer_load_dwordx4 v[196:199], v1, s[32:35], s59 offen offset:1024 sc1
    v_max_f32 v144, 0, v144
    v_mul_f32 v152, v25, v152
    s_waitcnt vmcnt(9)
    v_mfma_f32_32x32x16_bf16 v[32:47], a[80:83], v[168:171], v[32:47]
    v_max_f32 v145, 0, v145
    v_mul_f32 v153, v25, v153
    buffer_store_dwordx4 v[232:235], v1, s[32:35], s56 offen offset:2048 sc1
    v_max_f32 v146, 0, v146
    v_mul_f32 v154, v25, v154
    v_max_f32 v147, 0, v147
    v_mfma_f32_32x32x16_bf16 v[48:63], a[84:87], v[168:171], v[48:63]
    v_mul_f32 v155, v25, v155
    v_max_f32 v148, 0, v148
    v_mul_f32 v156, v25, v156
    v_max_f32 v149, 0, v149
    v_mul_f32 v157, v25, v157
    s_waitcnt vmcnt(9)
    v_mfma_f32_32x32x16_bf16 v[32:47], a[88:91], v[172:175], v[32:47]
    v_max_f32 v150, 0, v150
    v_mul_f32 v158, v25, v158
    v_max_f32 v151, 0, v151
    v_mul_f32 v159, v25, v159
    v_mul_f32 v144, v144, v152
    v_mul_f32 v145, v145, v153
    v_mfma_f32_32x32x16_bf16 v[48:63], a[92:95], v[172:175], v[48:63]
    v_mul_f32 v146, v146, v154
    v_mul_f32 v147, v147, v155
    v_mul_f32 v148, v148, v156
    v_mul_f32 v149, v149, v157
    v_mul_f32 v150, v150, v158
    s_waitcnt vmcnt(8)
    v_mfma_f32_32x32x16_bf16 v[32:47], a[96:99], v[176:179], v[32:47]
    v_mul_f32 v151, v151, v159
    v_cvt_pk_bf16_f32 v236, v144, v145
    v_cvt_pk_bf16_f32 v237, v146, v147
    v_cvt_pk_bf16_f32 v238, v148, v149
    v_cvt_pk_bf16_f32 v239, v150, v151
    buffer_store_dwordx4 v[236:239], v1, s[32:35], s56 offen offset:3072 sc1
    v_mfma_f32_32x32x16_bf16 v[48:63], a[100:103], v[176:179], v[48:63]
    s_add_u32 s56, s56, 114688
    s_waitcnt vmcnt(8)
    v_mfma_f32_32x32x16_bf16 v[32:47], a[104:107], v[180:183], v[32:47]
    v_mfma_f32_32x32x16_bf16 v[48:63], a[108:111], v[180:183], v[48:63]
    s_waitcnt vmcnt(7)
    v_mfma_f32_32x32x16_bf16 v[32:47], a[112:115], v[184:187], v[32:47]
    v_mfma_f32_32x32x16_bf16 v[48:63], a[116:119], v[184:187], v[48:63]
    buffer_load_dwordx4 v[200:203], v1, s[32:35], s59 offen offset:2048 sc1
    s_waitcnt vmcnt(6)
    v_mfma_f32_32x32x16_bf16 v[32:47], a[120:123], v[188:191], v[32:47]
    s_add_u32 m0, s37, 4096
    s_add_u32 s57, s57, 14336
    buffer_load_dwordx4 v2, s[24:27], s57 offen lds
    buffer_load_dwordx4 v0, s[24:27], s57 offen offset:1024 lds
    v_mfma_f32_32x32x16_bf16 v[48:63], a[124:127], v[188:191], v[48:63]
    buffer_load_dwordx4 v[204:207], v1, s[32:35], s59 offen offset:3072 sc1
    s_waitcnt vmcnt(8)
    v_mfma_f32_32x32x16_bf16 v[32:47], a[128:131], v[192:195], v[32:47]
    v_mfma_f32_32x32x16_bf16 v[48:63], a[132:135], v[192:195], v[48:63]
    s_add_u32 s59, s59, 4096
    buffer_load_dwordx4 a[244:247], v1, s[32:35], s59 offen offset:0 sc1
    s_waitcnt vmcnt(7)
    v_mfma_f32_32x32x16_bf16 v[32:47], a[136:139], v[196:199], v[32:47]
    buffer_load_dwordx4 a[240:243], v1, s[32:35], s59 offen offset:1024 sc1
    v_mfma_f32_32x32x16_bf16 v[48:63], a[140:143], v[196:199], v[48:63]
    buffer_load_dwordx4 a[236:239], v1, s[32:35], s59 offen offset:2048 sc1
    buffer_load_dwordx4 a[232:235], v1, s[32:35], s59 offen offset:3072 sc1
    s_waitcnt vmcnt(7) lgkmcnt(12)
    v_mfma_f32_32x32x16_bf16 v[32:47], a[144:147], v[200:203], v[32:47]
    s_mov_b64 exec, 1
    buffer_store_dword v11, v10, s[32:35], s48 offen offset:512 sc1
    s_mov_b64 exec, -1
    s_add_u32 m0, s37, 6144
    s_add_u32 s57, s57, 14336
    buffer_load_dwordx4 v2, s[24:27], s57 offen lds
    v_mfma_f32_32x32x16_bf16 v[48:63], a[148:151], v[200:203], v[48:63]
    buffer_load_dwordx4 v0, s[24:27], s57 offen offset:1024 lds
    s_add_u32 s59, s59, 4096
    buffer_load_dwordx4 a[252:255], v1, s[32:35], s59 offen offset:0 sc1
    s_waitcnt vmcnt(8) lgkmcnt(8)
    v_mfma_f32_32x32x16_bf16 v[32:47], a[152:155], v[204:207], v[32:47]
    buffer_load_dword v9, v31, s[32:35], s48 offen offset:512 sc1
    s_add_u32 m0, s37, 8192
    s_add_u32 s57, s57, 14336
    buffer_load_dwordx4 v2, s[24:27], s57 offen lds
    buffer_load_dwordx4 v0, s[24:27], s57 offen offset:1024 lds
    v_mfma_f32_32x32x16_bf16 v[48:63], a[156:159], v[204:207], v[48:63]
    ds_read_b64_tr_b16 a[176:177], v28 offset:4096
    ds_read_b64_tr_b16 a[178:179], v28 offset:4608
    s_waitcnt vmcnt(10) lgkmcnt(6)
    v_mfma_f32_32x32x16_bf16 v[32:47], a[160:163], a[244:247], v[32:47]
    ds_read_b64_tr_b16 a[180:181], v29 offset:4096
    ds_read_b64_tr_b16 a[182:183], v29 offset:4608
    v_mfma_f32_32x32x16_bf16 v[48:63], a[164:167], a[244:247], v[48:63]
    s_add_u32 m0, s37, 0
    s_add_u32 s57, s57, 14336
    buffer_load_dwordx4 v2, s[24:27], s57 offen lds
    buffer_load_dwordx4 v0, s[24:27], s57 offen offset:1024 lds
    s_waitcnt vmcnt(11) lgkmcnt(4)
    v_mfma_f32_32x32x16_bf16 v[32:47], a[168:171], a[240:243], v[32:47]
    v_mfma_f32_32x32x16_bf16 v[48:63], a[172:175], a[240:243], v[48:63]
    s_waitcnt vmcnt(10) lgkmcnt(0)
    v_mfma_f32_32x32x16_bf16 v[32:47], a[176:179], a[236:239], v[32:47]
    v_mfma_f32_32x32x16_bf16 v[48:63], a[180:183], a[236:239], v[48:63]
    s_add_u32 m0, s37, 2048
    s_add_u32 s57, s57, 14336
    buffer_load_dwordx4 v2, s[24:27], s57 offen lds
    buffer_load_dwordx4 v0, s[24:27], s57 offen offset:1024 lds
    s_waitcnt vmcnt(8)
    ds_read_b64_tr_b16 a[184:185], v28 offset:6144
    ds_read_b64_tr_b16 a[186:187], v28 offset:6656
    ds_read_b64_tr_b16 a[188:189], v29 offset:6144
    ds_read_b64_tr_b16 a[190:191], v29 offset:6656
    s_waitcnt lgkmcnt(0)
    v_mfma_f32_32x32x16_bf16 v[32:47], a[184:187], a[232:235], v[32:47]
    s_add_u32 m0, s37, 4096
    s_add_u32 s57, s57, 14336
    buffer_load_dwordx4 v2, s[24:27], s57 offen lds
    buffer_load_dwordx4 v0, s[24:27], s57 offen offset:1024 lds
    v_mfma_f32_32x32x16_bf16 v[48:63], a[188:191], a[232:235], v[48:63]
    buffer_load_dwordx4 a[228:231], v1, s[32:35], s59 offen offset:1024 sc1
    s_waitcnt vmcnt(7)
    ds_read_b64_tr_b16 a[192:193], v28 offset:8192
    ds_read_b64_tr_b16 a[194:195], v28 offset:8704
    ds_read_b64_tr_b16 a[196:197], v29 offset:8192
    ds_read_b64_tr_b16 a[198:199], v29 offset:8704
    s_waitcnt lgkmcnt(0)
    v_mfma_f32_32x32x16_bf16 v[32:47], a[192:195], a[252:255], v[32:47]
    v_cmp_ne_u32 vcc, s47, v9
    s_cbranch_vccnz L_hw_41
L_hw_41_back:
    buffer_load_dwordx4 a[248:251], v1, s[32:35], s59 offen offset:2048 sc1
    v_mfma_f32_32x32x16_bf16 v[48:63], a[196:199], a[252:255], v[48:63]
    buffer_load_dwordx4 a[224:227], v1, s[32:35], s59 offen offset:3072 sc1
    s_add_u32 s59, s59, 90112
    buffer_load_dwordx4 v[160:163], v1, s[32:35], s59 offen offset:0 sc1
    buffer_load_dwordx4 v[164:167], v1, s[32:35], s59 offen offset:1024 sc1
    s_waitcnt vmcnt(9)
    ds_read_b64_tr_b16 a[200:201], v28 offset:0
    ds_read_b64_tr_b16 a[202:203], v28 offset:512
    ds_read_b64_tr_b16 a[204:205], v29 offset:0
    ds_read_b64_tr_b16 a[206:207], v29 offset:512
    buffer_load_dwordx4 v[168:171], v1, s[32:35], s59 offen offset:2048 sc1
    s_waitcnt vmcnt(5) lgkmcnt(0)
    v_mfma_f32_32x32x16_bf16 v[32:47], a[200:203], a[228:231], v[32:47]
    buffer_load_dwordx4 v[172:175], v1, s[32:35], s59 offen offset:3072 sc1
    v_mfma_f32_32x32x16_bf16 v[48:63], a[204:207], a[228:231], v[48:63]
    s_add_u32 s59, s59, 4096
    buffer_load_dwordx4 v[176:179], v1, s[32:35], s59 offen offset:0 sc1
    ds_read_b64_tr_b16 a[208:209], v28 offset:2048
    ds_read_b64_tr_b16 a[210:211], v28 offset:2560
    ds_read_b64_tr_b16 a[212:213], v29 offset:2048
    ds_read_b64_tr_b16 a[214:215], v29 offset:2560
    ds_read_b64_tr_b16 a[216:217], v28 offset:4096
    ds_read_b64_tr_b16 a[218:219], v28 offset:4608
    ds_read_b64_tr_b16 a[220:221], v29 offset:4096
    ds_read_b64_tr_b16 a[222:223], v29 offset:4608
    s_waitcnt vmcnt(6) lgkmcnt(4)
    v_mfma_f32_32x32x16_bf16 v[32:47], a[208:211], a[248:251], v[32:47]
    buffer_load_dwordx4 v[180:183], v1, s[32:35], s59 offen offset:1024 sc1
    v_mfma_f32_32x32x16_bf16 v[48:63], a[212:215], a[248:251], v[48:63]
    buffer_load_dwordx4 v[184:187], v1, s[32:35], s59 offen offset:2048 sc1
    s_waitcnt vmcnt(7) lgkmcnt(0)
    v_mfma_f32_32x32x16_bf16 v[32:47], a[216:219], a[224:227], v[32:47]
    buffer_load_dwordx4 v[188:191], v1, s[32:35], s59 offen offset:3072 sc1
    v_mfma_f32_32x32x16_bf16 v[48:63], a[220:223], a[224:227], v[48:63]
    s_add_u32 s59, s59, 4096
    buffer_load_dwordx4 v[192:195], v1, s[32:35], s59 offen offset:0 sc1
    s_waitcnt vmcnt(8)
    v_mfma_f32_32x32x16_bf16 v[64:79], a[0:3], v[160:163], 0
    s_lshl_b32 s53, s46, 13
    v_add_u32 v5, s53, v1
    buffer_load_dwordx4 v[196:199], v1, s[32:35], s59 offen offset:1024 sc1
    v_xor_b32 v12, 8192, v5
    v_xor_b32 v13, 16384, v5
    v_xor_b32 v14, 24576, v5
    v_mfma_f32_32x32x16_bf16 v[80:95], a[4:7], v[160:163], 0
    v_lshlrev_b32 v128, 16, v248
    v_and_b32 v129, 0xffff0000, v248
    buffer_load_dwordx4 v[200:203], v1, s[32:35], s59 offen offset:2048 sc1
    v_lshlrev_b32 v130, 16, v249
    v_and_b32 v131, 0xffff0000, v249
    s_waitcnt vmcnt(9)
    v_mfma_f32_32x32x16_bf16 v[64:79], a[8:11], v[164:167], v[64:79]
    v_lshlrev_b32 v132, 16, v250
    v_and_b32 v133, 0xffff0000, v250
    buffer_load_dwordx4 v[204:207], v1, s[32:35], s59 offen offset:3072 sc1
    v_lshlrev_b32 v134, 16, v251
    v_and_b32 v135, 0xffff0000, v251
    v_lshlrev_b32 v136, 16, v240
    v_mfma_f32_32x32x16_bf16 v[80:95], a[12:15], v[164:167], v[80:95]
    v_and_b32 v137, 0xffff0000, v240
    v_lshlrev_b32 v138, 16, v241
    v_and_b32 v139, 0xffff0000, v241
    v_lshlrev_b32 v140, 16, v242
    v_and_b32 v141, 0xffff0000, v242
    s_waitcnt vmcnt(9)
    v_mfma_f32_32x32x16_bf16 v[64:79], a[16:19], v[168:171], v[64:79]
    v_lshlrev_b32 v142, 16, v243
    v_and_b32 v143, 0xffff0000, v243
    s_add_u32 s59, s59, 4096
    buffer_load_dwordx4 a[244:247], v1, s[32:35], s59 offen offset:0 sc1
    v_lshlrev_b32 v152, 16, v244
    v_and_b32 v153, 0xffff0000, v244
    v_mfma_f32_32x32x16_bf16 v[80:95], a[20:23], v[168:171], v[80:95]
    v_lshlrev_b32 v154, 16, v245
    v_and_b32 v155, 0xffff0000, v245
    v_lshlrev_b32 v156, 16, v246
    v_and_b32 v157, 0xffff0000, v246
    v_lshlrev_b32 v158, 16, v247
    s_waitcnt vmcnt(9)
    v_mfma_f32_32x32x16_bf16 v[64:79], a[24:27], v[172:175], v[64:79]
    v_and_b32 v159, 0xffff0000, v247
    buffer_load_dwordx4 a[240:243], v1, s[32:35], s59 offen offset:1024 sc1
    v_mfma_f32_32x32x16_bf16 v[80:95], a[28:31], v[172:175], v[80:95]
    buffer_load_dwordx4 a[236:239], v1, s[32:35], s59 offen offset:2048 sc1
    s_barrier
    s_waitcnt vmcnt(10)
    v_mfma_f32_32x32x16_bf16 v[64:79], a[32:35], v[176:179], v[64:79]
    ds_write_b128 v13, v[40:43] offset:2048
    v_mfma_f32_32x32x16_bf16 v[80:95], a[36:39], v[176:179], v[80:95]
    buffer_load_dwordx4 a[232:235], v1, s[32:35], s59 offen offset:3072 sc1
    s_waitcnt vmcnt(10)
    v_mfma_f32_32x32x16_bf16 v[64:79], a[40:43], v[180:183], v[64:79]
    ds_write_b128 v13, v[44:47] offset:3072
    v_mfma_f32_32x32x16_bf16 v[80:95], a[44:47], v[180:183], v[80:95]
    s_add_u32 s59, s59, 4096
    buffer_load_dwordx4 a[252:255], v1, s[32:35], s59 offen offset:0 sc1
    s_waitcnt vmcnt(10)
    v_mfma_f32_32x32x16_bf16 v[64:79], a[48:51], v[184:187], v[64:79]
    ds_write_b128 v12, v[48:51] offset:0
    v_mfma_f32_32x32x16_bf16 v[80:95], a[52:55], v[184:187], v[80:95]
    buffer_load_dwordx4 a[228:231], v1, s[32:35], s59 offen offset:1024 sc1
    s_waitcnt vmcnt(10)
    v_mfma_f32_32x32x16_bf16 v[64:79], a[56:59], v[188:191], v[64:79]
    ds_write_b128 v12, v[52:55] offset:1024
    v_mfma_f32_32x32x16_bf16 v[80:95], a[60:63], v[188:191], v[80:95]
    buffer_load_dwordx4 a[248:251], v1, s[32:35], s59 offen offset:2048 sc1
    s_waitcnt vmcnt(10)
    v_mfma_f32_32x32x16_bf16 v[64:79], a[64:67], v[192:195], v[64:79]
    ds_write_b128 v14, v[56:59] offset:4096
    v_mfma_f32_32x32x16_bf16 v[80:95], a[68:71], v[192:195], v[80:95]
    buffer_load_dwordx4 a[224:227], v1, s[32:35], s59 offen offset:3072 sc1
    s_waitcnt vmcnt(10)
    v_mfma_f32_32x32x16_bf16 v[64:79], a[72:75], v[196:199], v[64:79]
    ds_write_b128 v14, v[60:63] offset:5120
    v_mfma_f32_32x32x16_bf16 v[80:95], a[76:79], v[196:199], v[80:95]
    s_add_u32 s59, s59, 4096
    buffer_load_dwordx4 v[160:163], v1, s[32:35], s59 offen offset:0 sc1
    s_waitcnt vmcnt(10)
    v_mfma_f32_32x32x16_bf16 v[64:79], a[80:83], v[200:203], v[64:79]
    v_mfma_f32_32x32x16_bf16 v[80:95], a[84:87], v[200:203], v[80:95]
    buffer_load_dwordx4 v[164:167], v1, s[32:35], s59 offen offset:1024 sc1
    s_waitcnt vmcnt(10)
    v_mfma_f32_32x32x16_bf16 v[64:79], a[88:91], v[204:207], v[64:79]
    v_mfma_f32_32x32x16_bf16 v[80:95], a[92:95], v[204:207], v[80:95]
    buffer_load_dwordx4 v[168:171], v1, s[32:35], s59 offen offset:2048 sc1
    s_waitcnt lgkmcnt(0)
    s_barrier
    s_waitcnt vmcnt(10)
    v_mfma_f32_32x32x16_bf16 v[64:79], a[96:99], a[244:247], v[64:79]
    ds_read_b128 v[96:99], v5 offset:0
    ds_read_b128 v[100:103], v5 offset:1024
    ds_read_b128 v[104:107], v5 offset:2048
    ds_read_b128 v[108:111], v5 offset:3072
    ds_read_b128 v[112:115], v5 offset:4096
    ds_read_b128 v[116:119], v5 offset:5120
    v_mfma_f32_32x32x16_bf16 v[80:95], a[100:103], a[244:247], v[80:95]
    s_waitcnt lgkmcnt(4)
    v_add_f32 v32, v32, v96
    buffer_load_dwordx4 v[172:175], v1, s[32:35], s59 offen offset:3072 sc1
    v_add_f32 v33, v33, v97
    v_add_f32 v34, v34, v98
    s_waitcnt vmcnt(10)
    v_mfma_f32_32x32x16_bf16 v[64:79], a[104:107], a[240:243], v[64:79]
    v_add_f32 v35, v35, v99
    v_add_f32 v36, v36, v100
    v_add_f32 v37, v37, v101
    v_add_f32 v38, v38, v102
    v_add_f32 v39, v39, v103
    s_waitcnt lgkmcnt(0)
    v_mfma_f32_32x32x16_bf16 v[80:95], a[108:111], a[240:243], v[80:95]
    v_add_f32 v104, v104, v112
    v_add_f32 v105, v105, v113
    s_add_u32 s59, s59, 4096
    buffer_load_dwordx4 v[176:179], v1, s[32:35], s59 offen offset:0 sc1
    v_add_f32 v106, v106, v114
    s_waitcnt vmcnt(10)
    v_mfma_f32_32x32x16_bf16 v[64:79], a[112:115], a[236:239], v[64:79]
    v_add_f32 v107, v107, v115
    v_add_f32 v108, v108, v116
    v_add_f32 v109, v109, v117
    v_add_f32 v110, v110, v118
    v_add_f32 v111, v111, v119
    v_add_f32 v32, v32, v104
    v_mfma_f32_32x32x16_bf16 v[80:95], a[116:119], a[236:239], v[80:95]
    v_add_f32 v33, v33, v105
    v_add_f32 v34, v34, v106
    buffer_load_dwordx4 v[180:183], v1, s[32:35], s59 offen offset:1024 sc1
    v_add_f32 v35, v35, v107
    v_add_f32 v36, v36, v108
    s_waitcnt vmcnt(10)
    v_mfma_f32_32x32x16_bf16 v[64:79], a[120:123], a[232:235], v[64:79]
    v_add_f32 v37, v37, v109
    v_add_f32 v38, v38, v110
    v_add_f32 v39, v39, v111
    v_fma_f32 v32, v32, v128, v136
    v_fma_f32 v33, v33, v129, v137
    v_fma_f32 v34, v34, v130, v138
    v_mfma_f32_32x32x16_bf16 v[80:95], a[124:127], a[232:235], v[80:95]
    v_fma_f32 v35, v35, v131, v139
    v_fma_f32 v36, v36, v132, v140
    buffer_load_dwordx4 v[184:187], v1, s[32:35], s59 offen offset:2048 sc1
    v_fma_f32 v37, v37, v133, v141
    v_fma_f32 v38, v38, v134, v142
    s_waitcnt vmcnt(10)
    v_mfma_f32_32x32x16_bf16 v[64:79], a[128:131], a[252:255], v[64:79]
    v_fma_f32 v39, v39, v135, v143
    v_cvt_pk_bf16_f32 v144, v32, v33
    v_cvt_pk_bf16_f32 v145, v34, v35
    v_cvt_pk_bf16_f32 v146, v36, v37
    v_cvt_pk_bf16_f32 v147, v38, v39
    buffer_store_dwordx4 v[144:147], v3, s[28:31], s51 offen
    v_mfma_f32_32x32x16_bf16 v[80:95], a[132:135], a[252:255], v[80:95]
    s_add_u32 s51, s51, 28672
    buffer_load_dwordx4 v[188:191], v1, s[32:35], s59 offen offset:3072 sc1
    s_waitcnt vmcnt(11)
    v_mfma_f32_32x32x16_bf16 v[64:79], a[136:139], a[228:231], v[64:79]
    v_mfma_f32_32x32x16_bf16 v[80:95], a[140:143], a[228:231], v[80:95]
    s_waitcnt vmcnt(10)
    v_mfma_f32_32x32x16_bf16 v[64:79], a[144:147], a[248:251], v[64:79]
    v_mfma_f32_32x32x16_bf16 v[80:95], a[148:151], a[248:251], v[80:95]
    s_waitcnt vmcnt(9)
    v_mfma_f32_32x32x16_bf16 v[64:79], a[152:155], a[224:227], v[64:79]
    v_mfma_f32_32x32x16_bf16 v[80:95], a[156:159], a[224:227], v[80:95]
    s_waitcnt vmcnt(8)
    v_mfma_f32_32x32x16_bf16 v[64:79], a[160:163], v[160:163], v[64:79]
    v_mfma_f32_32x32x16_bf16 v[80:95], a[164:167], v[160:163], v[80:95]
    s_waitcnt vmcnt(7)
    v_mfma_f32_32x32x16_bf16 v[64:79], a[168:171], v[164:167], v[64:79]
    v_mfma_f32_32x32x16_bf16 v[80:95], a[172:175], v[164:167], v[80:95]
    s_waitcnt vmcnt(6)
    v_mfma_f32_32x32x16_bf16 v[64:79], a[176:179], v[168:171], v[64:79]
    v_mfma_f32_32x32x16_bf16 v[80:95], a[180:183], v[168:171], v[80:95]
    s_waitcnt vmcnt(5)
    v_mfma_f32_32x32x16_bf16 v[64:79], a[184:187], v[172:175], v[64:79]
    v_mfma_f32_32x32x16_bf16 v[80:95], a[188:191], v[172:175], v[80:95]
    s_waitcnt vmcnt(4)
    v_mfma_f32_32x32x16_bf16 v[64:79], a[192:195], v[176:179], v[64:79]
    v_mfma_f32_32x32x16_bf16 v[80:95], a[196:199], v[176:179], v[80:95]
    s_waitcnt vmcnt(3)
    v_mfma_f32_32x32x16_bf16 v[64:79], a[200:203], v[180:183], v[64:79]
    v_mfma_f32_32x32x16_bf16 v[80:95], a[204:207], v[180:183], v[80:95]
    s_waitcnt vmcnt(2)
    v_mfma_f32_32x32x16_bf16 v[64:79], a[208:211], v[184:187], v[64:79]
    v_mfma_f32_32x32x16_bf16 v[80:95], a[212:215], v[184:187], v[80:95]
    s_waitcnt vmcnt(0)
    v_mfma_f32_32x32x16_bf16 v[64:79], a[216:219], v[188:191], v[64:79]
    v_mfma_f32_32x32x16_bf16 v[80:95], a[220:223], v[188:191], v[80:95]
    s_nop 10
    ds_write_b128 v13, v[72:75] offset:34816
    ds_write_b128 v13, v[76:79] offset:35840
    ds_write_b128 v12, v[80:83] offset:32768
    ds_write_b128 v12, v[84:87] offset:33792
    ds_write_b128 v14, v[88:91] offset:36864
    ds_write_b128 v14, v[92:95] offset:37888
    s_waitcnt lgkmcnt(0)
    s_barrier
    ds_read_b128 v[96:99], v5 offset:32768
    ds_read_b128 v[100:103], v5 offset:33792
    ds_read_b128 v[104:107], v5 offset:34816
    ds_read_b128 v[108:111], v5 offset:35840
    ds_read_b128 v[112:115], v5 offset:36864
    ds_read_b128 v[116:119], v5 offset:37888
    s_waitcnt lgkmcnt(4)
    v_pk_add_f32 v[64:65], v[64:65], v[96:97]
    v_pk_add_f32 v[66:67], v[66:67], v[98:99]
    v_pk_add_f32 v[68:69], v[68:69], v[100:101]
    v_pk_add_f32 v[70:71], v[70:71], v[102:103]
    s_waitcnt lgkmcnt(0)
    v_pk_add_f32 v[104:105], v[104:105], v[112:113]
    v_pk_add_f32 v[106:107], v[106:107], v[114:115]
    v_pk_add_f32 v[108:109], v[108:109], v[116:117]
    v_pk_add_f32 v[110:111], v[110:111], v[118:119]
    v_pk_add_f32 v[64:65], v[64:65], v[104:105]
    v_pk_add_f32 v[66:67], v[66:67], v[106:107]
    v_pk_add_f32 v[68:69], v[68:69], v[108:109]
    v_pk_add_f32 v[70:71], v[70:71], v[110:111]
    v_pk_fma_f32 v[64:65], v[64:65], v[128:129], v[152:153]
    v_pk_fma_f32 v[66:67], v[66:67], v[130:131], v[154:155]
    v_pk_fma_f32 v[68:69], v[68:69], v[132:133], v[156:157]
    v_pk_fma_f32 v[70:71], v[70:71], v[134:135], v[158:159]
    v_cvt_pk_bf16_f32 v148, v64, v65
    v_cvt_pk_bf16_f32 v149, v66, v67
    v_cvt_pk_bf16_f32 v150, v68, v69
    v_cvt_pk_bf16_f32 v151, v70, v71
    buffer_store_dwordx4 v[148:151], v3, s[28:31], s51 offen
    s_branch L_end
L_poll_24_again:
    buffer_load_dword v8, v14, s[32:35], 0 offen sc1
    buffer_load_dwordx2 v[10:11], v243, s[32:35], s48 offen sc1
    s_add_u32 s52, s52, 1
    s_cmp_gt_u32 s52, 262144
    s_cbranch_scc0 L_poll_24
    s_branch L_abort
L_miss_25:
    s_nop 15
    v_mov_b32 v32, 0xf149f2ca
    v_mov_b32 v33, 0xf149f2ca
    v_mov_b32 v34, 0xf149f2ca
    v_mov_b32 v35, 0xf149f2ca
    v_mov_b32 v36, 0xf149f2ca
    v_mov_b32 v37, 0xf149f2ca
    v_mov_b32 v38, 0xf149f2ca
    v_mov_b32 v39, 0xf149f2ca
    v_mov_b32 v40, 0xf149f2ca
    v_mov_b32 v41, 0xf149f2ca
    v_mov_b32 v42, 0xf149f2ca
    v_mov_b32 v43, 0xf149f2ca
    v_mov_b32 v44, 0xf149f2ca
    v_mov_b32 v45, 0xf149f2ca
    v_mov_b32 v46, 0xf149f2ca
    v_mov_b32 v47, 0xf149f2ca
    s_branch L_miss_25_back
L_miss_26:
    s_nop 15
    v_mov_b32 v48, 0xf149f2ca
    v_mov_b32 v49, 0xf149f2ca
    v_mov_b32 v50, 0xf149f2ca
    v_mov_b32 v51, 0xf149f2ca
    v_mov_b32 v52, 0xf149f2ca
    v_mov_b32 v53, 0xf149f2ca
    v_mov_b32 v54, 0xf149f2ca
    v_mov_b32 v55, 0xf149f2ca
    v_mov_b32 v56, 0xf149f2ca
    v_mov_b32 v57, 0xf149f2ca
    v_mov_b32 v58, 0xf149f2ca
    v_mov_b32 v59, 0xf149f2ca
    v_mov_b32 v60, 0xf149f2ca
    v_mov_b32 v61, 0xf149f2ca
    v_mov_b32 v62, 0xf149f2ca
    v_mov_b32 v63, 0xf149f2ca
    s_branch L_miss_26_back
L_miss_27:
    s_nop 15
    v_mov_b32 v64, 0xf149f2ca
    v_mov_b32 v65, 0xf149f2ca
    v_mov_b32 v66, 0xf149f2ca
    v_mov_b32 v67, 0xf149f2ca
    v_mov_b32 v68, 0xf149f2ca
    v_mov_b32 v69, 0xf149f2ca
    v_mov_b32 v70, 0xf149f2ca
    v_mov_b32 v71, 0xf149f2ca
    v_mov_b32 v72, 0xf149f2ca
    v_mov_b32 v73, 0xf149f2ca
    v_mov_b32 v74, 0xf149f2ca
    v_mov_b32 v75, 0xf149f2ca
    v_mov_b32 v76, 0xf149f2ca
    v_mov_b32 v77, 0xf149f2ca
    v_mov_b32 v78, 0xf149f2ca
    v_mov_b32 v79, 0xf149f2ca
    s_branch L_miss_27_back
L_miss_28:
    s_nop 15
    v_mov_b32 v80, 0xf149f2ca
    v_mov_b32 v81, 0xf149f2ca
    v_mov_b32 v82, 0xf149f2ca
    v_mov_b32 v83, 0xf149f2ca
    v_mov_b32 v84, 0xf149f2ca
    v_mov_b32 v85, 0xf149f2ca
    v_mov_b32 v86, 0xf149f2ca
    v_mov_b32 v87, 0xf149f2ca
    v_mov_b32 v88, 0xf149f2ca
    v_mov_b32 v89, 0xf149f2ca
    v_mov_b32 v90, 0xf149f2ca
    v_mov_b32 v91, 0xf149f2ca
    v_mov_b32 v92, 0xf149f2ca
    v_mov_b32 v93, 0xf149f2ca
    v_mov_b32 v94, 0xf149f2ca
    v_mov_b32 v95, 0xf149f2ca
    s_branch L_miss_28_back
L_miss_29:
    s_nop 15
    v_mov_b32 v96, 0xf149f2ca
    v_mov_b32 v97, 0xf149f2ca
    v_mov_b32 v98, 0xf149f2ca
    v_mov_b32 v99, 0xf149f2ca
    v_mov_b32 v100, 0xf149f2ca
    v_mov_b32 v101, 0xf149f2ca
    v_mov_b32 v102, 0xf149f2ca
    v_mov_b32 v103, 0xf149f2ca
    v_mov_b32 v104, 0xf149f2ca
    v_mov_b32 v105, 0xf149f2ca
    v_mov_b32 v106, 0xf149f2ca
    v_mov_b32 v107, 0xf149f2ca
    v_mov_b32 v108, 0xf149f2ca
    v_mov_b32 v109, 0xf149f2ca
    v_mov_b32 v110, 0xf149f2ca
    v_mov_b32 v111, 0xf149f2ca
    s_branch L_miss_29_back
L_miss_30:
    s_nop 15
    v_mov_b32 v112, 0xf149f2ca
    v_mov_b32 v113, 0xf149f2ca
    v_mov_b32 v114, 0xf149f2ca
    v_mov_b32 v115, 0xf149f2ca
    v_mov_b32 v116, 0xf149f2ca
    v_mov_b32 v117, 0xf149f2ca
    v_mov_b32 v118, 0xf149f2ca
    v_mov_b32 v119, 0xf149f2ca
    v_mov_b32 v120, 0xf149f2ca
    v_mov_b32 v121, 0xf149f2ca
    v_mov_b32 v122, 0xf149f2ca
    v_mov_b32 v123, 0xf149f2ca
    v_mov_b32 v124, 0xf149f2ca
    v_mov_b32 v125, 0xf149f2ca
    v_mov_b32 v126, 0xf149f2ca
    v_mov_b32 v127, 0xf149f2ca
    s_branch L_miss_30_back
L_miss_31:
    s_nop 15
    v_mov_b32 v128, 0xf149f2ca
    v_mov_b32 v129, 0xf149f2ca
    v_mov_b32 v130, 0xf149f2ca
    v_mov_b32 v131, 0xf149f2ca
    v_mov_b32 v132, 0xf149f2ca
    v_mov_b32 v133, 0xf149f2ca
    v_mov_b32 v134, 0xf149f2ca
    v_mov_b32 v135, 0xf149f2ca
    v_mov_b32 v136, 0xf149f2ca
    v_mov_b32 v137, 0xf149f2ca
    v_mov_b32 v138, 0xf149f2ca
    v_mov_b32 v139, 0xf149f2ca
    v_mov_b32 v140, 0xf149f2ca
    v_mov_b32 v141, 0xf149f2ca
    v_mov_b32 v142, 0xf149f2ca
    v_mov_b32 v143, 0xf149f2ca
    s_branch L_miss_31_back
L_miss_32:
    s_nop 15
    v_mov_b32 v144, 0xf149f2ca
    v_mov_b32 v145, 0xf149f2ca
    v_mov_b32 v146, 0xf149f2ca
    v_mov_b32 v147, 0xf149f2ca
    v_mov_b32 v148, 0xf149f2ca
    v_mov_b32 v149, 0xf149f2ca
    v_mov_b32 v150, 0xf149f2ca
    v_mov_b32 v151, 0xf149f2ca
    v_mov_b32 v152, 0xf149f2ca
    v_mov_b32 v153, 0xf149f2ca
    v_mov_b32 v154, 0xf149f2ca
    v_mov_b32 v155, 0xf149f2ca
    v_mov_b32 v156, 0xf149f2ca
    v_mov_b32 v157, 0xf149f2ca
    v_mov_b32 v158, 0xf149f2ca
    v_mov_b32 v159, 0xf149f2ca
    s_branch L_miss_32_back
L_chk_36:
    s_mov_b32 s52, 0
L_chk_36_spin:
    buffer_load_dwordx2 v[232:233], v241, s[32:35], 0 offen offset:0 sc1
    buffer_load_dwordx2 v[234:235], v241, s[32:35], 0 offen offset:1792 sc1
    buffer_load_dwordx2 v[236:237], v242, s[32:35], 0 offen offset:0 sc1
    buffer_load_dwordx2 v[238:239], v242, s[32:35], 0 offen offset:1792 sc1
    s_add_u32 s52, s52, 1
    s_cmp_gt_u32 s52, 262144
    s_cbranch_scc1 L_abort
    s_waitcnt vmcnt(0)
    v_xor_b32 v255, s47, v233
    v_bitop3_b32 v255, v255, v235, s47 bitop3:0xf6
    v_bitop3_b32 v255, v255, v237, s47 bitop3:0xf6
    v_bitop3_b32 v255, v255, v239, s47 bitop3:0xf6
    v_cmp_ne_u32 vcc, 0, v255
    s_cbranch_vccnz L_chk_36_spin
    s_branch L_chk_36_back
L_poll_37_again:
    buffer_load_dword v10, v8, s[32:35], s53 offen sc1
    s_add_u32 s52, s52, 1
    s_cmp_gt_u32 s52, 262144
    s_cbranch_scc0 L_poll_37
    s_branch L_abort
L_poll_38_again:
    buffer_load_dword v10, v8, s[32:35], s53 offen sc1
    s_add_u32 s52, s52, 1
    s_cmp_gt_u32 s52, 262144
    s_cbranch_scc0 L_poll_38
    s_branch L_abort
L_hw_39:
    s_mov_b32 s52, 0
L_hw_39_spin:
    buffer_load_dword v9, v8, s[32:35], s53 offen sc1
    s_add_u32 s52, s52, 1
    s_cmp_gt_u32 s52, 262144
    s_cbranch_scc1 L_abort
    s_waitcnt vmcnt(0)
    v_cmp_ne_u32 vcc, s47, v9
    s_cbranch_vccnz L_hw_39_spin
    s_branch L_hw_39_back
L_hw_40:
    s_mov_b32 s52, 0
L_hw_40_spin:
    buffer_load_dword v9, v31, s[32:35], s48 offen offset:0 sc1
    s_add_u32 s52, s52, 1
    s_cmp_gt_u32 s52, 262144
    s_cbranch_scc1 L_abort
    s_waitcnt vmcnt(0)
    v_cmp_ne_u32 vcc, s47, v9
    s_cbranch_vccnz L_hw_40_spin
    s_branch L_hw_40_back
L_hw_41:
    s_mov_b32 s52, 0
L_hw_41_spin:
    buffer_load_dword v9, v31, s[32:35], s48 offen offset:512 sc1
    s_add_u32 s52, s52, 1
    s_cmp_gt_u32 s52, 262144
    s_cbranch_scc1 L_abort
    s_waitcnt vmcnt(0)
    v_cmp_ne_u32 vcc, s47, v9
    s_cbranch_vccnz L_hw_41_spin
    s_branch L_hw_41_back
    s_endpgm
.section .rodata,"a"
.p2align 6
.amdhsa_kernel adaLN_cond__sliding_block__glu_gated_reglu__prompt_kernel
  .amdhsa_next_free_vgpr 512
  .amdhsa_next_free_sgpr 102
  .amdhsa_accum_offset 256
  .amdhsa_group_segment_fixed_size 0
  .amdhsa_kernarg_size 96
  .amdhsa_user_sgpr_count 2
  .amdhsa_user_sgpr_kernarg_segment_ptr 1
  .amdhsa_system_sgpr_workgroup_id_x 1
  .amdhsa_float_denorm_mode_32 3
.end_amdhsa_kernel
```
